```python
import torch

def _softmax(x, axis=-1):
    return torch.softmax(x, dim=axis)
def _gelu(x):
    return torch.nn.functional.gelu(x, approximate="tanh")
def _silu(x):
    return torch.nn.functional.silu(x)
def _sigmoid(x):
    return torch.sigmoid(x)
def _layernorm(x, axis=-1, eps=1e-5):
    m = x.mean(dim=axis, keepdim=True)
    v = x.var(dim=axis, keepdim=True, unbiased=False)
    return (x - m) / torch.sqrt(v + eps)
def _scatter_add(tgt, idx, src, axis=0):
    return tgt.clone().index_add_(axis, idx, src)
def _segment_sum(src, seg, n):
    out = torch.zeros((n,) + src.shape[1:], dtype=src.dtype)
    return out.index_add_(0, seg, src)
def _pad(x, pw):
    flat = tuple(v for pair in reversed(pw) for v in pair)
    return torch.nn.functional.pad(x, flat)

kernel_name = 'interleave_layers__sliding_block__dense_activation_gelu__prompt'

def setup_inputs():

    _w = (lambda a: (lambda t: t.to(torch.bfloat16) if t.is_floating_point() else t)(torch.as_tensor(a)))
    def _A_setup():
        B, S, D = 1, 2048, 512
        return {
            "x": _w((lambda *s: torch.randn(*s, dtype=torch.bfloat16) * 0.05)(B, S, D)),
            "wqkv": _w((lambda *s: torch.randn(*s, dtype=torch.bfloat16) * 0.05)(D, 3 * D)),
            "wo": _w((lambda *s: torch.randn(*s, dtype=torch.bfloat16) * 0.05)(D, D)),
        }
    _A_in = _A_setup()

    def _B_setup():
        B, S, D, F = 1, 2048, 512, 1792
        return {
            "x": _w((lambda *s: torch.randn(*s, dtype=torch.bfloat16) * 0.05)(B, S, D)),
            "w1": _w((lambda *s: torch.randn(*s, dtype=torch.bfloat16) * 0.8)(D, F) * (D ** -0.5)),
            "b1": _w((lambda *s: torch.randn(*s, dtype=torch.bfloat16) * 0.8)(F) * 0.01),
            "w2": _w((lambda *s: torch.randn(*s, dtype=torch.bfloat16) * 0.8)(F, D) * (F ** -0.5)),
            "b2": _w((lambda *s: torch.randn(*s, dtype=torch.bfloat16) * 0.8)(D) * 0.01),
        }
    _B_in = _B_setup()

    return {
        "A_x": _A_in["x"],
        "A_wqkv": _A_in["wqkv"],
        "A_wo": _A_in["wo"],
        "B_x": _B_in["x"],
        "B_w1": _B_in["w1"],
        "B_b1": _B_in["b1"],
        "B_w2": _B_in["w2"],
        "B_b2": _B_in["b2"],
    }

def reference(A_x, A_wqkv, A_wo, B_x, B_w1, B_b1, B_w2, B_b2):
    def _A_ref(x, wqkv, wo):
        B, S, D = x.shape
        H = 32; Dh = D // H; W = 256
        qkv = (lambda x, *d: x.permute(*d))((x @ wqkv).reshape(B, S, 3, H, Dh), 2, 0, 3, 1, 4)
        q, k, v = qkv[0], qkv[1], qkv[2]
        scores = torch.einsum("bhqd,bhkd->bhqk", q, k) * (Dh ** -0.5)
        idx = torch.arange(S)
        mask = (idx[:, None] - idx[None, :] >= 0) & (idx[:, None] - idx[None, :] < W)
        scores = torch.where(mask[None, None], scores, -1e9)
        p = _softmax(scores, axis=-1)
        o = torch.einsum("bhqk,bhkd->bhqd", p, v)
        return (lambda x, *d: x.permute(*d))(o, 0, 2, 1, 3).reshape(B, S, D) @ wo

    def _B_ref(x, w1, b1, w2, b2):
        h = torch.einsum("bsd,df->bsf", x, w1) + b1
        h = _gelu(h)
        return torch.einsum("bsf,fd->bsd", h, w2) + b2

    x = A_x
    x = x + _A_ref(_layernorm(x, axis=-1), A_wqkv, A_wo)
    x = x + _B_ref(_layernorm(x, axis=-1), B_w1, B_b1, B_w2, B_b2)
    x = x + _A_ref(_layernorm(x, axis=-1), A_wqkv, A_wo)
    x = x + _B_ref(_layernorm(x, axis=-1), B_w1, B_b1, B_w2, B_b2)
    return x
```

```asm
; @launch grid=(256,1,1) block=(256,1,1) lds=163840
.amdgcn_target "amdgcn-amd-amdhsa--gfx950"
.text
.globl interleave_layers__sliding_block__dense_activation_gelu__prompt_kernel
.p2align 8
.type interleave_layers__sliding_block__dense_activation_gelu__prompt_kernel,@function
interleave_layers__sliding_block__dense_activation_gelu__prompt_kernel:
    s_cmp_ge_u32 s2, 256
    s_cbranch_scc1 M_END
    s_load_dwordx16 s[36:51], s[0:1], 0
    s_load_dwordx4 s[4:7], s[0:1], 64
    s_load_dwordx2 s[8:9], s[0:1], 80
    s_getpc_b64 s[52:53]
M_PC:
    v_lshlrev_b32 v9, 7, v0
    global_load_dword v15, v9, s[52:53]
    v_add_u32 v9, 0x8000, v9
    v_min_u32 v9, CODE_END-M_PC-4, v9
    global_load_dword v15, v9, s[52:53]
    v_and_b32 v8, 63, v0
    v_lshrrev_b32 v2, 6, v0
    v_lshlrev_b32 v1, 4, v8
    v_readfirstlane_b32 s12, v2
    s_and_b32 s13, s2, 7
    s_lshr_b32 s14, s2, 3
    v_and_b32 v4, 31, v0
    v_bfe_u32 v5, v0, 5, 1
    s_lshr_b32 s34, s13, 1
    s_and_b32 s19, s13, 1
    s_and_b32 s35, s14, 3
    s_lshr_b32 s26, s14, 2
    s_lshl_b32 s20, s34, 2
    s_add_u32 s20, s20, s35
    s_lshl_b32 s21, s19, 3
    s_add_u32 s21, s21, s26
    s_lshl_b32 s22, s20, 2
    s_add_u32 s22, s22, s12
    s_lshl_b32 s17, s12, 13
    s_mov_b32 s90, 2097152
    s_mov_b32 s91, 0x00020000
    s_mov_b32 s94, 1572864
    s_mov_b32 s95, 0x00020000
    v_lshrrev_b32 v204, 4, v8
    v_and_b32 v10, 7, v8
    v_xor_b32 v204, v204, v10
    v_lshlrev_b32 v204, 4, v204
    v_lshrrev_b32 v10, 3, v8
    v_lshl_add_u32 v204, v10, 10, v204
    v_xor_b32 v205, 64, v204
    s_mul_i32 s23, s12, 12288
    v_lshrrev_b32 v207, 2, v8
    v_and_b32 v11, 3, v8
    v_lshlrev_b32 v11, 4, v11
    v_mul_u32_u24 v206, 3072, v207
    v_add_u32 v206, v206, v11
    s_and_b32 s59, s26, 1
    s_mul_i32 s59, s59, 2
    s_and_b32 s34, s14, 1
    s_mul_i32 s34, s34, 2
    s_add_u32 s59, s59, s34
    s_mul_i32 s34, s13, 2
    s_add_u32 s59, s59, s34
    s_lshl_b32 s15, s22, 15
    s_lshl_b32 s16, s12, 10
    s_mul_i32 s63, s12, 49152
    s_lshl_b32 s34, s21, 6
    s_add_u32 s63, s63, s34
    s_waitcnt lgkmcnt(0)
    s_mov_b32 s88, s36
    s_mov_b32 s89, s37
    s_mov_b32 s92, s38
    s_mov_b32 s93, s39
    s_add_u32 s62, s59, 0
    s_and_b32 s62, s62, 7
    s_lshl_b32 s57, s62, 7
    s_add_u32 s57, s57, s15
    s_mul_i32 s62, s62, 196608
    s_add_u32 s62, s62, s63
    s_add_u32 m0, s23, 102400
    s_add_u32 s34, s57, 0
    buffer_load_dwordx4 v204, s[88:91], s34 offen lds
    s_add_u32 m0, s23, 103424
    s_add_u32 s34, s57, 8192
    buffer_load_dwordx4 v205, s[88:91], s34 offen lds
    s_add_u32 m0, s23, 104448
    s_add_u32 s34, s57, 16384
    buffer_load_dwordx4 v204, s[88:91], s34 offen lds
    s_add_u32 m0, s23, 105472
    s_add_u32 s34, s57, 24576
    buffer_load_dwordx4 v205, s[88:91], s34 offen lds
    s_add_u32 m0, s16, 33792
    s_add_u32 s34, s62, 1024
    buffer_load_dwordx4 v206, s[92:95], s34 offen lds
    s_add_u32 m0, s16, 67584
    s_add_u32 s34, s62, 2048
    buffer_load_dwordx4 v206, s[92:95], s34 offen lds
    s_add_u32 m0, s16, 0
    s_add_u32 s34, s62, 0
    buffer_load_dwordx4 v206, s[92:95], s34 offen lds
    s_add_u32 s62, s59, 1
    s_and_b32 s62, s62, 7
    s_lshl_b32 s57, s62, 7
    s_add_u32 s57, s57, s15
    s_mul_i32 s62, s62, 196608
    s_add_u32 s62, s62, s63
    v_mov_b32 v6, 0
    v_mov_b32 v7, 1
    v_mul_u32_u24 v0, 4352, v8
    v_add_u32 v2, 0x10000, v1
    v_add_u32 v3, 0x20000, v1
    s_mov_b32 s10, 54525952
    s_mov_b32 s11, 0x00020000
    s_mov_b32 s99, 0x00020000
    s_mov_b32 s55, 0x00020000
    s_mov_b32 s100, s50
    s_mov_b32 s101, s51
    s_mul_i32 s27, s19, 7
    s_min_u32 s34, s26, 6
    s_add_u32 s27, s27, s34
    s_lshl_b32 s18, s13, 2
    s_add_u32 s18, s18, s35
    s_and_b32 s24, s12, 1
    s_lshl_b32 s25, s18, 1
    s_add_u32 s24, s24, s25
    s_lshl_b32 s25, s26, 1
    s_lshr_b32 s35, s12, 1
    s_add_u32 s25, s25, s35
    s_cmp_lt_u32 s2, 224
    s_cbranch_scc1 NOZERO
    s_sub_u32 s34, s2, 224
    s_lshl_b32 s34, s34, 2
    s_add_u32 s34, s34, s12
    s_mul_i32 s34, s34, 30464
    s_add_u32 s34, s34, 50331648
    v_lshrrev_b32 v9, 3, v8
    v_mul_u32_u24 v9, 4352, v9
    v_and_b32 v10, 7, v8
    v_lshl_add_u32 v9, v10, 4, v9
    v_mov_b32 v24, 0
    v_mov_b32 v25, 0
    v_mov_b32 v26, 0
    v_mov_b32 v27, 0
    s_mov_b32 exec_hi, 0xffffff
    buffer_store_dwordx4 v[24:27], v9, s[8:11], s34 offen sc1
    s_mov_b64 exec, -1
NOZERO:
    s_lshl_b32 s34, s13, 4
    s_lshr_b32 s35, s14, 1
    s_add_u32 s34, s34, s35
    s_and_b32 s35, s14, 1
    s_cmp_lt_u32 s34, 16
    s_cbranch_scc1 U2_WO
    s_cmp_lt_u32 s34, 72
    s_cbranch_scc1 U2_W1
    s_mov_b32 s96, s48
    s_mov_b32 s97, s49
    s_mov_b32 s98, 1835008
    s_movk_i32 s28, 1024
    s_sub_u32 s34, s34, 72
    s_mul_i32 s29, s34, 9363
    s_lshr_b32 s29, s29, 16
    s_mul_i32 s41, s29, 7
    s_sub_u32 s41, s34, s41
    s_mov_b32 s30, 47185920
    s_movk_i32 s31, 112
    s_add_u32 s32, s29, 808
    s_mov_b32 s33, 0
    s_lshl_b32 s29, s29, 1
    s_add_u32 s29, s29, s35
    s_branch U2_GO
U2_WO:
    s_mov_b32 s96, s40
    s_mov_b32 s97, s41
    s_mov_b32 s98, 524288
    s_movk_i32 s28, 1024
    s_lshr_b32 s29, s34, 1
    s_and_b32 s41, s34, 1
    s_mov_b32 s30, 44040192
    s_movk_i32 s31, 32
    s_add_u32 s32, s29, 786
    s_mov_b32 s33, 0
    s_lshl_b32 s29, s29, 1
    s_add_u32 s29, s29, s35
    s_branch U2_GO
U2_W1:
    s_mov_b32 s96, s44
    s_mov_b32 s97, s45
    s_mov_b32 s98, 1835008
    s_movk_i32 s28, 3584
    s_sub_u32 s34, s34, 16
    s_lshr_b32 s29, s34, 1
    s_and_b32 s41, s34, 1
    s_mov_b32 s30, 45088768
    s_movk_i32 s31, 33
    s_mov_b32 s33, 1
    s_lshl_b32 s29, s29, 1
    s_add_u32 s29, s29, s35
    s_mul_i32 s32, s29, 4682
    s_lshr_b32 s32, s32, 16
    s_mul_i32 s32, s32, 14
    s_sub_u32 s32, s29, s32
    s_add_u32 s32, s32, 794
U2_GO:
    s_mov_b32 s52, s46
    s_mov_b32 s53, s47
    s_cmp_eq_u32 s41, 0
    s_cselect_b32 s54, 3584, 0
    v_lshlrev_b32 v9, 1, v4
    s_lshl_b32 s34, s29, 6
    buffer_load_ushort a0, v9, s[52:55], s34 offen
    v_mul_lo_u32 v207, v207, s28
    v_add_u32 v207, v207, v11
    s_lshl_b32 s39, s41, 2
    s_add_u32 s39, s39, s12
    s_lshl_b32 s39, s39, 6
    s_mul_i32 s39, s39, s28
    s_add_u32 s39, s39, s34
    s_lshl_b32 s35, s28, 4
    s_mul_i32 s3, s29, s31
    s_lshl_b32 s56, s41, 4
    s_add_u32 s56, s56, s3
    s_lshl_b32 s56, s56, 10
    s_add_u32 s56, s56, s30
    s_lshl_b32 s34, s12, 12
    s_add_u32 s56, s56, s34
    s_add_u32 s3, s3, 32
    s_lshl_b32 s3, s3, 10
    s_add_u32 s3, s3, s30
    s_mul_i32 s36, s32, 4352
    s_add_u32 s36, s36, 50331648
    s_lshl_b32 s37, s41, 1
    s_or_b32 s37, s37, s33
    v_lshlrev_b32 v9, 10, v4
    v_lshl_add_u32 v9, v5, 3, v9
    s_lshl_b32 s34, s24, 15
    s_lshl_b32 s19, s25, 6
    s_add_u32 s34, s34, s19
    buffer_load_dwordx2 v[212:213], v9, s[88:91], s34 offen offset:0
    buffer_load_dwordx2 v[214:215], v9, s[88:91], s34 offen offset:16
    buffer_load_dwordx2 v[216:217], v9, s[88:91], s34 offen offset:32
    buffer_load_dwordx2 v[218:219], v9, s[88:91], s34 offen offset:48
    s_mul_i32 s29, s21, 33792
    s_add_u32 s29, s29, 41943040
    s_min_u32 s34, s12, 2
    s_mul_i32 s28, s34, 540672
    s_add_u32 s28, s28, s29
    s_add_u32 s28, s28, 32768
    s_add_u32 s29, s29, s17
    s_mul_i32 s30, s27, 33792
    s_add_u32 s30, s30, 45088768
    s_mul_i32 s58, s12, 473088
    s_add_u32 s58, s58, s30
    s_add_u32 s58, s58, 32768
    s_add_u32 s30, s30, s17
    s_lshl_b32 s32, s24, 15
    s_lshl_b32 s33, s25, 11
    s_add_u32 s32, s32, s33
    s_lshl_b32 s33, s24, 12
    s_lshl_b32 s34, s25, 8
    s_add_u32 s33, s33, s34
    v_bfe_u32 v20, v8, 2, 2
    v_lshl_add_u32 v20, v5, 2, v20
    v_lshlrev_b32 v20, 6, v20
    v_bfe_u32 v21, v8, 4, 1
    v_lshl_add_u32 v20, v21, 5, v20
    v_and_b32 v21, 3, v8
    v_lshl_add_u32 v20, v21, 3, v20
    v_accvgpr_write_b32 a1, v20
    v_lshl_add_u32 v20, v5, 8, v20
    v_add_u32 v192, s16, v20
    v_xor_b32 v193, 0x400, v192
    v_xor_b32 v194, 0x800, v192
    v_xor_b32 v195, 0xc00, v192
    v_add_u32 v196, 0x10000, v192
    v_add_u32 v197, 0x10000, v193
    v_add_u32 v198, 0x10000, v194
    v_add_u32 v199, 0x10000, v195
    v_lshrrev_b32 v208, 2, v8
    v_xor_b32 v208, v208, v8
    v_bfe_u32 v208, v208, 2, 1
    v_add_u32 v208, -1, v208
    v_and_b32 v208, 0x3f803f80, v208
    v_mov_b32 v209, v208
    v_mov_b32 v210, v208
    v_mov_b32 v211, v208
    v_bfe_u32 v200, v4, 1, 3
    v_xor_b32 v200, v200, v5
    v_lshlrev_b32 v200, 4, v200
    v_lshl_add_u32 v200, v4, 7, v200
    s_lshl_b32 s34, s12, 5
    v_xor_b32 v200, s34, v200
    s_add_u32 s34, s23, 102400
    v_add_u32 v200, s34, v200
    v_xor_b32 v201, 32, v200
    v_xor_b32 v202, 64, v200
    v_xor_b32 v203, 0x60, v200
    s_add_u32 m0, s23, 106496
    s_add_u32 s34, s57, 0
    buffer_load_dwordx4 v204, s[88:91], s34 offen lds
    s_add_u32 m0, s23, 107520
    s_add_u32 s34, s57, 8192
    buffer_load_dwordx4 v205, s[88:91], s34 offen lds
    s_add_u32 m0, s23, 108544
    s_add_u32 s34, s57, 16384
    buffer_load_dwordx4 v204, s[88:91], s34 offen lds
    s_add_u32 m0, s23, 109568
    s_add_u32 s34, s57, 24576
    buffer_load_dwordx4 v205, s[88:91], s34 offen lds
    s_add_u32 m0, s16, 37888
    s_add_u32 s34, s62, 1024
    buffer_load_dwordx4 v206, s[92:95], s34 offen lds
    s_add_u32 m0, s16, 71680
    s_add_u32 s34, s62, 2048
    buffer_load_dwordx4 v206, s[92:95], s34 offen lds
    s_add_u32 m0, s16, 4096
    s_add_u32 s34, s62, 0
    buffer_load_dwordx4 v206, s[92:95], s34 offen lds
    s_waitcnt vmcnt(12)
    s_barrier
    ds_read_b128 v[64:67], v200 offset:0
    ds_read_b128 v[68:71], v201 offset:0
    ds_read_b128 v[72:75], v202 offset:0
    ds_read_b128 v[76:79], v203 offset:0
    ds_read_b64_tr_b16 a[224:225], v192 offset:33792
    ds_read_b64_tr_b16 a[226:227], v192 offset:34048
    ds_read_b64_tr_b16 a[228:229], v196 offset:2048
    ds_read_b64_tr_b16 a[230:231], v196 offset:2304
    ds_read_b64_tr_b16 a[232:233], v192 offset:0
    ds_read_b64_tr_b16 a[234:235], v192 offset:256
    ds_read_b64_tr_b16 a[236:237], v193 offset:33792
    ds_read_b64_tr_b16 a[238:239], v193 offset:34048
    s_waitcnt lgkmcnt(6)
    v_mfma_f32_32x32x16_bf16 v[16:31], a[224:227], v[64:67], 0
    ds_read_b64_tr_b16 a[240:241], v197 offset:2048
    ds_read_b64_tr_b16 a[242:243], v197 offset:2304
    v_mfma_f32_16x16x32_bf16 a[8:11], v[208:211], v[64:67], 0
    s_add_u32 s62, s59, 2
    s_and_b32 s62, s62, 7
    s_lshl_b32 s57, s62, 7
    s_add_u32 s57, s57, s15
    s_mul_i32 s62, s62, 196608
    s_add_u32 s62, s62, s63
    v_mfma_f32_16x16x32_bf16 a[40:43], v[208:211], a[224:227], 0
    s_add_u32 m0, s23, 110592
    s_add_u32 s34, s57, 0
    buffer_load_dwordx4 v204, s[88:91], s34 offen lds
    s_waitcnt lgkmcnt(6)
    v_mfma_f32_32x32x16_bf16 v[32:47], v[64:67], a[228:231], 0
    ds_read_b64_tr_b16 a[244:245], v194 offset:33792
    ds_read_b64_tr_b16 a[246:247], v194 offset:34048
    v_mfma_f32_32x32x16_bf16 a[24:39], v[64:67], v[64:67], 0
    s_add_u32 m0, s23, 111616
    s_add_u32 s34, s57, 8192
    buffer_load_dwordx4 v205, s[88:91], s34 offen lds
    s_add_u32 m0, s23, 112640
    s_add_u32 s34, s57, 16384
    buffer_load_dwordx4 v204, s[88:91], s34 offen lds
    v_mfma_f32_16x16x32_bf16 a[56:59], v[208:211], a[228:231], 0
    s_add_u32 m0, s23, 113664
    s_add_u32 s34, s57, 24576
    buffer_load_dwordx4 v205, s[88:91], s34 offen lds
    s_waitcnt lgkmcnt(6)
    v_mfma_f32_32x32x16_bf16 v[48:63], a[232:235], v[64:67], 0
    ds_read_b64_tr_b16 a[248:249], v198 offset:2048
    ds_read_b64_tr_b16 a[250:251], v198 offset:2304
    v_mfma_f32_16x16x32_bf16 a[72:75], v[208:211], a[232:235], 0
    s_add_u32 m0, s16, 41984
    s_add_u32 s34, s62, 1024
    buffer_load_dwordx4 v206, s[92:95], s34 offen lds
    s_waitcnt lgkmcnt(6)
    v_mfma_f32_32x32x16_bf16 v[16:31], a[236:239], v[68:71], v[16:31]
    ds_read_b64_tr_b16 a[252:253], v195 offset:33792
    ds_read_b64_tr_b16 a[254:255], v195 offset:34048
    v_mfma_f32_16x16x32_bf16 a[8:11], v[208:211], v[68:71], a[8:11]
    s_add_u32 m0, s16, 75776
    s_add_u32 s34, s62, 2048
    buffer_load_dwordx4 v206, s[92:95], s34 offen lds
    s_waitcnt lgkmcnt(6)
    v_mfma_f32_32x32x16_bf16 v[32:47], v[68:71], a[240:243], v[32:47]
    ds_read_b64_tr_b16 a[224:225], v199 offset:2048
    ds_read_b64_tr_b16 a[226:227], v199 offset:2304
    v_mfma_f32_32x32x16_bf16 a[24:39], v[68:71], v[68:71], a[24:39]
    s_add_u32 m0, s16, 8192
    s_add_u32 s34, s62, 0
    buffer_load_dwordx4 v206, s[92:95], s34 offen lds
    s_waitcnt lgkmcnt(6)
    v_mfma_f32_32x32x16_bf16 v[16:31], a[244:247], v[72:75], v[16:31]
    s_waitcnt vmcnt(7)
    s_barrier
    ds_read_b128 v[80:83], v200 offset:4096
    ds_read_b128 v[84:87], v201 offset:4096
    ds_read_b128 v[88:91], v202 offset:4096
    ds_read_b128 v[92:95], v203 offset:4096
    ds_read_b64_tr_b16 a[228:229], v192 offset:37888
    ds_read_b64_tr_b16 a[230:231], v192 offset:38144
    v_mfma_f32_16x16x32_bf16 a[8:11], v[208:211], v[72:75], a[8:11]
    s_waitcnt lgkmcnt(10)
    v_mfma_f32_32x32x16_bf16 v[32:47], v[72:75], a[248:251], v[32:47]
    ds_read_b64_tr_b16 a[232:233], v196 offset:6144
    ds_read_b64_tr_b16 a[234:235], v196 offset:6400
    v_mfma_f32_32x32x16_bf16 a[24:39], v[72:75], v[72:75], a[24:39]
    s_waitcnt lgkmcnt(10)
    v_mfma_f32_32x32x16_bf16 v[16:31], a[252:255], v[76:79], v[16:31]
    ds_read_b64_tr_b16 a[236:237], v192 offset:4096
    ds_read_b64_tr_b16 a[238:239], v192 offset:4352
    v_mfma_f32_16x16x32_bf16 a[8:11], v[208:211], v[76:79], a[8:11]
    s_waitcnt lgkmcnt(10)
    v_mfma_f32_32x32x16_bf16 v[32:47], v[76:79], a[224:227], v[32:47]
    ds_read_b64_tr_b16 a[240:241], v193 offset:37888
    ds_read_b64_tr_b16 a[242:243], v193 offset:38144
    v_mfma_f32_32x32x16_bf16 a[24:39], v[76:79], v[76:79], a[24:39]
    s_waitcnt lgkmcnt(6)
    v_mfma_f32_32x32x16_bf16 v[16:31], a[228:231], v[80:83], v[16:31]
    ds_read_b64_tr_b16 a[244:245], v197 offset:6144
    ds_read_b64_tr_b16 a[246:247], v197 offset:6400
    v_mfma_f32_16x16x32_bf16 a[8:11], v[208:211], v[80:83], a[8:11]
    s_add_u32 s62, s59, 3
    s_and_b32 s62, s62, 7
    s_lshl_b32 s57, s62, 7
    s_add_u32 s57, s57, s15
    s_mul_i32 s62, s62, 196608
    s_add_u32 s62, s62, s63
    v_mfma_f32_16x16x32_bf16 a[40:43], v[208:211], a[228:231], a[40:43]
    s_add_u32 m0, s23, 102400
    s_add_u32 s34, s57, 0
    buffer_load_dwordx4 v204, s[88:91], s34 offen lds
    s_waitcnt lgkmcnt(6)
    v_mfma_f32_32x32x16_bf16 v[32:47], v[80:83], a[232:235], v[32:47]
    ds_read_b64_tr_b16 a[248:249], v194 offset:37888
    ds_read_b64_tr_b16 a[250:251], v194 offset:38144
    v_mfma_f32_32x32x16_bf16 a[24:39], v[80:83], v[80:83], a[24:39]
    s_add_u32 m0, s23, 103424
    s_add_u32 s34, s57, 8192
    buffer_load_dwordx4 v205, s[88:91], s34 offen lds
    s_add_u32 m0, s23, 104448
    s_add_u32 s34, s57, 16384
    buffer_load_dwordx4 v204, s[88:91], s34 offen lds
    v_mfma_f32_16x16x32_bf16 a[56:59], v[208:211], a[232:235], a[56:59]
    s_add_u32 m0, s23, 105472
    s_add_u32 s34, s57, 24576
    buffer_load_dwordx4 v205, s[88:91], s34 offen lds
    s_waitcnt lgkmcnt(6)
    v_mfma_f32_32x32x16_bf16 v[48:63], a[236:239], v[80:83], v[48:63]
    ds_read_b64_tr_b16 a[252:253], v198 offset:6144
    ds_read_b64_tr_b16 a[254:255], v198 offset:6400
    v_mfma_f32_16x16x32_bf16 a[72:75], v[208:211], a[236:239], a[72:75]
    s_add_u32 m0, s16, 46080
    s_add_u32 s34, s62, 1024
    buffer_load_dwordx4 v206, s[92:95], s34 offen lds
    s_waitcnt lgkmcnt(6)
    v_mfma_f32_32x32x16_bf16 v[16:31], a[240:243], v[84:87], v[16:31]
    ds_read_b64_tr_b16 a[224:225], v195 offset:37888
    ds_read_b64_tr_b16 a[226:227], v195 offset:38144
    v_mfma_f32_16x16x32_bf16 a[8:11], v[208:211], v[84:87], a[8:11]
    s_add_u32 m0, s16, 79872
    s_add_u32 s34, s62, 2048
    buffer_load_dwordx4 v206, s[92:95], s34 offen lds
    s_waitcnt lgkmcnt(6)
    v_mfma_f32_32x32x16_bf16 v[32:47], v[84:87], a[244:247], v[32:47]
    ds_read_b64_tr_b16 a[228:229], v199 offset:6144
    ds_read_b64_tr_b16 a[230:231], v199 offset:6400
    v_mfma_f32_32x32x16_bf16 a[24:39], v[84:87], v[84:87], a[24:39]
    s_add_u32 m0, s16, 12288
    s_add_u32 s34, s62, 0
    buffer_load_dwordx4 v206, s[92:95], s34 offen lds
    s_cmp_lt_u32 s2, 224
    s_cbranch_scc1 NOZ2
    s_cmp_lg_u32 s12, 0
    s_cbranch_scc1 NOZ2
    s_mov_b32 s52, s6
    s_mov_b32 s53, s7
    s_movk_i32 s54, 256
    s_sub_u32 s34, s2, 224
    s_lshl_b32 s34, s34, 2
    s_mov_b64 exec, 1
    buffer_store_dword v7, v6, s[52:55], s34 offen sc1
    s_mov_b64 exec, -1
NOZ2:
    s_waitcnt lgkmcnt(6)
    v_mfma_f32_32x32x16_bf16 v[16:31], a[248:251], v[88:91], v[16:31]
    s_waitcnt vmcnt(7)
    s_barrier
    ds_read_b128 v[96:99], v200 offset:8192
    ds_read_b128 v[100:103], v201 offset:8192
    ds_read_b128 v[104:107], v202 offset:8192
    ds_read_b128 v[108:111], v203 offset:8192
    ds_read_b64_tr_b16 a[232:233], v192 offset:41984
    ds_read_b64_tr_b16 a[234:235], v192 offset:42240
    v_mfma_f32_16x16x32_bf16 a[8:11], v[208:211], v[88:91], a[8:11]
    s_waitcnt lgkmcnt(10)
    v_mfma_f32_32x32x16_bf16 v[32:47], v[88:91], a[252:255], v[32:47]
    ds_read_b64_tr_b16 a[236:237], v196 offset:10240
    ds_read_b64_tr_b16 a[238:239], v196 offset:10496
    v_mfma_f32_32x32x16_bf16 a[24:39], v[88:91], v[88:91], a[24:39]
    s_waitcnt lgkmcnt(10)
    v_mfma_f32_32x32x16_bf16 v[16:31], a[224:227], v[92:95], v[16:31]
    ds_read_b64_tr_b16 a[240:241], v192 offset:8192
    ds_read_b64_tr_b16 a[242:243], v192 offset:8448
    v_mfma_f32_16x16x32_bf16 a[8:11], v[208:211], v[92:95], a[8:11]
    s_waitcnt lgkmcnt(10)
    v_mfma_f32_32x32x16_bf16 v[32:47], v[92:95], a[228:231], v[32:47]
    ds_read_b64_tr_b16 a[244:245], v193 offset:41984
    ds_read_b64_tr_b16 a[246:247], v193 offset:42240
    v_mfma_f32_32x32x16_bf16 a[24:39], v[92:95], v[92:95], a[24:39]
    s_waitcnt lgkmcnt(6)
    v_mfma_f32_32x32x16_bf16 v[16:31], a[232:235], v[96:99], v[16:31]
    ds_read_b64_tr_b16 a[248:249], v197 offset:10240
    ds_read_b64_tr_b16 a[250:251], v197 offset:10496
    v_mfma_f32_16x16x32_bf16 a[8:11], v[208:211], v[96:99], a[8:11]
    s_add_u32 s62, s59, 4
    s_and_b32 s62, s62, 7
    s_lshl_b32 s57, s62, 7
    s_add_u32 s57, s57, s15
    s_mul_i32 s62, s62, 196608
    s_add_u32 s62, s62, s63
    v_mfma_f32_16x16x32_bf16 a[40:43], v[208:211], a[232:235], a[40:43]
    s_add_u32 m0, s23, 106496
    s_add_u32 s34, s57, 0
    buffer_load_dwordx4 v204, s[88:91], s34 offen lds
    s_waitcnt lgkmcnt(6)
    v_mfma_f32_32x32x16_bf16 v[32:47], v[96:99], a[236:239], v[32:47]
    ds_read_b64_tr_b16 a[252:253], v194 offset:41984
    ds_read_b64_tr_b16 a[254:255], v194 offset:42240
    v_mfma_f32_32x32x16_bf16 a[24:39], v[96:99], v[96:99], a[24:39]
    s_add_u32 m0, s23, 107520
    s_add_u32 s34, s57, 8192
    buffer_load_dwordx4 v205, s[88:91], s34 offen lds
    s_add_u32 m0, s23, 108544
    s_add_u32 s34, s57, 16384
    buffer_load_dwordx4 v204, s[88:91], s34 offen lds
    v_mfma_f32_16x16x32_bf16 a[56:59], v[208:211], a[236:239], a[56:59]
    s_add_u32 m0, s23, 109568
    s_add_u32 s34, s57, 24576
    buffer_load_dwordx4 v205, s[88:91], s34 offen lds
    s_waitcnt lgkmcnt(6)
    v_mfma_f32_32x32x16_bf16 v[48:63], a[240:243], v[96:99], v[48:63]
    ds_read_b64_tr_b16 a[224:225], v198 offset:10240
    ds_read_b64_tr_b16 a[226:227], v198 offset:10496
    v_mfma_f32_16x16x32_bf16 a[72:75], v[208:211], a[240:243], a[72:75]
    s_add_u32 m0, s16, 50176
    s_add_u32 s34, s62, 1024
    buffer_load_dwordx4 v206, s[92:95], s34 offen lds
    s_waitcnt lgkmcnt(6)
    v_mfma_f32_32x32x16_bf16 v[16:31], a[244:247], v[100:103], v[16:31]
    ds_read_b64_tr_b16 a[228:229], v195 offset:41984
    ds_read_b64_tr_b16 a[230:231], v195 offset:42240
    v_mfma_f32_16x16x32_bf16 a[8:11], v[208:211], v[100:103], a[8:11]
    s_add_u32 m0, s16, 83968
    s_add_u32 s34, s62, 2048
    buffer_load_dwordx4 v206, s[92:95], s34 offen lds
    s_waitcnt lgkmcnt(6)
    v_mfma_f32_32x32x16_bf16 v[32:47], v[100:103], a[248:251], v[32:47]
    ds_read_b64_tr_b16 a[232:233], v199 offset:10240
    ds_read_b64_tr_b16 a[234:235], v199 offset:10496
    v_mfma_f32_32x32x16_bf16 a[24:39], v[100:103], v[100:103], a[24:39]
    s_add_u32 m0, s16, 16384
    s_add_u32 s34, s62, 0
    buffer_load_dwordx4 v206, s[92:95], s34 offen lds
    v_lshlrev_b32 v240, 16, v212
    v_and_b32 v241, 0xffff0000, v212
    v_lshlrev_b32 v242, 16, v213
    s_waitcnt lgkmcnt(6)
    v_mfma_f32_32x32x16_bf16 v[16:31], a[252:255], v[104:107], v[16:31]
    s_waitcnt vmcnt(7)
    s_barrier
    ds_read_b128 v[112:115], v200 offset:0
    ds_read_b128 v[116:119], v201 offset:0
    ds_read_b128 v[120:123], v202 offset:0
    ds_read_b128 v[124:127], v203 offset:0
    ds_read_b64_tr_b16 a[236:237], v192 offset:46080
    ds_read_b64_tr_b16 a[238:239], v192 offset:46336
    v_mfma_f32_16x16x32_bf16 a[8:11], v[208:211], v[104:107], a[8:11]
    v_and_b32 v243, 0xffff0000, v213
    v_lshlrev_b32 v244, 16, v214
    v_and_b32 v245, 0xffff0000, v214
    s_waitcnt lgkmcnt(10)
    v_mfma_f32_32x32x16_bf16 v[32:47], v[104:107], a[224:227], v[32:47]
    ds_read_b64_tr_b16 a[240:241], v196 offset:14336
    ds_read_b64_tr_b16 a[242:243], v196 offset:14592
    v_mfma_f32_32x32x16_bf16 a[24:39], v[104:107], v[104:107], a[24:39]
    v_lshlrev_b32 v246, 16, v215
    v_and_b32 v247, 0xffff0000, v215
    v_lshlrev_b32 v248, 16, v216
    v_and_b32 v249, 0xffff0000, v216
    v_lshlrev_b32 v250, 16, v217
    v_and_b32 v251, 0xffff0000, v217
    s_waitcnt lgkmcnt(10)
    v_mfma_f32_32x32x16_bf16 v[16:31], a[228:231], v[108:111], v[16:31]
    ds_read_b64_tr_b16 a[244:245], v192 offset:12288
    ds_read_b64_tr_b16 a[246:247], v192 offset:12544
    v_mfma_f32_16x16x32_bf16 a[8:11], v[208:211], v[108:111], a[8:11]
    v_lshlrev_b32 v252, 16, v218
    v_and_b32 v253, 0xffff0000, v218
    v_lshlrev_b32 v254, 16, v219
    s_waitcnt lgkmcnt(10)
    v_mfma_f32_32x32x16_bf16 v[32:47], v[108:111], a[232:235], v[32:47]
    ds_read_b64_tr_b16 a[248:249], v193 offset:46080
    ds_read_b64_tr_b16 a[250:251], v193 offset:46336
    v_mfma_f32_32x32x16_bf16 a[24:39], v[108:111], v[108:111], a[24:39]
    v_and_b32 v255, 0xffff0000, v219
    s_waitcnt lgkmcnt(6)
    v_mfma_f32_32x32x16_bf16 v[16:31], a[236:239], v[112:115], v[16:31]
    ds_read_b64_tr_b16 a[252:253], v197 offset:14336
    ds_read_b64_tr_b16 a[254:255], v197 offset:14592
    v_mfma_f32_16x16x32_bf16 a[8:11], v[208:211], v[112:115], a[8:11]
    s_add_u32 s62, s59, 5
    s_and_b32 s62, s62, 7
    s_lshl_b32 s57, s62, 7
    s_add_u32 s57, s57, s15
    s_mul_i32 s62, s62, 196608
    s_add_u32 s62, s62, s63
    v_mfma_f32_16x16x32_bf16 a[40:43], v[208:211], a[236:239], a[40:43]
    s_add_u32 m0, s23, 110592
    s_add_u32 s34, s57, 0
    buffer_load_dwordx4 v204, s[88:91], s34 offen lds
    s_waitcnt lgkmcnt(6)
    v_mfma_f32_32x32x16_bf16 v[32:47], v[112:115], a[240:243], v[32:47]
    ds_read_b64_tr_b16 a[224:225], v194 offset:46080
    ds_read_b64_tr_b16 a[226:227], v194 offset:46336
    v_mfma_f32_32x32x16_bf16 a[24:39], v[112:115], v[112:115], a[24:39]
    s_add_u32 m0, s23, 111616
    s_add_u32 s34, s57, 8192
    buffer_load_dwordx4 v205, s[88:91], s34 offen lds
    s_add_u32 m0, s23, 112640
    s_add_u32 s34, s57, 16384
    buffer_load_dwordx4 v204, s[88:91], s34 offen lds
    v_mfma_f32_16x16x32_bf16 a[56:59], v[208:211], a[240:243], a[56:59]
    s_add_u32 m0, s23, 113664
    s_add_u32 s34, s57, 24576
    buffer_load_dwordx4 v205, s[88:91], s34 offen lds
    s_waitcnt lgkmcnt(6)
    v_mfma_f32_32x32x16_bf16 v[48:63], a[244:247], v[112:115], v[48:63]
    ds_read_b64_tr_b16 a[228:229], v198 offset:14336
    ds_read_b64_tr_b16 a[230:231], v198 offset:14592
    v_mfma_f32_16x16x32_bf16 a[72:75], v[208:211], a[244:247], a[72:75]
    s_add_u32 m0, s16, 54272
    s_add_u32 s34, s62, 1024
    buffer_load_dwordx4 v206, s[92:95], s34 offen lds
    s_waitcnt lgkmcnt(6)
    v_mfma_f32_32x32x16_bf16 v[16:31], a[248:251], v[116:119], v[16:31]
    ds_read_b64_tr_b16 a[232:233], v195 offset:46080
    ds_read_b64_tr_b16 a[234:235], v195 offset:46336
    v_mfma_f32_16x16x32_bf16 a[8:11], v[208:211], v[116:119], a[8:11]
    s_add_u32 m0, s16, 88064
    s_add_u32 s34, s62, 2048
    buffer_load_dwordx4 v206, s[92:95], s34 offen lds
    s_waitcnt lgkmcnt(6)
    v_mfma_f32_32x32x16_bf16 v[32:47], v[116:119], a[252:255], v[32:47]
    ds_read_b64_tr_b16 a[236:237], v199 offset:14336
    ds_read_b64_tr_b16 a[238:239], v199 offset:14592
    v_mfma_f32_32x32x16_bf16 a[24:39], v[116:119], v[116:119], a[24:39]
    s_add_u32 m0, s16, 20480
    s_add_u32 s34, s62, 0
    buffer_load_dwordx4 v206, s[92:95], s34 offen lds
    s_waitcnt lgkmcnt(6)
    v_mfma_f32_32x32x16_bf16 v[16:31], a[224:227], v[120:123], v[16:31]
    s_waitcnt vmcnt(7)
    s_barrier
    ds_read_b128 v[128:131], v200 offset:4096
    ds_read_b128 v[132:135], v201 offset:4096
    ds_read_b128 v[136:139], v202 offset:4096
    ds_read_b128 v[140:143], v203 offset:4096
    ds_read_b64_tr_b16 a[240:241], v192 offset:50176
    ds_read_b64_tr_b16 a[242:243], v192 offset:50432
    v_mfma_f32_16x16x32_bf16 a[8:11], v[208:211], v[120:123], a[8:11]
    s_waitcnt lgkmcnt(10)
    v_mfma_f32_32x32x16_bf16 v[32:47], v[120:123], a[228:231], v[32:47]
    ds_read_b64_tr_b16 a[244:245], v196 offset:18432
    ds_read_b64_tr_b16 a[246:247], v196 offset:18688
    v_mfma_f32_32x32x16_bf16 a[24:39], v[120:123], v[120:123], a[24:39]
    s_waitcnt lgkmcnt(10)
    v_mfma_f32_32x32x16_bf16 v[16:31], a[232:235], v[124:127], v[16:31]
    ds_read_b64_tr_b16 a[248:249], v192 offset:16384
    ds_read_b64_tr_b16 a[250:251], v192 offset:16640
    v_mfma_f32_16x16x32_bf16 a[8:11], v[208:211], v[124:127], a[8:11]
    s_waitcnt lgkmcnt(10)
    v_mfma_f32_32x32x16_bf16 v[32:47], v[124:127], a[236:239], v[32:47]
    ds_read_b64_tr_b16 a[252:253], v193 offset:50176
    ds_read_b64_tr_b16 a[254:255], v193 offset:50432
    v_mfma_f32_32x32x16_bf16 a[24:39], v[124:127], v[124:127], a[24:39]
    s_waitcnt lgkmcnt(6)
    v_mfma_f32_32x32x16_bf16 v[16:31], a[240:243], v[128:131], v[16:31]
    ds_read_b64_tr_b16 a[224:225], v197 offset:18432
    ds_read_b64_tr_b16 a[226:227], v197 offset:18688
    v_mfma_f32_16x16x32_bf16 a[8:11], v[208:211], v[128:131], a[8:11]
    s_add_u32 s62, s59, 6
    s_and_b32 s62, s62, 7
    s_lshl_b32 s57, s62, 7
    s_add_u32 s57, s57, s15
    s_mul_i32 s62, s62, 196608
    s_add_u32 s62, s62, s63
    v_mfma_f32_16x16x32_bf16 a[40:43], v[208:211], a[240:243], a[40:43]
    s_add_u32 m0, s23, 102400
    s_add_u32 s34, s57, 0
    buffer_load_dwordx4 v204, s[88:91], s34 offen lds
    s_waitcnt lgkmcnt(6)
    v_mfma_f32_32x32x16_bf16 v[32:47], v[128:131], a[244:247], v[32:47]
    ds_read_b64_tr_b16 a[228:229], v194 offset:50176
    ds_read_b64_tr_b16 a[230:231], v194 offset:50432
    v_mfma_f32_32x32x16_bf16 a[24:39], v[128:131], v[128:131], a[24:39]
    s_add_u32 m0, s23, 103424
    s_add_u32 s34, s57, 8192
    buffer_load_dwordx4 v205, s[88:91], s34 offen lds
    s_add_u32 m0, s23, 104448
    s_add_u32 s34, s57, 16384
    buffer_load_dwordx4 v204, s[88:91], s34 offen lds
    v_mfma_f32_16x16x32_bf16 a[56:59], v[208:211], a[244:247], a[56:59]
    s_add_u32 m0, s23, 105472
    s_add_u32 s34, s57, 24576
    buffer_load_dwordx4 v205, s[88:91], s34 offen lds
    s_waitcnt lgkmcnt(6)
    v_mfma_f32_32x32x16_bf16 v[48:63], a[248:251], v[128:131], v[48:63]
    ds_read_b64_tr_b16 a[232:233], v198 offset:18432
    ds_read_b64_tr_b16 a[234:235], v198 offset:18688
    v_mfma_f32_16x16x32_bf16 a[72:75], v[208:211], a[248:251], a[72:75]
    s_add_u32 m0, s16, 58368
    s_add_u32 s34, s62, 1024
    buffer_load_dwordx4 v206, s[92:95], s34 offen lds
    s_waitcnt lgkmcnt(6)
    v_mfma_f32_32x32x16_bf16 v[16:31], a[252:255], v[132:135], v[16:31]
    ds_read_b64_tr_b16 a[236:237], v195 offset:50176
    ds_read_b64_tr_b16 a[238:239], v195 offset:50432
    v_mfma_f32_16x16x32_bf16 a[8:11], v[208:211], v[132:135], a[8:11]
    s_add_u32 m0, s16, 92160
    s_add_u32 s34, s62, 2048
    buffer_load_dwordx4 v206, s[92:95], s34 offen lds
    s_waitcnt lgkmcnt(6)
    v_mfma_f32_32x32x16_bf16 v[32:47], v[132:135], a[224:227], v[32:47]
    ds_read_b64_tr_b16 a[240:241], v199 offset:18432
    ds_read_b64_tr_b16 a[242:243], v199 offset:18688
    v_mfma_f32_32x32x16_bf16 a[24:39], v[132:135], v[132:135], a[24:39]
    s_add_u32 m0, s16, 24576
    s_add_u32 s34, s62, 0
    buffer_load_dwordx4 v206, s[92:95], s34 offen lds
    s_waitcnt lgkmcnt(6)
    v_mfma_f32_32x32x16_bf16 v[16:31], a[228:231], v[136:139], v[16:31]
    s_waitcnt vmcnt(7)
    s_barrier
    ds_read_b128 v[144:147], v200 offset:8192
    ds_read_b128 v[148:151], v201 offset:8192
    ds_read_b128 v[152:155], v202 offset:8192
    ds_read_b128 v[156:159], v203 offset:8192
    ds_read_b64_tr_b16 a[244:245], v192 offset:54272
    ds_read_b64_tr_b16 a[246:247], v192 offset:54528
    v_mfma_f32_16x16x32_bf16 a[8:11], v[208:211], v[136:139], a[8:11]
    s_waitcnt lgkmcnt(10)
    v_mfma_f32_32x32x16_bf16 v[32:47], v[136:139], a[232:235], v[32:47]
    ds_read_b64_tr_b16 a[248:249], v196 offset:22528
    ds_read_b64_tr_b16 a[250:251], v196 offset:22784
    v_mfma_f32_32x32x16_bf16 a[24:39], v[136:139], v[136:139], a[24:39]
    s_waitcnt lgkmcnt(10)
    v_mfma_f32_32x32x16_bf16 v[16:31], a[236:239], v[140:143], v[16:31]
    ds_read_b64_tr_b16 a[252:253], v192 offset:20480
    ds_read_b64_tr_b16 a[254:255], v192 offset:20736
    v_mfma_f32_16x16x32_bf16 a[8:11], v[208:211], v[140:143], a[8:11]
    s_waitcnt lgkmcnt(10)
    v_mfma_f32_32x32x16_bf16 v[32:47], v[140:143], a[240:243], v[32:47]
    ds_read_b64_tr_b16 a[224:225], v193 offset:54272
    ds_read_b64_tr_b16 a[226:227], v193 offset:54528
    v_mfma_f32_32x32x16_bf16 a[24:39], v[140:143], v[140:143], a[24:39]
    s_waitcnt lgkmcnt(6)
    v_mfma_f32_32x32x16_bf16 v[16:31], a[244:247], v[144:147], v[16:31]
    ds_read_b64_tr_b16 a[228:229], v197 offset:22528
    ds_read_b64_tr_b16 a[230:231], v197 offset:22784
    v_mfma_f32_16x16x32_bf16 a[8:11], v[208:211], v[144:147], a[8:11]
    s_add_u32 s62, s59, 7
    s_and_b32 s62, s62, 7
    s_lshl_b32 s57, s62, 7
    s_add_u32 s57, s57, s15
    s_mul_i32 s62, s62, 196608
    s_add_u32 s62, s62, s63
    v_mfma_f32_16x16x32_bf16 a[40:43], v[208:211], a[244:247], a[40:43]
    s_add_u32 m0, s23, 106496
    s_add_u32 s34, s57, 0
    buffer_load_dwordx4 v204, s[88:91], s34 offen lds
    s_waitcnt lgkmcnt(6)
    v_mfma_f32_32x32x16_bf16 v[32:47], v[144:147], a[248:251], v[32:47]
    ds_read_b64_tr_b16 a[232:233], v194 offset:54272
    ds_read_b64_tr_b16 a[234:235], v194 offset:54528
    v_mfma_f32_32x32x16_bf16 a[24:39], v[144:147], v[144:147], a[24:39]
    s_add_u32 m0, s23, 107520
    s_add_u32 s34, s57, 8192
    buffer_load_dwordx4 v205, s[88:91], s34 offen lds
    s_add_u32 m0, s23, 108544
    s_add_u32 s34, s57, 16384
    buffer_load_dwordx4 v204, s[88:91], s34 offen lds
    v_mfma_f32_16x16x32_bf16 a[56:59], v[208:211], a[248:251], a[56:59]
    s_add_u32 m0, s23, 109568
    s_add_u32 s34, s57, 24576
    buffer_load_dwordx4 v205, s[88:91], s34 offen lds
    s_waitcnt lgkmcnt(6)
    v_mfma_f32_32x32x16_bf16 v[48:63], a[252:255], v[144:147], v[48:63]
    ds_read_b64_tr_b16 a[236:237], v198 offset:22528
    ds_read_b64_tr_b16 a[238:239], v198 offset:22784
    v_mfma_f32_16x16x32_bf16 a[72:75], v[208:211], a[252:255], a[72:75]
    s_add_u32 m0, s16, 62464
    s_add_u32 s34, s62, 1024
    buffer_load_dwordx4 v206, s[92:95], s34 offen lds
    s_waitcnt lgkmcnt(6)
    v_mfma_f32_32x32x16_bf16 v[16:31], a[224:227], v[148:151], v[16:31]
    ds_read_b64_tr_b16 a[240:241], v195 offset:54272
    ds_read_b64_tr_b16 a[242:243], v195 offset:54528
    v_mfma_f32_16x16x32_bf16 a[8:11], v[208:211], v[148:151], a[8:11]
    s_add_u32 m0, s16, 96256
    s_add_u32 s34, s62, 2048
    buffer_load_dwordx4 v206, s[92:95], s34 offen lds
    s_waitcnt lgkmcnt(6)
    v_mfma_f32_32x32x16_bf16 v[32:47], v[148:151], a[228:231], v[32:47]
    ds_read_b64_tr_b16 a[244:245], v199 offset:22528
    ds_read_b64_tr_b16 a[246:247], v199 offset:22784
    v_mfma_f32_32x32x16_bf16 a[24:39], v[148:151], v[148:151], a[24:39]
    s_add_u32 m0, s16, 28672
    s_add_u32 s34, s62, 0
    buffer_load_dwordx4 v206, s[92:95], s34 offen lds
    s_waitcnt lgkmcnt(6)
    v_mfma_f32_32x32x16_bf16 v[16:31], a[232:235], v[152:155], v[16:31]
    s_waitcnt vmcnt(7)
    s_barrier
    ds_read_b128 v[160:163], v200 offset:0
    ds_read_b128 v[164:167], v201 offset:0
    ds_read_b128 v[168:171], v202 offset:0
    ds_read_b128 v[172:175], v203 offset:0
    ds_read_b64_tr_b16 a[248:249], v192 offset:58368
    ds_read_b64_tr_b16 a[250:251], v192 offset:58624
    v_mfma_f32_16x16x32_bf16 a[8:11], v[208:211], v[152:155], a[8:11]
    s_waitcnt lgkmcnt(10)
    v_mfma_f32_32x32x16_bf16 v[32:47], v[152:155], a[236:239], v[32:47]
    ds_read_b64_tr_b16 a[252:253], v196 offset:26624
    ds_read_b64_tr_b16 a[254:255], v196 offset:26880
    v_mfma_f32_32x32x16_bf16 a[24:39], v[152:155], v[152:155], a[24:39]
    s_waitcnt lgkmcnt(10)
    v_mfma_f32_32x32x16_bf16 v[16:31], a[240:243], v[156:159], v[16:31]
    ds_read_b64_tr_b16 a[224:225], v192 offset:24576
    ds_read_b64_tr_b16 a[226:227], v192 offset:24832
    v_mfma_f32_16x16x32_bf16 a[8:11], v[208:211], v[156:159], a[8:11]
    s_waitcnt lgkmcnt(10)
    v_mfma_f32_32x32x16_bf16 v[32:47], v[156:159], a[244:247], v[32:47]
    ds_read_b64_tr_b16 a[228:229], v193 offset:58368
    ds_read_b64_tr_b16 a[230:231], v193 offset:58624
    v_mfma_f32_32x32x16_bf16 a[24:39], v[156:159], v[156:159], a[24:39]
    s_waitcnt lgkmcnt(6)
    v_mfma_f32_32x32x16_bf16 v[16:31], a[248:251], v[160:163], v[16:31]
    ds_read_b64_tr_b16 a[232:233], v197 offset:26624
    ds_read_b64_tr_b16 a[234:235], v197 offset:26880
    v_mfma_f32_16x16x32_bf16 a[8:11], v[208:211], v[160:163], a[8:11]
    s_add_u32 m0, s23, 110592
    s_nop 0
    buffer_load_dwordx4 v207, s[96:99], s39 offen lds
    s_add_u32 s39, s39, s35
    v_mfma_f32_16x16x32_bf16 a[40:43], v[208:211], a[248:251], a[40:43]
    s_add_u32 m0, s23, 111616
    s_nop 0
    buffer_load_dwordx4 v207, s[96:99], s39 offen lds
    s_add_u32 s39, s39, s35
    s_waitcnt lgkmcnt(6)
    v_mfma_f32_32x32x16_bf16 v[32:47], v[160:163], a[252:255], v[32:47]
    ds_read_b64_tr_b16 a[236:237], v194 offset:58368
    ds_read_b64_tr_b16 a[238:239], v194 offset:58624
    v_mfma_f32_32x32x16_bf16 a[24:39], v[160:163], v[160:163], a[24:39]
    s_add_u32 m0, s23, 112640
    s_nop 0
    buffer_load_dwordx4 v207, s[96:99], s39 offen lds
    s_add_u32 s39, s39, s35
    s_add_u32 m0, s23, 113664
    s_nop 0
    buffer_load_dwordx4 v207, s[96:99], s39 offen lds
    s_add_u32 s39, s39, s35
    v_mfma_f32_16x16x32_bf16 a[56:59], v[208:211], a[252:255], a[56:59]
    s_mov_b32 s15, 0
    s_mov_b32 s16, 0
    s_mov_b32 s88, s6
    s_waitcnt lgkmcnt(6)
    v_mfma_f32_32x32x16_bf16 v[48:63], a[224:227], v[160:163], v[48:63]
    ds_read_b64_tr_b16 a[240:241], v198 offset:26624
    ds_read_b64_tr_b16 a[242:243], v198 offset:26880
    v_mfma_f32_16x16x32_bf16 a[72:75], v[208:211], a[224:227], a[72:75]
    s_mov_b32 s89, s7
    s_movk_i32 s90, 256
    s_add_u32 s46, s16, 1
    s_waitcnt lgkmcnt(6)
    v_mfma_f32_32x32x16_bf16 v[16:31], a[228:231], v[164:167], v[16:31]
    ds_read_b64_tr_b16 a[244:245], v195 offset:58368
    ds_read_b64_tr_b16 a[246:247], v195 offset:58624
    v_mfma_f32_16x16x32_bf16 a[8:11], v[208:211], v[164:167], a[8:11]
    s_lshl_b32 s46, s46, 2
    s_lshl_b32 s34, s21, 18
    s_add_u32 s34, s34, s15
    s_waitcnt lgkmcnt(6)
    v_mfma_f32_32x32x16_bf16 v[32:47], v[164:167], a[232:235], v[32:47]
    ds_read_b64_tr_b16 a[248:249], v199 offset:26624
    ds_read_b64_tr_b16 a[250:251], v199 offset:26880
    v_mfma_f32_32x32x16_bf16 a[24:39], v[164:167], v[164:167], a[24:39]
    s_add_u32 s34, s34, 2097152
    s_lshl_b32 s47, s22, 12
    s_add_u32 s47, s47, s34
    s_lshl_b32 s19, s21, 4
    s_add_u32 s19, s19, s20
    s_mul_i32 s57, s19, 4352
    s_waitcnt lgkmcnt(6)
    v_mfma_f32_32x32x16_bf16 v[16:31], a[236:239], v[168:171], v[16:31]
    s_waitcnt vmcnt(4)
    s_barrier
    ds_read_b128 v[176:179], v200 offset:4096
    ds_read_b128 v[180:183], v201 offset:4096
    ds_read_b128 v[184:187], v202 offset:4096
    ds_read_b128 v[188:191], v203 offset:4096
    ds_read_b64_tr_b16 a[252:253], v192 offset:62464
    ds_read_b64_tr_b16 a[254:255], v192 offset:62720
    v_mfma_f32_16x16x32_bf16 a[8:11], v[208:211], v[168:171], a[8:11]
    s_add_u32 s57, s57, 50340352
    s_lshr_b32 s19, s12, 1
    s_mul_i32 s23, s19, 4352
    s_waitcnt lgkmcnt(10)
    v_mfma_f32_32x32x16_bf16 v[32:47], v[168:171], a[240:243], v[32:47]
    ds_read_b64_tr_b16 a[224:225], v196 offset:30720
    ds_read_b64_tr_b16 a[226:227], v196 offset:30976
    v_mfma_f32_32x32x16_bf16 a[24:39], v[168:171], v[168:171], a[24:39]
    s_add_u32 s23, s23, s57
    s_sub_u32 s23, s23, 8704
    s_add_u32 s19, s19, s20
    s_cmp_lt_u32 s19, 2
    s_cselect_b32 s46, 0, s46
    s_cselect_b32 s23, s57, s23
    s_lshl_b32 s49, s12, 14
    s_lshl_b32 s48, s12, 12
    s_waitcnt lgkmcnt(10)
    v_mfma_f32_32x32x16_bf16 v[16:31], a[244:247], v[172:175], v[16:31]
    ds_read_b64_tr_b16 a[228:229], v192 offset:28672
    ds_read_b64_tr_b16 a[230:231], v192 offset:28928
    v_mfma_f32_16x16x32_bf16 a[8:11], v[208:211], v[172:175], a[8:11]
    s_add_u32 s48, s48, s47
    s_sub_u32 s48, s48, 0x8000
    s_lshl_b32 s43, s26, 7
    s_waitcnt lgkmcnt(10)
    v_mfma_f32_32x32x16_bf16 v[32:47], v[172:175], a[248:251], v[32:47]
    ds_read_b64_tr_b16 a[232:233], v193 offset:62464
    ds_read_b64_tr_b16 a[234:235], v193 offset:62720
    v_mfma_f32_32x32x16_bf16 a[24:39], v[172:175], v[172:175], a[24:39]
    s_lshl_b32 s19, s12, 17
    s_add_u32 s43, s43, s19
    s_min_u32 s38, s22, 8
    s_lshl_b32 s42, s12, 7
    s_add_u32 s42, s42, 139264
    s_lshl_b32 s45, s22, 4
    s_waitcnt lgkmcnt(6)
    v_mfma_f32_32x32x16_bf16 v[16:31], a[252:255], v[176:179], v[16:31]
    ds_read_b64_tr_b16 a[236:237], v197 offset:30720
    ds_read_b64_tr_b16 a[238:239], v197 offset:30976
    v_mfma_f32_16x16x32_bf16 a[8:11], v[208:211], v[176:179], a[8:11]
    s_add_u32 s45, s45, s21
    s_lshl_b32 s45, s45, 11
    s_add_u32 s45, s45, s15
    v_mfma_f32_16x16x32_bf16 a[40:43], v[208:211], a[252:255], a[40:43]
    s_add_u32 s45, s45, 8388608
    s_lshl_b32 s19, s22, 1
    s_lshr_b32 s40, s21, 3
    s_waitcnt lgkmcnt(6)
    v_mfma_f32_32x32x16_bf16 v[32:47], v[176:179], a[224:227], v[32:47]
    ds_read_b64_tr_b16 a[240:241], v194 offset:62464
    ds_read_b64_tr_b16 a[242:243], v194 offset:62720
    v_mfma_f32_32x32x16_bf16 a[24:39], v[176:179], v[176:179], a[24:39]
    s_add_u32 s19, s19, s40
    s_mul_i32 s40, s19, 4352
    s_add_u32 s40, s40, 51454464
    v_mfma_f32_16x16x32_bf16 a[56:59], v[208:211], a[224:227], a[56:59]
    s_waitcnt lgkmcnt(6)
    v_mfma_f32_32x32x16_bf16 v[48:63], a[228:231], v[176:179], v[48:63]
    ds_read_b64_tr_b16 a[244:245], v198 offset:30720
    ds_read_b64_tr_b16 a[246:247], v198 offset:30976
    v_mfma_f32_16x16x32_bf16 a[72:75], v[208:211], a[228:231], a[72:75]
    s_waitcnt lgkmcnt(6)
    v_mfma_f32_32x32x16_bf16 v[16:31], a[232:235], v[180:183], v[16:31]
    ds_read_b64_tr_b16 a[248:249], v195 offset:62464
    ds_read_b64_tr_b16 a[250:251], v195 offset:62720
    v_mfma_f32_16x16x32_bf16 a[8:11], v[208:211], v[180:183], a[8:11]
    s_waitcnt lgkmcnt(6)
    v_mfma_f32_32x32x16_bf16 v[32:47], v[180:183], a[236:239], v[32:47]
    ds_read_b64_tr_b16 a[252:253], v199 offset:30720
    ds_read_b64_tr_b16 a[254:255], v199 offset:30976
    v_mfma_f32_32x32x16_bf16 a[24:39], v[180:183], v[180:183], a[24:39]
    s_waitcnt lgkmcnt(6)
    v_mfma_f32_32x32x16_bf16 v[16:31], a[240:243], v[184:187], v[16:31]
    ds_read_b64_tr_b16 a[224:225], v193 offset:0
    ds_read_b64_tr_b16 a[226:227], v193 offset:256
    v_mfma_f32_16x16x32_bf16 a[8:11], v[208:211], v[184:187], a[8:11]
    s_waitcnt lgkmcnt(6)
    v_mfma_f32_32x32x16_bf16 v[32:47], v[184:187], a[244:247], v[32:47]
    ds_read_b64_tr_b16 a[228:229], v194 offset:0
    ds_read_b64_tr_b16 a[230:231], v194 offset:256
    v_mfma_f32_32x32x16_bf16 a[24:39], v[184:187], v[184:187], a[24:39]
    s_waitcnt lgkmcnt(6)
    v_mfma_f32_32x32x16_bf16 v[16:31], a[248:251], v[188:191], v[16:31]
    ds_read_b64_tr_b16 a[232:233], v195 offset:0
    ds_read_b64_tr_b16 a[234:235], v195 offset:256
    v_mfma_f32_16x16x32_bf16 a[8:11], v[208:211], v[188:191], a[8:11]
    s_waitcnt lgkmcnt(6)
    v_mfma_f32_32x32x16_bf16 v[32:47], v[188:191], a[252:255], v[32:47]
    ds_read_b64_tr_b16 a[236:237], v193 offset:4096
    ds_read_b64_tr_b16 a[238:239], v193 offset:4352
    v_mfma_f32_32x32x16_bf16 a[24:39], v[188:191], v[188:191], a[24:39]
    s_waitcnt lgkmcnt(6)
    v_mfma_f32_32x32x16_bf16 v[48:63], a[224:227], v[68:71], v[48:63]
    ds_read_b64_tr_b16 a[240:241], v194 offset:4096
    ds_read_b64_tr_b16 a[242:243], v194 offset:4352
    v_accvgpr_read_b32 v204, a40
    v_accvgpr_read_b32 v205, a56
    v_accvgpr_read_b32 v206, a72
    v_lshrrev_b32 v13, 2, v1
    v_add_u32 v13, 153600, v13
    s_lshl_b32 s34, s12, 8
    v_add_u32 v11, s34, v13
    ds_write_b32 v11, v204 offset:0
    ds_write_b32 v11, v205 offset:1024
    ds_write_b32 v11, v206 offset:2048
    v_accvgpr_read_b32 v224, a8
    v_mov_b32 v225, 0
    v_lshlrev_b32 v12, 2, v5
    v_sub_u32 v12, v4, v12
    v_mul_f32 v224, 0.5, v224
    s_waitcnt lgkmcnt(0)
    v_mfma_f32_32x32x16_bf16 v[48:63], a[228:231], v[72:75], v[48:63]
    ds_read_b64_tr_b16 a[244:245], v195 offset:4096
    ds_read_b64_tr_b16 a[246:247], v195 offset:4352
    s_barrier
    ds_read_b32 v212, v13 offset:0
    v_cmp_eq_u32 vcc, 0, v12
    v_accvgpr_read_b32 v8, a24
    s_nop 0
    v_cndmask_b32 v225, v225, v8, vcc
    ds_read_b32 v213, v13 offset:256
    v_cmp_eq_u32 vcc, 1, v12
    v_accvgpr_read_b32 v8, a25
    s_nop 0
    v_cndmask_b32 v225, v225, v8, vcc
    ds_read_b32 v214, v13 offset:512
    v_cmp_eq_u32 vcc, 2, v12
    v_accvgpr_read_b32 v8, a26
    s_nop 0
    v_cndmask_b32 v225, v225, v8, vcc
    v_mfma_f32_32x32x16_bf16 v[48:63], a[232:235], v[76:79], v[48:63]
    ds_read_b64_tr_b16 a[248:249], v193 offset:8192
    ds_read_b64_tr_b16 a[250:251], v193 offset:8448
    ds_read_b32 v215, v13 offset:768
    v_cmp_eq_u32 vcc, 3, v12
    v_accvgpr_read_b32 v8, a27
    s_nop 0
    v_cndmask_b32 v225, v225, v8, vcc
    ds_read_b32 v216, v13 offset:1024
    v_cmp_eq_u32 vcc, 8, v12
    v_accvgpr_read_b32 v8, a28
    s_nop 0
    v_cndmask_b32 v225, v225, v8, vcc
    ds_read_b32 v217, v13 offset:1280
    v_cmp_eq_u32 vcc, 9, v12
    v_accvgpr_read_b32 v8, a29
    s_nop 0
    v_cndmask_b32 v225, v225, v8, vcc
    ds_read_b32 v218, v13 offset:1536
    v_mfma_f32_32x32x16_bf16 v[48:63], a[236:239], v[84:87], v[48:63]
    ds_read_b64_tr_b16 a[252:253], v194 offset:8192
    ds_read_b64_tr_b16 a[254:255], v194 offset:8448
    v_cmp_eq_u32 vcc, 10, v12
    v_accvgpr_read_b32 v8, a30
    s_nop 0
    v_cndmask_b32 v225, v225, v8, vcc
    ds_read_b32 v219, v13 offset:1792
    v_cmp_eq_u32 vcc, 11, v12
    v_accvgpr_read_b32 v8, a31
    s_nop 0
    v_cndmask_b32 v225, v225, v8, vcc
    ds_read_b32 v220, v13 offset:2048
    v_cmp_eq_u32 vcc, 16, v12
    v_accvgpr_read_b32 v8, a32
    s_nop 0
    v_cndmask_b32 v225, v225, v8, vcc
    ds_read_b32 v221, v13 offset:2304
    v_cmp_eq_u32 vcc, 17, v12
    v_mfma_f32_32x32x16_bf16 v[48:63], a[240:243], v[88:91], v[48:63]
    ds_read_b64_tr_b16 a[224:225], v195 offset:8192
    ds_read_b64_tr_b16 a[226:227], v195 offset:8448
    v_accvgpr_read_b32 v8, a33
    s_nop 0
    v_cndmask_b32 v225, v225, v8, vcc
    ds_read_b32 v222, v13 offset:2560
    v_cmp_eq_u32 vcc, 18, v12
    v_accvgpr_read_b32 v8, a34
    s_nop 0
    v_cndmask_b32 v225, v225, v8, vcc
    ds_read_b32 v223, v13 offset:2816
    v_cmp_eq_u32 vcc, 19, v12
    v_accvgpr_read_b32 v8, a35
    s_nop 0
    v_cndmask_b32 v225, v225, v8, vcc
    v_cmp_eq_u32 vcc, 24, v12
    v_accvgpr_read_b32 v8, a36
    s_nop 0
    s_waitcnt lgkmcnt(15)
    v_mfma_f32_32x32x16_bf16 v[48:63], a[244:247], v[92:95], v[48:63]
    ds_read_b64_tr_b16 a[228:229], v193 offset:12288
    ds_read_b64_tr_b16 a[230:231], v193 offset:12544
    v_cndmask_b32 v225, v225, v8, vcc
    v_cmp_eq_u32 vcc, 25, v12
    v_accvgpr_read_b32 v8, a37
    s_nop 0
    v_cndmask_b32 v225, v225, v8, vcc
    v_cmp_eq_u32 vcc, 26, v12
    v_accvgpr_read_b32 v8, a38
    s_nop 0
    v_cndmask_b32 v225, v225, v8, vcc
    v_cmp_eq_u32 vcc, 27, v12
    v_accvgpr_read_b32 v8, a39
    s_nop 0
    v_cndmask_b32 v225, v225, v8, vcc
    v_mov_b32 v8, v224
    v_mov_b32 v9, v225
    s_nop 0
    s_waitcnt lgkmcnt(15)
    v_mfma_f32_32x32x16_bf16 v[48:63], a[248:251], v[100:103], v[48:63]
    ds_read_b64_tr_b16 a[232:233], v194 offset:12288
    ds_read_b64_tr_b16 a[234:235], v194 offset:12544
    v_permlane32_swap_b32 v224, v8
    v_permlane32_swap_b32 v225, v9
    v_add_f32 v8, v224, v8
    v_add_f32 v9, v225, v9
    v_mul_f32 v8, 0xbb000000, v8
    v_mul_f32 v9, 0x3b000000, v9
    v_fma_f32 v9, -v8, v8, v9
    v_max_f32 v9, 0, v9
    v_add_f32 v9, 0x3727c5ac, v9
    v_sqrt_f32 v9, v9
    v_cvt_pk_bf16_f32 v228, v8, v8
    v_lshlrev_b32 v10, 16, v228
    v_sub_f32 v10, v8, v10
    v_rcp_f32 v14, v9
    s_waitcnt lgkmcnt(11)
    v_mfma_f32_32x32x16_bf16 v[48:63], a[252:255], v[104:107], v[48:63]
    ds_read_b64_tr_b16 a[236:237], v195 offset:12288
    ds_read_b64_tr_b16 a[238:239], v195 offset:12544
    v_cvt_pk_bf16_f32 v229, v10, v9
    v_and_b32 v10, 0xffff0000, v229
    v_sub_f32 v10, v9, v10
    v_cvt_pk_bf16_f32 v230, v10, 0
    v_mov_b32 v231, 0
    v_lshlrev_b32 v12, 2, v4
    v_add_u32 v12, s42, v12
    ds_write_b32 v12, v14
    v_lshlrev_b32 v12, 4, v5
    v_add_u32 v12, s42, v12
    v_mul_f32 v10, 0x3eb8aa3b, v14
    s_waitcnt lgkmcnt(7)
    v_cmp_eq_u32 vcc, 0, v5
    v_add_f32 v212, v212, v213
    v_add_f32 v214, v214, v215
    v_add_f32 v204, v212, v214
    v_mfma_f32_32x32x16_bf16 v[48:63], a[224:227], v[108:111], v[48:63]
    ds_read_b64_tr_b16 a[240:241], v193 offset:16384
    ds_read_b64_tr_b16 a[242:243], v193 offset:16640
    v_cndmask_b32 v204, 0, v204, vcc
    v_cvt_pk_bf16_f32 v213, v204, v204
    v_lshlrev_b32 v214, 16, v213
    v_sub_f32 v214, v204, v214
    v_cvt_pk_bf16_f32 v212, v204, v214
    v_and_b32 v213, 0xffff, v213
    v_mov_b32 v214, 0
    v_mov_b32 v215, 0
    v_add_f32 v216, v216, v217
    v_add_f32 v218, v218, v219
    v_add_f32 v205, v216, v218
    v_cndmask_b32 v205, 0, v205, vcc
    v_cvt_pk_bf16_f32 v217, v205, v205
    v_lshlrev_b32 v218, 16, v217
    v_sub_f32 v218, v205, v218
    v_cvt_pk_bf16_f32 v216, v205, v218
    v_and_b32 v217, 0xffff, v217
    v_mov_b32 v218, 0
    v_mov_b32 v219, 0
    v_add_f32 v220, v220, v221
    v_add_f32 v222, v222, v223
    v_add_f32 v206, v220, v222
    v_cndmask_b32 v206, 0, v206, vcc
    s_waitcnt lgkmcnt(7)
    v_mfma_f32_32x32x16_bf16 v[48:63], a[228:231], v[116:119], v[48:63]
    ds_read_b64_tr_b16 a[244:245], v194 offset:16384
    ds_read_b64_tr_b16 a[246:247], v194 offset:16640
    v_cvt_pk_bf16_f32 v221, v206, v206
    v_lshlrev_b32 v222, 16, v221
    v_sub_f32 v222, v206, v222
    v_cvt_pk_bf16_f32 v220, v206, v222
    v_and_b32 v221, 0xffff, v221
    v_mov_b32 v222, 0
    v_mov_b32 v223, 0
    v_mfma_f32_32x32x16_bf16 v[16:31], v[212:215], v[228:231], v[16:31]
    v_mfma_f32_32x32x16_bf16 v[32:47], v[228:231], v[216:219], v[32:47]
    v_mfma_f32_32x32x16_bf16 v[48:63], v[220:223], v[228:231], v[48:63]
    s_cmp_gt_u32 s22, 2
    s_cbranch_scc1 NOCP
    s_cmp_eq_u32 s22, 1
    s_cselect_b64 vcc, -1, 0
    v_cndmask_b32 v220, v220, v212, vcc
    v_cndmask_b32 v221, v221, v213, vcc
    v_cndmask_b32 v222, v222, v214, vcc
    v_cndmask_b32 v223, v223, v215, vcc
    s_cmp_eq_u32 s22, 2
    s_cselect_b64 vcc, -1, 0
    v_cndmask_b32 v220, v220, v216, vcc
    v_cndmask_b32 v221, v221, v217, vcc
    v_cndmask_b32 v222, v222, v218, vcc
    v_cndmask_b32 v223, v223, v219, vcc
    buffer_store_dwordx4 v[220:223], v1, s[8:11], s28 offen sc1
NOCP:
    s_nop 0
    s_nop 0
    s_nop 0
    s_nop 0
    ds_read_b128 v[224:227], v12 offset:0
    ds_read_b128 v[228:231], v12 offset:32
    ds_read_b128 v[232:235], v12 offset:64
    ds_read_b128 v[236:239], v12 offset:96
    v_mul_f32 v16, v16, v14
    v_mul_f32 v17, v17, v14
    s_waitcnt lgkmcnt(11)
    v_mfma_f32_32x32x16_bf16 v[48:63], a[232:235], v[120:123], v[48:63]
    ds_read_b64_tr_b16 a[248:249], v195 offset:16384
    ds_read_b64_tr_b16 a[250:251], v195 offset:16640
    v_mul_f32 v18, v18, v14
    v_mul_f32 v19, v19, v14
    v_mul_f32 v20, v20, v14
    v_mul_f32 v21, v21, v14
    v_mul_f32 v22, v22, v14
    v_mul_f32 v23, v23, v14
    s_waitcnt lgkmcnt(11)
    v_mfma_f32_32x32x16_bf16 v[48:63], a[236:239], v[124:127], v[48:63]
    ds_read_b64_tr_b16 a[252:253], v193 offset:20480
    ds_read_b64_tr_b16 a[254:255], v193 offset:20736
    v_cvt_pk_bf16_f32 v16, v16, v17
    v_cvt_pk_bf16_f32 v17, v18, v19
    v_cvt_pk_bf16_f32 v18, v20, v21
    v_cvt_pk_bf16_f32 v19, v22, v23
    buffer_store_dwordx4 v[16:19], v1, s[8:11], s47 offen offset:0 sc1
    v_mul_f32 v24, v24, v14
    s_waitcnt lgkmcnt(10)
    v_mfma_f32_32x32x16_bf16 v[48:63], a[240:243], v[132:135], v[48:63]
    ds_read_b64_tr_b16 a[224:225], v194 offset:20480
    ds_read_b64_tr_b16 a[226:227], v194 offset:20736
    v_mul_f32 v25, v25, v14
    v_mul_f32 v26, v26, v14
    v_mul_f32 v27, v27, v14
    v_mul_f32 v28, v28, v14
    v_mul_f32 v29, v29, v14
    v_mul_f32 v30, v30, v14
    s_waitcnt lgkmcnt(10)
    v_mfma_f32_32x32x16_bf16 v[48:63], a[244:247], v[136:139], v[48:63]
    ds_read_b64_tr_b16 a[228:229], v195 offset:20480
    ds_read_b64_tr_b16 a[230:231], v195 offset:20736
    v_mul_f32 v31, v31, v14
    v_cvt_pk_bf16_f32 v20, v24, v25
    v_cvt_pk_bf16_f32 v21, v26, v27
    v_cvt_pk_bf16_f32 v22, v28, v29
    v_cvt_pk_bf16_f32 v23, v30, v31
    buffer_store_dwordx4 v[20:23], v1, s[8:11], s47 offen offset:1024 sc1
    s_waitcnt lgkmcnt(6)
    v_mfma_f32_32x32x16_bf16 v[48:63], a[248:251], v[140:143], v[48:63]
    ds_read_b64_tr_b16 a[232:233], v193 offset:24576
    ds_read_b64_tr_b16 a[234:235], v193 offset:24832
    v_mul_f32 v32, v32, v224
    v_mul_f32 v33, v33, v225
    v_mul_f32 v34, v34, v226
    v_mul_f32 v35, v35, v227
    v_mul_f32 v36, v36, v228
    s_waitcnt lgkmcnt(6)
    v_mfma_f32_32x32x16_bf16 v[48:63], a[252:255], v[148:151], v[48:63]
    ds_read_b64_tr_b16 a[236:237], v194 offset:24576
    ds_read_b64_tr_b16 a[238:239], v194 offset:24832
    v_mul_f32 v37, v37, v229
    v_mul_f32 v38, v38, v230
    v_mul_f32 v39, v39, v231
    v_cvt_pk_bf16_f32 v32, v32, v33
    v_cvt_pk_bf16_f32 v33, v34, v35
    v_cvt_pk_bf16_f32 v34, v36, v37
    s_waitcnt lgkmcnt(6)
    v_mfma_f32_32x32x16_bf16 v[48:63], a[224:227], v[152:155], v[48:63]
    ds_read_b64_tr_b16 a[240:241], v195 offset:24576
    ds_read_b64_tr_b16 a[242:243], v195 offset:24832
    v_cvt_pk_bf16_f32 v35, v38, v39
    buffer_store_dwordx4 v[32:35], v1, s[8:11], s47 offen offset:2048 sc1
    v_mul_f32 v40, v40, v232
    v_mul_f32 v41, v41, v233
    v_mul_f32 v42, v42, v234
    v_mul_f32 v43, v43, v235
    s_waitcnt lgkmcnt(6)
    v_mfma_f32_32x32x16_bf16 v[48:63], a[228:231], v[156:159], v[48:63]
    ds_read_b64_tr_b16 a[244:245], v193 offset:28672
    ds_read_b64_tr_b16 a[246:247], v193 offset:28928
    v_mul_f32 v44, v44, v236
    v_mul_f32 v45, v45, v237
    v_mul_f32 v46, v46, v238
    v_mul_f32 v47, v47, v239
    v_cvt_pk_bf16_f32 v36, v40, v41
    v_cvt_pk_bf16_f32 v37, v42, v43
    s_waitcnt lgkmcnt(6)
    v_mfma_f32_32x32x16_bf16 v[48:63], a[232:235], v[164:167], v[48:63]
    ds_read_b64_tr_b16 a[248:249], v194 offset:28672
    ds_read_b64_tr_b16 a[250:251], v194 offset:28928
    v_cvt_pk_bf16_f32 v38, v44, v45
    v_cvt_pk_bf16_f32 v39, v46, v47
    buffer_store_dwordx4 v[36:39], v1, s[8:11], s47 offen offset:3072 sc1
    v_lshlrev_b32 v13, 2, v4
    buffer_load_dword v15, v13, s[88:91], 0 offen sc1
    v_lshrrev_b32 v40, 2, v4
    s_waitcnt lgkmcnt(6)
    v_mfma_f32_32x32x16_bf16 v[48:63], a[236:239], v[168:171], v[48:63]
    ds_read_b64_tr_b16 a[252:253], v195 offset:28672
    ds_read_b64_tr_b16 a[254:255], v195 offset:28928
    v_xor_b32 v40, v40, v4
    v_bfe_u32 v40, v40, 2, 1
    v_add_u32 v40, -1, v40
    v_and_b32 v40, 0x3f803f80, v40
    v_mov_b32 v41, v40
    v_mov_b32 v42, v40
    s_waitcnt lgkmcnt(6)
    v_mfma_f32_32x32x16_bf16 v[48:63], a[240:243], v[172:175], v[48:63]
    v_mov_b32 v43, v40
    s_mul_i32 s42, s12, 7168
    s_mul_i32 s31, s25, 114688
    s_add_u32 s31, s31, s42
    s_add_u32 s31, s31, 47185920
    s_xor_b32 s44, s25, 1
    s_waitcnt lgkmcnt(4)
    v_mfma_f32_32x32x16_bf16 v[48:63], a[244:247], v[180:183], v[48:63]
    s_mul_i32 s44, s44, 114688
    s_add_u32 s44, s44, s42
    s_add_u32 s44, s44, 47185920
    s_waitcnt lgkmcnt(2)
    v_mfma_f32_32x32x16_bf16 v[48:63], a[248:251], v[184:187], v[48:63]
    s_waitcnt lgkmcnt(0)
    v_mfma_f32_32x32x16_bf16 v[48:63], a[252:255], v[188:191], v[48:63]
    v_lshlrev_b32 v12, 2, v5
    v_sub_u32 v12, v4, v12
    v_mov_b32 v8, 0xf149f2ca
    v_cmp_le_i32 s[92:93], 0, v12
    v_cmp_le_i32 s[94:95], 1, v12
    s_nop 0
    v_cndmask_b32 v192, v8, 0, s[92:93]
    v_cndmask_b32 v208, 0, v8, s[92:93]
    v_cndmask_b32 v193, v8, 0, s[94:95]
    v_cndmask_b32 v209, 0, v8, s[94:95]
    v_cmp_le_i32 s[92:93], 2, v12
    v_cmp_le_i32 s[94:95], 3, v12
    s_nop 0
    v_cndmask_b32 v194, v8, 0, s[92:93]
    v_cndmask_b32 v210, 0, v8, s[92:93]
    v_cndmask_b32 v195, v8, 0, s[94:95]
    v_cndmask_b32 v211, 0, v8, s[94:95]
    v_cmp_le_i32 s[92:93], 8, v12
    v_cmp_le_i32 s[94:95], 9, v12
    s_nop 0
    v_cndmask_b32 v196, v8, 0, s[92:93]
    v_cndmask_b32 v212, 0, v8, s[92:93]
    v_cndmask_b32 v197, v8, 0, s[94:95]
    v_cndmask_b32 v213, 0, v8, s[94:95]
    v_cmp_le_i32 s[92:93], 10, v12
    v_cmp_le_i32 s[94:95], 11, v12
    s_nop 0
    v_cndmask_b32 v198, v8, 0, s[92:93]
    v_cndmask_b32 v214, 0, v8, s[92:93]
    v_cndmask_b32 v199, v8, 0, s[94:95]
    v_cndmask_b32 v215, 0, v8, s[94:95]
    v_cmp_le_i32 s[92:93], 16, v12
    v_cmp_le_i32 s[94:95], 17, v12
    s_nop 0
    v_cndmask_b32 v200, v8, 0, s[92:93]
    v_cndmask_b32 v216, 0, v8, s[92:93]
    v_cndmask_b32 v201, v8, 0, s[94:95]
    v_cndmask_b32 v217, 0, v8, s[94:95]
    v_cmp_le_i32 s[92:93], 18, v12
    v_cmp_le_i32 s[94:95], 19, v12
    s_nop 0
    v_cndmask_b32 v202, v8, 0, s[92:93]
    v_cndmask_b32 v218, 0, v8, s[92:93]
    v_cndmask_b32 v203, v8, 0, s[94:95]
    v_cndmask_b32 v219, 0, v8, s[94:95]
    v_cmp_le_i32 s[92:93], 24, v12
    v_cmp_le_i32 s[94:95], 25, v12
    s_nop 0
    v_cndmask_b32 v204, v8, 0, s[92:93]
    v_cndmask_b32 v220, 0, v8, s[92:93]
    v_cndmask_b32 v205, v8, 0, s[94:95]
    v_cndmask_b32 v221, 0, v8, s[94:95]
    v_cmp_le_i32 s[92:93], 26, v12
    v_cmp_le_i32 s[94:95], 27, v12
    s_nop 0
    v_cndmask_b32 v206, v8, 0, s[92:93]
    v_cndmask_b32 v222, 0, v8, s[92:93]
    v_cndmask_b32 v207, v8, 0, s[94:95]
    v_cndmask_b32 v223, 0, v8, s[94:95]
    s_waitcnt vmcnt(0)
    s_mov_b32 s59, 262144
    s_nop 2
FW:
    v_cmp_ne_u32 vcc, 0, v15
    s_nop 1
    s_cmp_eq_u64 vcc, -1
    s_cbranch_scc1 P1_DONE
    s_sleep 16
    buffer_load_dword v15, v13, s[88:91], 0 offen sc1
    s_waitcnt vmcnt(0)
    s_sub_u32 s59, s59, 1
    s_cbranch_scc0 FW
    s_branch P1_DONE
LAYER:
    s_mul_i32 s35, s22, 4352
    s_add_u32 s35, s35, 53404160
    v_lshlrev_b32 v12, 2, v5
    v_sub_u32 v12, v4, v12
    v_mov_b32 v8, 0xf149f2ca
    v_cmp_le_i32 s[92:93], 0, v12
    v_cmp_le_i32 s[94:95], 1, v12
    s_nop 0
    v_cndmask_b32 v192, v8, 0, s[92:93]
    v_cndmask_b32 v208, 0, v8, s[92:93]
    v_cndmask_b32 v193, v8, 0, s[94:95]
    v_cndmask_b32 v209, 0, v8, s[94:95]
    v_cmp_le_i32 s[92:93], 2, v12
    v_cmp_le_i32 s[94:95], 3, v12
    s_nop 0
    v_cndmask_b32 v194, v8, 0, s[92:93]
    v_cndmask_b32 v210, 0, v8, s[92:93]
    v_cndmask_b32 v195, v8, 0, s[94:95]
    v_cndmask_b32 v211, 0, v8, s[94:95]
    v_cmp_le_i32 s[92:93], 8, v12
    v_cmp_le_i32 s[94:95], 9, v12
    s_nop 0
    v_cndmask_b32 v196, v8, 0, s[92:93]
    v_cndmask_b32 v212, 0, v8, s[92:93]
    v_cndmask_b32 v197, v8, 0, s[94:95]
    v_cndmask_b32 v213, 0, v8, s[94:95]
    v_cmp_le_i32 s[92:93], 10, v12
    v_cmp_le_i32 s[94:95], 11, v12
    s_nop 0
    v_cndmask_b32 v198, v8, 0, s[92:93]
    v_cndmask_b32 v214, 0, v8, s[92:93]
    v_cndmask_b32 v199, v8, 0, s[94:95]
    v_cndmask_b32 v215, 0, v8, s[94:95]
    v_cmp_le_i32 s[92:93], 16, v12
    v_cmp_le_i32 s[94:95], 17, v12
    s_nop 0
    v_cndmask_b32 v200, v8, 0, s[92:93]
    v_cndmask_b32 v216, 0, v8, s[92:93]
    v_cndmask_b32 v201, v8, 0, s[94:95]
    v_cndmask_b32 v217, 0, v8, s[94:95]
    v_cmp_le_i32 s[92:93], 18, v12
    v_cmp_le_i32 s[94:95], 19, v12
    s_nop 0
    v_cndmask_b32 v202, v8, 0, s[92:93]
    v_cndmask_b32 v218, 0, v8, s[92:93]
    v_cndmask_b32 v203, v8, 0, s[94:95]
    v_cndmask_b32 v219, 0, v8, s[94:95]
    v_cmp_le_i32 s[92:93], 24, v12
    v_cmp_le_i32 s[94:95], 25, v12
    s_nop 0
    v_cndmask_b32 v204, v8, 0, s[92:93]
    v_cndmask_b32 v220, 0, v8, s[92:93]
    v_cndmask_b32 v205, v8, 0, s[94:95]
    v_cndmask_b32 v221, 0, v8, s[94:95]
    v_cmp_le_i32 s[92:93], 26, v12
    v_cmp_le_i32 s[94:95], 27, v12
    s_nop 0
    v_cndmask_b32 v206, v8, 0, s[92:93]
    v_cndmask_b32 v222, 0, v8, s[92:93]
    v_cndmask_b32 v207, v8, 0, s[94:95]
    v_cndmask_b32 v223, 0, v8, s[94:95]
    s_add_u32 s46, s16, 1
    s_lshl_b32 s46, s46, 2
    s_lshl_b32 s34, s21, 18
    s_add_u32 s34, s34, s15
    s_add_u32 s34, s34, 2097152
    s_lshl_b32 s47, s22, 12
    s_add_u32 s47, s47, s34
    s_lshl_b32 s19, s21, 4
    s_add_u32 s19, s19, s20
    s_mul_i32 s57, s19, 4352
    s_add_u32 s57, s57, 50340352
    s_lshr_b32 s19, s12, 1
    s_mul_i32 s23, s19, 4352
    s_add_u32 s23, s23, s57
    s_sub_u32 s23, s23, 8704
    s_add_u32 s19, s19, s20
    s_cmp_lt_u32 s19, 2
    s_cselect_b32 s46, 0, s46
    s_cselect_b32 s23, s57, s23
    s_lshl_b32 s49, s12, 14
    s_lshl_b32 s48, s12, 12
    s_add_u32 s48, s48, s47
    s_sub_u32 s48, s48, 0x8000
    s_lshl_b32 s43, s26, 7
    s_lshl_b32 s19, s12, 17
    s_add_u32 s43, s43, s19
    s_min_u32 s38, s22, 8
    s_lshl_b32 s42, s12, 7
    s_add_u32 s42, s42, 139264
    s_lshl_b32 s45, s22, 4
    s_add_u32 s45, s45, s21
    s_lshl_b32 s45, s45, 11
    s_add_u32 s45, s45, s15
    s_add_u32 s45, s45, 8388608
    s_lshl_b32 s19, s22, 1
    s_lshr_b32 s40, s21, 3
    s_add_u32 s19, s19, s40
    s_mul_i32 s40, s19, 4352
    s_add_u32 s40, s40, 51454464
    s_lshl_b32 s36, s22, 15
    s_add_u32 s36, s36, s15
    s_add_u32 s36, s36, 0
    s_lshl_b32 s37, s22, 12
    s_add_u32 s37, s37, s15
    s_add_u32 s37, s37, 19922944
    v_lshlrev_b32 v12, 3, v4
    v_lshl_add_u32 v12, v5, 11, v12
    s_mov_b64 exec, 1
    v_mov_b32 v15, 0
    buffer_atomic_add v15, v6, s[8:11], s35 offen offset:0 sc0 sc1
    s_mov_b64 exec, -1
    s_waitcnt vmcnt(0)
    s_mov_b64 exec, 1
    v_cmp_le_u32 vcc, 16, v15
    s_nop 1
    s_cmp_eq_u64 vcc, exec
    s_cbranch_scc1 POLL1D
    s_mov_b32 s59, 262144
    s_nop 0
POLL1:
    v_mov_b32 v15, 0
    buffer_atomic_add v15, v6, s[8:11], s35 offen offset:0 sc0 sc1
    s_waitcnt vmcnt(0)
    v_cmp_le_u32 vcc, 16, v15
    s_nop 1
    s_cmp_eq_u64 vcc, exec
    s_cbranch_scc1 POLL1D
    s_sub_u32 s59, s59, 1
    s_cbranch_scc0 POLL1
POLL1D:
    s_mov_b64 exec, -1
    buffer_load_dwordx4 v[64:67], v1, s[8:11], s36 offen offset:0 sc1
    buffer_load_dwordx4 v[68:71], v1, s[8:11], s36 offen offset:1024 sc1
    buffer_load_dwordx4 v[72:75], v1, s[8:11], s36 offen offset:2048 sc1
    buffer_load_dwordx4 v[76:79], v1, s[8:11], s36 offen offset:3072 sc1
    s_add_u32 s36, s36, 4096
    buffer_load_dwordx4 v[80:83], v1, s[8:11], s36 offen offset:0 sc1
    buffer_load_dwordx4 v[84:87], v1, s[8:11], s36 offen offset:1024 sc1
    buffer_load_dwordx4 v[88:91], v1, s[8:11], s36 offen offset:2048 sc1
    buffer_load_dwordx4 v[92:95], v1, s[8:11], s36 offen offset:3072 sc1
    s_add_u32 s36, s36, 4096
    buffer_load_dwordx4 v[96:99], v1, s[8:11], s36 offen offset:0 sc1
    buffer_load_dwordx4 v[100:103], v1, s[8:11], s36 offen offset:1024 sc1
    s_barrier
    ds_read_b128 a[224:227], v1 offset:33792
    ds_read_b128 a[228:231], v2 offset:2048
    ds_read_b128 a[232:235], v1 offset:0
    ds_read_b128 a[236:239], v1 offset:34816
    ds_read_b128 a[240:243], v2 offset:3072
    ds_read_b128 a[244:247], v1 offset:35840
    s_waitcnt vmcnt(9)
    s_waitcnt lgkmcnt(5)
    v_mfma_f32_32x32x16_bf16 v[16:31], a[224:227], v[64:67], 0
    ds_read_b128 a[248:251], v2 offset:4096
    buffer_load_dwordx4 v[104:107], v1, s[8:11], s36 offen offset:2048 sc1
    s_waitcnt lgkmcnt(5)
    v_mfma_f32_32x32x16_bf16 v[32:47], v[64:67], a[228:231], 0
    ds_read_b128 a[252:255], v1 offset:36864
    buffer_load_dwordx4 v[108:111], v1, s[8:11], s36 offen offset:3072 sc1
    s_add_u32 s36, s36, 4096
    s_waitcnt lgkmcnt(5)
    v_mfma_f32_32x32x16_bf16 v[48:63], a[232:235], v[64:67], 0
    ds_read_b128 a[224:227], v2 offset:5120
    buffer_load_dwordx4 v[112:115], v1, s[8:11], s36 offen offset:0 sc1
    s_waitcnt vmcnt(11)
    s_waitcnt lgkmcnt(5)
    v_mfma_f32_32x32x16_bf16 v[16:31], a[236:239], v[68:71], v[16:31]
    ds_read_b128 a[228:231], v1 offset:37888
    buffer_load_dwordx4 v[116:119], v1, s[8:11], s36 offen offset:1024 sc1
    s_waitcnt lgkmcnt(5)
    v_mfma_f32_32x32x16_bf16 v[32:47], v[68:71], a[240:243], v[32:47]
    ds_read_b128 a[232:235], v2 offset:6144
    buffer_load_dwordx4 v[120:123], v1, s[8:11], s36 offen offset:2048 sc1
    s_waitcnt vmcnt(12)
    s_waitcnt lgkmcnt(5)
    v_mfma_f32_32x32x16_bf16 v[16:31], a[244:247], v[72:75], v[16:31]
    ds_read_b128 a[236:239], v1 offset:1024
    buffer_load_dwordx4 v[124:127], v1, s[8:11], s36 offen offset:3072 sc1
    s_add_u32 s36, s36, 4096
    s_waitcnt lgkmcnt(5)
    v_mfma_f32_32x32x16_bf16 v[32:47], v[72:75], a[248:251], v[32:47]
    ds_read_b128 a[240:243], v1 offset:38912
    s_waitcnt vmcnt(12)
    s_waitcnt lgkmcnt(5)
    v_mfma_f32_32x32x16_bf16 v[16:31], a[252:255], v[76:79], v[16:31]
    ds_read_b128 a[244:247], v2 offset:7168
    buffer_load_dwordx4 v[128:131], v1, s[8:11], s36 offen offset:0 sc1
    s_waitcnt lgkmcnt(5)
    v_mfma_f32_32x32x16_bf16 v[32:47], v[76:79], a[224:227], v[32:47]
    ds_read_b128 a[248:251], v1 offset:39936
    s_waitcnt vmcnt(12)
    s_waitcnt lgkmcnt(5)
    v_mfma_f32_32x32x16_bf16 v[16:31], a[228:231], v[80:83], v[16:31]
    ds_read_b128 a[252:255], v2 offset:8192
    buffer_load_dwordx2 v[224:225], v12, s[8:11], s37 offen offset:0 sc1
    buffer_load_dwordx2 v[226:227], v12, s[8:11], s37 offen offset:256 sc1
    buffer_load_dwordx2 v[228:229], v12, s[8:11], s37 offen offset:512 sc1
    buffer_load_dwordx2 v[230:231], v12, s[8:11], s37 offen offset:768 sc1
    buffer_load_dwordx2 v[232:233], v12, s[8:11], s37 offen offset:1024 sc1
    buffer_load_dwordx2 v[234:235], v12, s[8:11], s37 offen offset:1280 sc1
    buffer_load_dwordx2 v[236:237], v12, s[8:11], s37 offen offset:1536 sc1
    buffer_load_dwordx2 v[238:239], v12, s[8:11], s37 offen offset:1792 sc1
    s_waitcnt lgkmcnt(5)
    v_mfma_f32_32x32x16_bf16 v[32:47], v[80:83], a[232:235], v[32:47]
    ds_read_b128 a[224:227], v1 offset:40960
    buffer_load_dwordx4 v[132:135], v1, s[8:11], s36 offen offset:1024 sc1
    s_waitcnt lgkmcnt(5)
    v_mfma_f32_32x32x16_bf16 v[48:63], a[236:239], v[68:71], v[48:63]
    ds_read_b128 a[228:231], v2 offset:9216
    s_waitcnt vmcnt(20)
    s_waitcnt lgkmcnt(5)
    v_mfma_f32_32x32x16_bf16 v[16:31], a[240:243], v[84:87], v[16:31]
    ds_read_b128 a[232:235], v1 offset:41984
    buffer_load_dwordx4 v[136:139], v1, s[8:11], s36 offen offset:2048 sc1
    s_waitcnt lgkmcnt(5)
    v_mfma_f32_32x32x16_bf16 v[32:47], v[84:87], a[244:247], v[32:47]
    ds_read_b128 a[236:239], v2 offset:10240
    s_waitcnt vmcnt(20)
    s_waitcnt lgkmcnt(5)
    v_mfma_f32_32x32x16_bf16 v[16:31], a[248:251], v[88:91], v[16:31]
    ds_read_b128 a[240:243], v1 offset:2048
    buffer_load_dwordx4 v[140:143], v1, s[8:11], s36 offen offset:3072 sc1
    s_add_u32 s36, s36, 4096
    s_waitcnt lgkmcnt(5)
    v_mfma_f32_32x32x16_bf16 v[32:47], v[88:91], a[252:255], v[32:47]
    ds_read_b128 a[244:247], v1 offset:43008
    s_waitcnt vmcnt(20)
    s_waitcnt lgkmcnt(5)
    v_mfma_f32_32x32x16_bf16 v[16:31], a[224:227], v[92:95], v[16:31]
    ds_read_b128 a[248:251], v2 offset:11264
    buffer_load_dwordx4 v[144:147], v1, s[8:11], s36 offen offset:0 sc1
    s_waitcnt lgkmcnt(5)
    v_mfma_f32_32x32x16_bf16 v[32:47], v[92:95], a[228:231], v[32:47]
    ds_read_b128 a[252:255], v1 offset:44032
    s_waitcnt vmcnt(20)
    s_waitcnt lgkmcnt(5)
    v_mfma_f32_32x32x16_bf16 v[16:31], a[232:235], v[96:99], v[16:31]
    ds_read_b128 a[224:227], v2 offset:12288
    buffer_load_dwordx4 v[148:151], v1, s[8:11], s36 offen offset:1024 sc1
    s_waitcnt lgkmcnt(5)
    v_mfma_f32_32x32x16_bf16 v[32:47], v[96:99], a[236:239], v[32:47]
    ds_read_b128 a[228:231], v1 offset:45056
    s_waitcnt lgkmcnt(5)
    v_mfma_f32_32x32x16_bf16 v[48:63], a[240:243], v[72:75], v[48:63]
    ds_read_b128 a[232:235], v2 offset:13312
    s_waitcnt vmcnt(20)
    s_waitcnt lgkmcnt(5)
    v_mfma_f32_32x32x16_bf16 v[16:31], a[244:247], v[100:103], v[16:31]
    ds_read_b128 a[236:239], v1 offset:46080
    buffer_load_dwordx4 v[152:155], v1, s[8:11], s36 offen offset:2048 sc1
    s_waitcnt lgkmcnt(5)
    v_mfma_f32_32x32x16_bf16 v[32:47], v[100:103], a[248:251], v[32:47]
    ds_read_b128 a[240:243], v2 offset:14336
    s_waitcnt vmcnt(20)
    s_waitcnt lgkmcnt(5)
    v_mfma_f32_32x32x16_bf16 v[16:31], a[252:255], v[104:107], v[16:31]
    ds_read_b128 a[244:247], v1 offset:3072
    buffer_load_dwordx4 v[156:159], v1, s[8:11], s36 offen offset:3072 sc1
    s_add_u32 s36, s36, 4096
    s_waitcnt lgkmcnt(5)
    v_mfma_f32_32x32x16_bf16 v[32:47], v[104:107], a[224:227], v[32:47]
    ds_read_b128 a[248:251], v1 offset:47104
    s_waitcnt vmcnt(20)
    s_waitcnt lgkmcnt(5)
    v_mfma_f32_32x32x16_bf16 v[16:31], a[228:231], v[108:111], v[16:31]
    ds_read_b128 a[252:255], v2 offset:15360
    buffer_load_dwordx4 v[160:163], v1, s[8:11], s36 offen offset:0 sc1
    s_waitcnt lgkmcnt(5)
    v_mfma_f32_32x32x16_bf16 v[32:47], v[108:111], a[232:235], v[32:47]
    ds_read_b128 a[224:227], v1 offset:48128
    s_waitcnt vmcnt(20)
    s_waitcnt lgkmcnt(5)
    v_mfma_f32_32x32x16_bf16 v[16:31], a[236:239], v[112:115], v[16:31]
    ds_read_b128 a[228:231], v2 offset:16384
    buffer_load_dwordx4 v[164:167], v1, s[8:11], s36 offen offset:1024 sc1
    s_waitcnt lgkmcnt(5)
    v_mfma_f32_32x32x16_bf16 v[32:47], v[112:115], a[240:243], v[32:47]
    ds_read_b128 a[232:235], v1 offset:49152
    s_waitcnt lgkmcnt(5)
    v_mfma_f32_32x32x16_bf16 v[48:63], a[244:247], v[76:79], v[48:63]
    ds_read_b128 a[236:239], v2 offset:17408
    s_waitcnt vmcnt(20)
    s_waitcnt lgkmcnt(5)
    v_mfma_f32_32x32x16_bf16 v[16:31], a[248:251], v[116:119], v[16:31]
    ds_read_b128 a[240:243], v1 offset:50176
    buffer_load_dwordx4 v[168:171], v1, s[8:11], s36 offen offset:2048 sc1
    s_waitcnt lgkmcnt(5)
    v_mfma_f32_32x32x16_bf16 v[32:47], v[116:119], a[252:255], v[32:47]
    ds_read_b128 a[244:247], v2 offset:18432
    s_waitcnt vmcnt(20)
    s_waitcnt lgkmcnt(5)
    v_mfma_f32_32x32x16_bf16 v[16:31], a[224:227], v[120:123], v[16:31]
    ds_read_b128 a[248:251], v1 offset:4096
    buffer_load_dwordx4 v[172:175], v1, s[8:11], s36 offen offset:3072 sc1
    s_add_u32 s36, s36, 4096
    s_waitcnt lgkmcnt(5)
    v_mfma_f32_32x32x16_bf16 v[32:47], v[120:123], a[228:231], v[32:47]
    ds_read_b128 a[252:255], v1 offset:51200
    s_waitcnt vmcnt(20)
    s_waitcnt lgkmcnt(5)
    v_mfma_f32_32x32x16_bf16 v[16:31], a[232:235], v[124:127], v[16:31]
    ds_read_b128 a[224:227], v2 offset:19456
    buffer_load_dwordx4 v[176:179], v1, s[8:11], s36 offen offset:0 sc1
    s_waitcnt lgkmcnt(5)
    v_mfma_f32_32x32x16_bf16 v[32:47], v[124:127], a[236:239], v[32:47]
    ds_read_b128 a[228:231], v1 offset:52224
    s_waitcnt vmcnt(20)
    s_waitcnt lgkmcnt(5)
    v_mfma_f32_32x32x16_bf16 v[16:31], a[240:243], v[128:131], v[16:31]
    ds_read_b128 a[232:235], v2 offset:20480
    buffer_load_dwordx4 v[180:183], v1, s[8:11], s36 offen offset:1024 sc1
    s_waitcnt lgkmcnt(5)
    v_mfma_f32_32x32x16_bf16 v[32:47], v[128:131], a[244:247], v[32:47]
    ds_read_b128 a[236:239], v1 offset:53248
    s_waitcnt lgkmcnt(5)
    v_mfma_f32_32x32x16_bf16 v[48:63], a[248:251], v[80:83], v[48:63]
    ds_read_b128 a[240:243], v2 offset:21504
    s_waitcnt vmcnt(12)
    s_waitcnt lgkmcnt(5)
    v_mfma_f32_32x32x16_bf16 v[16:31], a[252:255], v[132:135], v[16:31]
    ds_read_b128 a[244:247], v1 offset:54272
    buffer_load_dwordx4 v[184:187], v1, s[8:11], s36 offen offset:2048 sc1
    v_add_f32 v224, v224, v232
    v_add_f32 v225, v225, v233
    v_add_f32 v226, v226, v234
    v_add_f32 v227, v227, v235
    s_waitcnt lgkmcnt(5)
    v_mfma_f32_32x32x16_bf16 v[32:47], v[132:135], a[224:227], v[32:47]
    ds_read_b128 a[248:251], v2 offset:22528
    v_add_f32 v228, v228, v236
    v_add_f32 v229, v229, v237
    v_add_f32 v230, v230, v238
    v_add_f32 v231, v231, v239
    s_waitcnt vmcnt(12)
    s_waitcnt lgkmcnt(5)
    v_mfma_f32_32x32x16_bf16 v[16:31], a[228:231], v[136:139], v[16:31]
    ds_read_b128 a[252:255], v1 offset:5120
    buffer_load_dwordx4 v[188:191], v1, s[8:11], s36 offen offset:3072 sc1
    s_add_u32 s36, s36, 4096
    v_add_f32 v224, v224, v228
    v_add_f32 v225, v225, v229
    v_add_f32 v226, v226, v230
    v_add_f32 v227, v227, v231
    s_waitcnt lgkmcnt(5)
    v_mfma_f32_32x32x16_bf16 v[32:47], v[136:139], a[232:235], v[32:47]
    ds_read_b128 a[224:227], v1 offset:55296
    v_add_f32 v224, v224, v226
    v_add_f32 v225, v225, v227
    v_mov_b32 v8, v224
    v_mov_b32 v9, v225
    s_waitcnt vmcnt(12)
    s_waitcnt lgkmcnt(5)
    v_mfma_f32_32x32x16_bf16 v[16:31], a[236:239], v[140:143], v[16:31]
    ds_read_b128 a[228:231], v2 offset:23552
    s_nop 0
    v_permlane32_swap_b32 v224, v8
    v_permlane32_swap_b32 v225, v9
    v_add_f32 v8, v224, v8
    s_waitcnt lgkmcnt(5)
    v_mfma_f32_32x32x16_bf16 v[32:47], v[140:143], a[240:243], v[32:47]
    ds_read_b128 a[232:235], v1 offset:56320
    v_add_f32 v9, v225, v9
    v_mul_f32 v8, 0xbb000000, v8
    v_mul_f32 v9, 0x3b000000, v9
    v_fma_f32 v9, -v8, v8, v9
    s_waitcnt vmcnt(11)
    s_waitcnt lgkmcnt(5)
    v_mfma_f32_32x32x16_bf16 v[16:31], a[244:247], v[144:147], v[16:31]
    ds_read_b128 a[236:239], v2 offset:24576
    v_max_f32 v9, 0, v9
    v_add_f32 v9, 0x3727c5ac, v9
    v_sqrt_f32 v9, v9
    s_waitcnt lgkmcnt(5)
    v_mfma_f32_32x32x16_bf16 v[32:47], v[144:147], a[248:251], v[32:47]
    ds_read_b128 a[240:243], v1 offset:57344
    v_cvt_pk_bf16_f32 v228, v8, v8
    v_lshlrev_b32 v10, 16, v228
    v_sub_f32 v10, v8, v10
    s_waitcnt lgkmcnt(5)
    v_mfma_f32_32x32x16_bf16 v[48:63], a[252:255], v[84:87], v[48:63]
    ds_read_b128 a[244:247], v2 offset:25600
    v_rcp_f32 v14, v9
    v_cvt_pk_bf16_f32 v229, v10, v9
    v_and_b32 v10, 0xffff0000, v229
    s_waitcnt vmcnt(10)
    s_waitcnt lgkmcnt(5)
    v_mfma_f32_32x32x16_bf16 v[16:31], a[224:227], v[148:151], v[16:31]
    ds_read_b128 a[248:251], v1 offset:58368
    v_sub_f32 v10, v9, v10
    v_cvt_pk_bf16_f32 v230, v10, 0
    v_mov_b32 v231, 0
    v_lshlrev_b32 v12, 2, v4
    s_waitcnt lgkmcnt(5)
    v_mfma_f32_32x32x16_bf16 v[32:47], v[148:151], a[228:231], v[32:47]
    ds_read_b128 a[252:255], v2 offset:26624
    v_add_u32 v12, s42, v12
    ds_write_b32 v12, v14
    v_lshlrev_b32 v12, 4, v5
    v_add_u32 v12, s42, v12
    s_waitcnt vmcnt(9)
    s_waitcnt lgkmcnt(6)
    v_mfma_f32_32x32x16_bf16 v[16:31], a[232:235], v[152:155], v[16:31]
    ds_read_b128 a[224:227], v1 offset:6144
    v_mul_f32 v10, 0x3eb8aa3b, v14
    s_waitcnt lgkmcnt(6)
    v_mfma_f32_32x32x16_bf16 v[32:47], v[152:155], a[236:239], v[32:47]
    ds_read_b128 a[228:231], v1 offset:59392
    s_waitcnt vmcnt(8)
    s_waitcnt lgkmcnt(6)
    v_mfma_f32_32x32x16_bf16 v[16:31], a[240:243], v[156:159], v[16:31]
    ds_read_b128 a[232:235], v2 offset:27648
    s_waitcnt lgkmcnt(6)
    v_mfma_f32_32x32x16_bf16 v[32:47], v[156:159], a[244:247], v[32:47]
    ds_read_b128 a[236:239], v1 offset:60416
    s_waitcnt vmcnt(7)
    s_waitcnt lgkmcnt(6)
    v_mfma_f32_32x32x16_bf16 v[16:31], a[248:251], v[160:163], v[16:31]
    ds_read_b128 a[240:243], v2 offset:28672
    s_waitcnt lgkmcnt(6)
    v_mfma_f32_32x32x16_bf16 v[32:47], v[160:163], a[252:255], v[32:47]
    ds_read_b128 a[244:247], v1 offset:61440
    s_waitcnt lgkmcnt(5)
    v_mfma_f32_32x32x16_bf16 v[48:63], a[224:227], v[88:91], v[48:63]
    ds_read_b128 a[248:251], v2 offset:29696
    s_waitcnt vmcnt(6)
    s_waitcnt lgkmcnt(5)
    v_mfma_f32_32x32x16_bf16 v[16:31], a[228:231], v[164:167], v[16:31]
    ds_read_b128 a[252:255], v1 offset:62464
    s_waitcnt lgkmcnt(5)
    v_mfma_f32_32x32x16_bf16 v[32:47], v[164:167], a[232:235], v[32:47]
    ds_read_b128 a[224:227], v2 offset:30720
    s_waitcnt vmcnt(5)
    s_waitcnt lgkmcnt(5)
    v_mfma_f32_32x32x16_bf16 v[16:31], a[236:239], v[168:171], v[16:31]
    ds_read_b128 a[228:231], v1 offset:7168
    s_waitcnt lgkmcnt(5)
    v_mfma_f32_32x32x16_bf16 v[32:47], v[168:171], a[240:243], v[32:47]
    ds_read_b128 a[232:235], v1 offset:63488
    s_waitcnt vmcnt(4)
    s_waitcnt lgkmcnt(5)
    v_mfma_f32_32x32x16_bf16 v[16:31], a[244:247], v[172:175], v[16:31]
    ds_read_b128 a[236:239], v2 offset:31744
    s_waitcnt lgkmcnt(5)
    v_mfma_f32_32x32x16_bf16 v[32:47], v[172:175], a[248:251], v[32:47]
    ds_read_b128 a[240:243], v1 offset:64512
    s_waitcnt vmcnt(3)
    s_waitcnt lgkmcnt(5)
    v_mfma_f32_32x32x16_bf16 v[16:31], a[252:255], v[176:179], v[16:31]
    ds_read_b128 a[244:247], v2 offset:32768
    s_waitcnt lgkmcnt(5)
    v_mfma_f32_32x32x16_bf16 v[32:47], v[176:179], a[224:227], v[32:47]
    ds_read_b128 a[248:251], v2 offset:0
    s_waitcnt lgkmcnt(5)
    v_mfma_f32_32x32x16_bf16 v[48:63], a[228:231], v[92:95], v[48:63]
    ds_read_b128 a[252:255], v2 offset:33792
    s_waitcnt vmcnt(2)
    s_waitcnt lgkmcnt(5)
    v_mfma_f32_32x32x16_bf16 v[16:31], a[232:235], v[180:183], v[16:31]
    ds_read_b128 a[224:227], v2 offset:1024
    s_waitcnt lgkmcnt(5)
    v_mfma_f32_32x32x16_bf16 v[32:47], v[180:183], a[236:239], v[32:47]
    ds_read_b128 a[228:231], v2 offset:34816
    s_waitcnt vmcnt(1)
    s_waitcnt lgkmcnt(5)
    v_mfma_f32_32x32x16_bf16 v[16:31], a[240:243], v[184:187], v[16:31]
    ds_read_b128 a[232:235], v1 offset:32768
    s_waitcnt lgkmcnt(5)
    v_mfma_f32_32x32x16_bf16 v[32:47], v[184:187], a[244:247], v[32:47]
    ds_read_b128 a[236:239], v1 offset:8192
    s_waitcnt vmcnt(0)
    s_waitcnt lgkmcnt(5)
    v_mfma_f32_32x32x16_bf16 v[16:31], a[248:251], v[188:191], v[16:31]
    ds_read_b128 a[240:243], v1 offset:9216
    s_waitcnt lgkmcnt(5)
    v_mfma_f32_32x32x16_bf16 v[32:47], v[188:191], a[252:255], v[32:47]
    ds_read_b128 a[244:247], v1 offset:10240
    s_waitcnt lgkmcnt(5)
    v_mfma_f32_32x32x16_bf16 v[16:31], a[224:227], v[228:231], v[16:31]
    ds_read_b128 a[248:251], v1 offset:11264
    s_waitcnt lgkmcnt(5)
    v_mfma_f32_32x32x16_bf16 v[32:47], v[228:231], a[228:231], v[32:47]
    ds_read_b128 a[252:255], v1 offset:12288
    s_waitcnt lgkmcnt(5)
    v_mfma_f32_32x32x16_bf16 v[48:63], a[232:235], v[228:231], v[48:63]
    ds_read_b128 a[224:227], v1 offset:13312
    s_waitcnt lgkmcnt(5)
    v_mfma_f32_32x32x16_bf16 v[48:63], a[236:239], v[96:99], v[48:63]
    ds_read_b128 a[228:231], v1 offset:14336
    ds_read_b128 v[224:227], v12 offset:0
    ds_read_b128 v[228:231], v12 offset:32
    ds_read_b128 v[232:235], v12 offset:64
    ds_read_b128 v[236:239], v12 offset:96
    v_mul_f32 v16, v16, v14
    v_mul_f32 v17, v17, v14
    v_mul_f32 v18, v18, v14
    s_waitcnt lgkmcnt(9)
    v_mfma_f32_32x32x16_bf16 v[48:63], a[240:243], v[100:103], v[48:63]
    ds_read_b128 a[232:235], v1 offset:15360
    v_mul_f32 v19, v19, v14
    v_mul_f32 v20, v20, v14
    v_mul_f32 v21, v21, v14
    v_mul_f32 v22, v22, v14
    v_mul_f32 v23, v23, v14
    v_cvt_pk_bf16_f32 v16, v16, v17
    v_cvt_pk_bf16_f32 v17, v18, v19
    s_waitcnt lgkmcnt(9)
    v_mfma_f32_32x32x16_bf16 v[48:63], a[244:247], v[104:107], v[48:63]
    ds_read_b128 a[236:239], v1 offset:16384
    v_cvt_pk_bf16_f32 v18, v20, v21
    v_cvt_pk_bf16_f32 v19, v22, v23
    buffer_store_dwordx4 v[16:19], v1, s[8:11], s47 offen offset:0 sc1
    v_mul_f32 v24, v24, v14
    v_mul_f32 v25, v25, v14
    v_mul_f32 v26, v26, v14
    v_mul_f32 v27, v27, v14
    s_waitcnt lgkmcnt(9)
    v_mfma_f32_32x32x16_bf16 v[48:63], a[248:251], v[108:111], v[48:63]
    ds_read_b128 a[240:243], v1 offset:17408
    v_mul_f32 v28, v28, v14
    v_mul_f32 v29, v29, v14
    v_mul_f32 v30, v30, v14
    v_mul_f32 v31, v31, v14
    v_cvt_pk_bf16_f32 v20, v24, v25
    v_cvt_pk_bf16_f32 v21, v26, v27
    v_cvt_pk_bf16_f32 v22, v28, v29
    s_waitcnt lgkmcnt(9)
    v_mfma_f32_32x32x16_bf16 v[48:63], a[252:255], v[112:115], v[48:63]
    ds_read_b128 a[244:247], v1 offset:18432
    v_cvt_pk_bf16_f32 v23, v30, v31
    buffer_store_dwordx4 v[20:23], v1, s[8:11], s47 offen offset:1024 sc1
    s_waitcnt lgkmcnt(4)
    v_mul_f32 v32, v32, v224
    v_mul_f32 v33, v33, v225
    v_mul_f32 v34, v34, v226
    v_mul_f32 v35, v35, v227
    v_mfma_f32_32x32x16_bf16 v[48:63], a[224:227], v[116:119], v[48:63]
    ds_read_b128 a[248:251], v1 offset:19456
    v_mul_f32 v36, v36, v228
    v_mul_f32 v37, v37, v229
    v_mul_f32 v38, v38, v230
    v_mul_f32 v39, v39, v231
    v_cvt_pk_bf16_f32 v32, v32, v33
    v_cvt_pk_bf16_f32 v33, v34, v35
    v_cvt_pk_bf16_f32 v34, v36, v37
    v_mfma_f32_32x32x16_bf16 v[48:63], a[228:231], v[120:123], v[48:63]
    ds_read_b128 a[252:255], v1 offset:20480
    v_cvt_pk_bf16_f32 v35, v38, v39
    buffer_store_dwordx4 v[32:35], v1, s[8:11], s47 offen offset:2048 sc1
    v_mul_f32 v40, v40, v232
    v_mul_f32 v41, v41, v233
    v_mul_f32 v42, v42, v234
    v_mul_f32 v43, v43, v235
    v_mul_f32 v44, v44, v236
    s_waitcnt lgkmcnt(5)
    v_mfma_f32_32x32x16_bf16 v[48:63], a[232:235], v[124:127], v[48:63]
    ds_read_b128 a[224:227], v1 offset:21504
    v_mul_f32 v45, v45, v237
    v_mul_f32 v46, v46, v238
    v_mul_f32 v47, v47, v239
    v_cvt_pk_bf16_f32 v36, v40, v41
    v_cvt_pk_bf16_f32 v37, v42, v43
    v_cvt_pk_bf16_f32 v38, v44, v45
    v_cvt_pk_bf16_f32 v39, v46, v47
    s_waitcnt lgkmcnt(5)
    v_mfma_f32_32x32x16_bf16 v[48:63], a[236:239], v[128:131], v[48:63]
    ds_read_b128 a[228:231], v1 offset:22528
    buffer_store_dwordx4 v[36:39], v1, s[8:11], s47 offen offset:3072 sc1
    v_lshrrev_b32 v40, 2, v4
    v_xor_b32 v40, v40, v4
    v_bfe_u32 v40, v40, 2, 1
    v_add_u32 v40, -1, v40
    v_and_b32 v40, 0x3f803f80, v40
    v_mov_b32 v41, v40
    s_waitcnt lgkmcnt(5)
    v_mfma_f32_32x32x16_bf16 v[48:63], a[240:243], v[132:135], v[48:63]
    ds_read_b128 a[232:235], v1 offset:23552
    v_mov_b32 v42, v40
    v_mov_b32 v43, v40
    s_mul_i32 s42, s12, 7168
    s_mul_i32 s31, s25, 114688
    s_add_u32 s31, s31, s42
    s_add_u32 s31, s31, 47185920
    s_xor_b32 s44, s25, 1
    s_waitcnt lgkmcnt(5)
    v_mfma_f32_32x32x16_bf16 v[48:63], a[244:247], v[136:139], v[48:63]
    ds_read_b128 a[236:239], v1 offset:24576
    s_mul_i32 s44, s44, 114688
    s_add_u32 s44, s44, s42
    s_add_u32 s44, s44, 47185920
    s_waitcnt lgkmcnt(5)
    v_mfma_f32_32x32x16_bf16 v[48:63], a[248:251], v[140:143], v[48:63]
    ds_read_b128 a[240:243], v1 offset:25600
    s_waitcnt lgkmcnt(5)
    v_mfma_f32_32x32x16_bf16 v[48:63], a[252:255], v[144:147], v[48:63]
    ds_read_b128 a[244:247], v1 offset:26624
    s_waitcnt lgkmcnt(5)
    v_mfma_f32_32x32x16_bf16 v[48:63], a[224:227], v[148:151], v[48:63]
    ds_read_b128 a[248:251], v1 offset:27648
    s_waitcnt lgkmcnt(5)
    v_mfma_f32_32x32x16_bf16 v[48:63], a[228:231], v[152:155], v[48:63]
    ds_read_b128 a[252:255], v1 offset:28672
    s_waitcnt lgkmcnt(5)
    v_mfma_f32_32x32x16_bf16 v[48:63], a[232:235], v[156:159], v[48:63]
    ds_read_b128 a[224:227], v1 offset:29696
    s_waitcnt lgkmcnt(5)
    v_mfma_f32_32x32x16_bf16 v[48:63], a[236:239], v[160:163], v[48:63]
    ds_read_b128 a[228:231], v1 offset:30720
    s_waitcnt lgkmcnt(5)
    v_mfma_f32_32x32x16_bf16 v[48:63], a[240:243], v[164:167], v[48:63]
    ds_read_b128 a[232:235], v1 offset:31744
    s_waitcnt lgkmcnt(5)
    v_mfma_f32_32x32x16_bf16 v[48:63], a[244:247], v[168:171], v[48:63]
    s_waitcnt lgkmcnt(4)
    v_mfma_f32_32x32x16_bf16 v[48:63], a[248:251], v[172:175], v[48:63]
    s_waitcnt lgkmcnt(3)
    v_mfma_f32_32x32x16_bf16 v[48:63], a[252:255], v[176:179], v[48:63]
    s_waitcnt lgkmcnt(2)
    v_mfma_f32_32x32x16_bf16 v[48:63], a[224:227], v[180:183], v[48:63]
    s_waitcnt lgkmcnt(1)
    v_mfma_f32_32x32x16_bf16 v[48:63], a[228:231], v[184:187], v[48:63]
    s_waitcnt lgkmcnt(0)
    v_mfma_f32_32x32x16_bf16 v[48:63], a[232:235], v[188:191], v[48:63]
    s_waitcnt vmcnt(0)
P1_DONE:
    s_mov_b64 exec, 1
    buffer_atomic_add v7, v6, s[8:11], s57 offen offset:0 sc1
    s_mov_b64 exec, -1
    s_nop 7
    v_pk_mul_f32 v[48:49], v[48:49], v[10:11] op_sel_hi:[1,0]
    v_pk_mul_f32 v[50:51], v[50:51], v[10:11] op_sel_hi:[1,0]
    v_pk_mul_f32 v[52:53], v[52:53], v[10:11] op_sel_hi:[1,0]
    v_pk_mul_f32 v[54:55], v[54:55], v[10:11] op_sel_hi:[1,0]
    v_pk_mul_f32 v[56:57], v[56:57], v[10:11] op_sel_hi:[1,0]
    v_pk_mul_f32 v[58:59], v[58:59], v[10:11] op_sel_hi:[1,0]
    v_pk_mul_f32 v[60:61], v[60:61], v[10:11] op_sel_hi:[1,0]
    v_pk_mul_f32 v[62:63], v[62:63], v[10:11] op_sel_hi:[1,0]
    v_cvt_pk_bf16_f32 v48, v48, v49
    v_cvt_pk_bf16_f32 v49, v50, v51
    v_cvt_pk_bf16_f32 v50, v52, v53
    v_cvt_pk_bf16_f32 v51, v54, v55
    v_cvt_pk_bf16_f32 v52, v56, v57
    v_cvt_pk_bf16_f32 v53, v58, v59
    v_cvt_pk_bf16_f32 v54, v60, v61
    v_cvt_pk_bf16_f32 v55, v62, v63
    v_mfma_f32_32x32x16_bf16 v[64:79], v[16:19], v[48:51], v[192:207]
    s_nop 0
    v_mfma_f32_32x32x16_bf16 v[80:95], v[20:23], v[52:55], v[192:207]
    s_cmp_lg_u32 s16, 0
    s_cbranch_scc1 W_RDY
    s_load_dwordx2 s[96:97], s[0:1], 16
    s_mov_b32 s98, 524288
    v_accvgpr_read_b32 v128, a1
    v_accvgpr_read_b32 v129, a0
    s_mul_i32 s34, s12, 12288
    s_add_u32 s34, s34, 110592
    v_add_u32 v128, s34, v128
    s_lshl_b32 s34, s22, 1
    s_min_u32 s34, s34, 94
    s_lshr_b32 s39, s34, 5
    s_and_b32 s19, s26, 1
    s_mul_i32 s19, s19, 2
    s_and_b32 s35, s14, 1
    s_mul_i32 s35, s35, 2
    s_add_u32 s19, s19, s35
    s_mul_i32 s35, s13, 2
    s_add_u32 s19, s19, s35
    s_lshl_b32 s19, s19, 2
    s_sub_u32 s19, s34, s19
    s_and_b32 s19, s19, 31
    s_mul_i32 s35, s39, 33
    s_add_u32 s19, s19, s35
    s_lshl_b32 s19, s19, 10
    v_accvgpr_read_b32 v130, a1
    v_add_u32 v130, s19, v130
    ds_read_b64_tr_b16 v[132:133], v128 offset:0
    ds_read_b64_tr_b16 v[134:135], v128 offset:512
    ds_read_b64_tr_b16 v[136:137], v128 offset:1024
    ds_read_b64_tr_b16 v[138:139], v128 offset:1536
    ds_read_b64_tr_b16 v[140:141], v128 offset:2048
    ds_read_b64_tr_b16 v[142:143], v128 offset:2560
    ds_read_b64_tr_b16 v[144:145], v128 offset:3072
    ds_read_b64_tr_b16 v[146:147], v128 offset:3584
    ds_read_b64_tr_b16 v[148:149], v130 offset:0
    ds_read_b64_tr_b16 v[150:151], v130 offset:512
    ds_read_b64_tr_b16 v[152:153], v130 offset:1024
    ds_read_b64_tr_b16 v[154:155], v130 offset:1536
    s_and_b32 s19, s34, 31
    s_mul_i32 s39, s39, 528
    s_add_u32 s19, s19, s39
    s_lshl_b32 s19, s19, 10
    s_add_u32 s19, s19, s29
    s_sub_u32 s19, s19, s17
    v_mov_b32 v131, 0
    v_mov_b32 v156, 0x3f803f80
    s_waitcnt lgkmcnt(0)
    buffer_store_dwordx4 v[132:135], v1, s[8:11], s56 offen offset:0 sc1
    buffer_store_dwordx4 v[136:139], v1, s[8:11], s56 offen offset:1024 sc1
    buffer_store_dwordx4 v[140:143], v1, s[8:11], s56 offen offset:2048 sc1
    buffer_store_dwordx4 v[144:147], v1, s[8:11], s56 offen offset:3072 sc1
    buffer_store_dwordx4 v[148:151], v1, s[8:11], s19 offen sc1
    buffer_store_dwordx4 v[152:155], v1, s[8:11], s19 offen offset:1024 sc1
    s_bitcmp0_b32 s37, 0
    s_cbranch_scc1 W_RDY
    v_dot2_f32_bf16 v131, v132, v156, v131
    v_dot2_f32_bf16 v131, v133, v156, v131
    v_dot2_f32_bf16 v131, v134, v156, v131
    v_dot2_f32_bf16 v131, v135, v156, v131
    v_dot2_f32_bf16 v131, v136, v156, v131
    v_dot2_f32_bf16 v131, v137, v156, v131
    v_dot2_f32_bf16 v131, v138, v156, v131
    v_dot2_f32_bf16 v131, v139, v156, v131
    v_dot2_f32_bf16 v131, v140, v156, v131
    v_dot2_f32_bf16 v131, v141, v156, v131
    v_dot2_f32_bf16 v131, v142, v156, v131
    v_dot2_f32_bf16 v131, v143, v156, v131
    v_dot2_f32_bf16 v131, v144, v156, v131
    v_dot2_f32_bf16 v131, v145, v156, v131
    v_dot2_f32_bf16 v131, v146, v156, v131
    v_dot2_f32_bf16 v131, v147, v156, v131
    s_nop 2
    v_mov_b32 v130, v131
    v_lshrrev_b32 v128, 2, v1
    s_lshl_b32 s34, s12, 8
    s_add_u32 s34, s34, 153600
    v_permlane32_swap_b32 v131, v130
    v_add_u32 v128, s34, v128
    v_add_f32 v131, v131, v130
    ds_write_b32 v128, v131
    s_waitcnt lgkmcnt(0)
    s_barrier
    s_cmp_lg_u32 s12, 0
    s_cbranch_scc1 W_RDY
    ds_read_b32 v157, v128 offset:256
    ds_read_b32 v158, v128 offset:512
    ds_read_b32 v159, v128 offset:768
    s_lshr_b32 s34, s37, 1
    v_cmp_eq_u32 vcc, s34, v5
    s_waitcnt lgkmcnt(0)
    v_add_f32 v131, v131, v157
    v_add_f32 v158, v158, v159
    v_add_f32 v131, v131, v158
    v_cvt_pk_bf16_f32 v157, v131, v131
    v_lshlrev_b32 v158, 16, v157
    v_sub_f32 v158, v131, v158
    v_cvt_pk_bf16_f32 v156, v131, v158
    v_and_b32 v157, 0xffff, v157
    v_lshl_or_b32 v157, v129, 16, v157
    v_mov_b32 v158, v129
    v_mov_b32 v159, 0
    s_mov_b64 exec, vcc
    buffer_store_dwordx4 v[156:159], v1, s[8:11], s3 offen sc1
    s_mov_b64 exec, -1
W_RDY:
    s_barrier
    s_mov_b64 exec, 1
    v_mov_b32 v15, 0
    buffer_atomic_add v15, v6, s[8:11], s23 offen offset:0 sc0 sc1
    s_mov_b64 exec, -1
    s_lshl_b32 s34, s12, 12
    s_add_u32 s34, s34, 98304
    v_add_u32 v14, s34, v1
    ds_write_b128 v14, v[16:19] offset:32768
    ds_write_b128 v14, v[20:23] offset:33792
    ds_write_b128 v14, v[32:35] offset:34816
    ds_write_b128 v14, v[36:39] offset:35840
    v_max_f32 v8, v64, v65
    v_max3_f32 v8, v66, v67, v8
    v_max3_f32 v8, v68, v69, v8
    v_max3_f32 v8, v70, v71, v8
    v_max3_f32 v8, v72, v73, v8
    v_max3_f32 v8, v74, v75, v8
    v_max3_f32 v8, v76, v77, v8
    v_max3_f32 v8, v78, v79, v8
    v_mov_b32 v10, v8
    s_nop 1
    v_permlane32_swap_b32 v8, v10
    v_max_f32 v8, v8, v10
    v_sub_f32 v8, 0, v8
    v_pk_add_f32 v[64:65], v[64:65], v[8:9] op_sel_hi:[1,0]
    v_pk_add_f32 v[66:67], v[66:67], v[8:9] op_sel_hi:[1,0]
    v_pk_add_f32 v[68:69], v[68:69], v[8:9] op_sel_hi:[1,0]
    v_pk_add_f32 v[70:71], v[70:71], v[8:9] op_sel_hi:[1,0]
    v_pk_add_f32 v[72:73], v[72:73], v[8:9] op_sel_hi:[1,0]
    v_pk_add_f32 v[74:75], v[74:75], v[8:9] op_sel_hi:[1,0]
    v_pk_add_f32 v[76:77], v[76:77], v[8:9] op_sel_hi:[1,0]
    v_pk_add_f32 v[78:79], v[78:79], v[8:9] op_sel_hi:[1,0]
    v_pk_add_f32 v[96:97], v[6:7], v[8:9] op_sel_hi:[0,0]
    v_pk_add_f32 v[98:99], v[6:7], v[8:9] op_sel_hi:[0,0]
    v_pk_add_f32 v[100:101], v[6:7], v[8:9] op_sel_hi:[0,0]
    v_pk_add_f32 v[102:103], v[6:7], v[8:9] op_sel_hi:[0,0]
    v_pk_add_f32 v[104:105], v[6:7], v[8:9] op_sel_hi:[0,0]
    v_pk_add_f32 v[106:107], v[6:7], v[8:9] op_sel_hi:[0,0]
    v_pk_add_f32 v[108:109], v[6:7], v[8:9] op_sel_hi:[0,0]
    v_pk_add_f32 v[110:111], v[6:7], v[8:9] op_sel_hi:[0,0]
    v_exp_f32 v64, v64
    v_exp_f32 v65, v65
    v_exp_f32 v66, v66
    v_exp_f32 v67, v67
    v_exp_f32 v68, v68
    v_exp_f32 v69, v69
    v_exp_f32 v70, v70
    v_exp_f32 v71, v71
    v_cvt_pk_bf16_f32 v24, v64, v65
    v_cvt_pk_bf16_f32 v25, v66, v67
    v_cvt_pk_bf16_f32 v26, v68, v69
    v_cvt_pk_bf16_f32 v27, v70, v71
    v_exp_f32 v72, v72
    v_exp_f32 v73, v73
    v_exp_f32 v74, v74
    v_exp_f32 v75, v75
    v_mfma_f32_32x32x16_bf16 v[144:159], v[32:35], v[24:27], 0
    v_exp_f32 v76, v76
    v_exp_f32 v77, v77
    v_exp_f32 v78, v78
    v_exp_f32 v79, v79
    v_mfma_f32_16x16x32_bf16 v[176:179], v[40:43], v[24:27], 0
    v_cvt_pk_bf16_f32 v28, v72, v73
    v_cvt_pk_bf16_f32 v29, v74, v75
    v_cvt_pk_bf16_f32 v30, v76, v77
    v_cvt_pk_bf16_f32 v31, v78, v79
    s_nop 1
    v_mfma_f32_32x32x16_bf16 v[144:159], v[36:39], v[28:31], v[144:159]
    v_mfma_f32_16x16x32_bf16 v[176:179], v[40:43], v[28:31], v[176:179]
    s_waitcnt vmcnt(0)
    s_mov_b64 exec, 1
    v_cmp_le_u32 vcc, s46, v15
    s_nop 1
    s_cmp_eq_u64 vcc, exec
    s_cbranch_scc1 POLL2D
    s_mov_b32 s59, 262144
    s_nop 2
POLL2:
    v_mov_b32 v15, 0
    buffer_atomic_add v15, v6, s[8:11], s23 offen offset:0 sc0 sc1
    s_waitcnt vmcnt(0)
    v_cmp_le_u32 vcc, s46, v15
    s_nop 1
    s_cmp_eq_u64 vcc, exec
    s_cbranch_scc1 POLL2D
    s_sub_u32 s59, s59, 1
    s_cbranch_scc0 POLL2
POLL2D:
    s_mov_b64 exec, -1
    s_cmp_eq_u32 s46, 0
    s_cbranch_scc1 NOKV
    s_add_u32 m0, s17, 98304
    s_add_u32 s19, s48, 0
    buffer_load_dwordx4 v1, s[8:11], s19 offen offset:0 sc1 lds
    buffer_load_dwordx4 v1, s[8:11], s19 offen offset:1024 sc1 lds
    buffer_load_dwordx4 v1, s[8:11], s19 offen offset:2048 sc1 lds
    buffer_load_dwordx4 v1, s[8:11], s19 offen offset:3072 sc1 lds
    s_add_u32 m0, s17, 102400
    s_add_u32 s19, s48, 4096
    buffer_load_dwordx4 v1, s[8:11], s19 offen offset:0 sc1 lds
    buffer_load_dwordx4 v1, s[8:11], s19 offen offset:1024 sc1 lds
    buffer_load_dwordx4 v1, s[8:11], s19 offen offset:2048 sc1 lds
    buffer_load_dwordx4 v1, s[8:11], s19 offen offset:3072 sc1 lds
NOKV:
    s_cmp_lg_u32 s16, 0
    s_cbranch_scc1 NOSIG0
    s_mul_i32 s35, s21, 4352
    s_add_u32 s35, s35, 53682688
    s_mov_b64 exec, 1
    buffer_atomic_add v7, v6, s[8:11], s36 offen offset:0 sc1
    s_mov_b64 exec, -1
    s_mov_b64 exec, 1
    buffer_atomic_add v7, v6, s[8:11], s35 offen offset:0 sc1
    s_mov_b64 exec, -1
NOSIG0:
    v_bfe_u32 v13, v1, 8, 1
    v_lshlrev_b32 v13, 6, v13
    v_and_b32 v11, 0x70, v1
    v_xor_b32 v13, v13, v11
    v_lshrrev_b32 v11, 7, v1
    v_lshl_add_u32 v13, v11, 10, v13
    v_max_f32 v8, v80, v81
    v_max3_f32 v8, v82, v83, v8
    v_max3_f32 v8, v84, v85, v8
    v_max3_f32 v8, v86, v87, v8
    v_max3_f32 v8, v88, v89, v8
    v_max3_f32 v8, v90, v91, v8
    v_max3_f32 v8, v92, v93, v8
    v_max3_f32 v8, v94, v95, v8
    v_mov_b32 v10, v8
    s_nop 1
    v_permlane32_swap_b32 v8, v10
    v_max_f32 v8, v8, v10
    v_sub_f32 v8, 0, v8
    v_pk_add_f32 v[80:81], v[80:81], v[8:9] op_sel_hi:[1,0]
    v_pk_add_f32 v[82:83], v[82:83], v[8:9] op_sel_hi:[1,0]
    v_pk_add_f32 v[84:85], v[84:85], v[8:9] op_sel_hi:[1,0]
    v_pk_add_f32 v[86:87], v[86:87], v[8:9] op_sel_hi:[1,0]
    v_pk_add_f32 v[88:89], v[88:89], v[8:9] op_sel_hi:[1,0]
    v_pk_add_f32 v[90:91], v[90:91], v[8:9] op_sel_hi:[1,0]
    v_pk_add_f32 v[92:93], v[92:93], v[8:9] op_sel_hi:[1,0]
    v_pk_add_f32 v[94:95], v[94:95], v[8:9] op_sel_hi:[1,0]
    v_pk_add_f32 v[112:113], v[6:7], v[8:9] op_sel_hi:[0,0]
    v_pk_add_f32 v[114:115], v[6:7], v[8:9] op_sel_hi:[0,0]
    v_pk_add_f32 v[116:117], v[6:7], v[8:9] op_sel_hi:[0,0]
    v_pk_add_f32 v[118:119], v[6:7], v[8:9] op_sel_hi:[0,0]
    v_pk_add_f32 v[120:121], v[6:7], v[8:9] op_sel_hi:[0,0]
    v_pk_add_f32 v[122:123], v[6:7], v[8:9] op_sel_hi:[0,0]
    v_pk_add_f32 v[124:125], v[6:7], v[8:9] op_sel_hi:[0,0]
    v_pk_add_f32 v[126:127], v[6:7], v[8:9] op_sel_hi:[0,0]
    v_exp_f32 v80, v80
    v_exp_f32 v81, v81
    v_exp_f32 v82, v82
    v_exp_f32 v83, v83
    v_exp_f32 v84, v84
    v_exp_f32 v85, v85
    v_exp_f32 v86, v86
    v_exp_f32 v87, v87
    v_cvt_pk_bf16_f32 v24, v80, v81
    v_cvt_pk_bf16_f32 v25, v82, v83
    v_cvt_pk_bf16_f32 v26, v84, v85
    v_cvt_pk_bf16_f32 v27, v86, v87
    v_exp_f32 v88, v88
    v_exp_f32 v89, v89
    v_exp_f32 v90, v90
    v_exp_f32 v91, v91
    v_mfma_f32_32x32x16_bf16 v[160:175], v[32:35], v[24:27], 0
    v_exp_f32 v92, v92
    v_exp_f32 v93, v93
    v_exp_f32 v94, v94
    v_exp_f32 v95, v95
    v_mfma_f32_16x16x32_bf16 v[184:187], v[40:43], v[24:27], 0
    v_cvt_pk_bf16_f32 v28, v88, v89
    v_cvt_pk_bf16_f32 v29, v90, v91
    v_cvt_pk_bf16_f32 v30, v92, v93
    v_cvt_pk_bf16_f32 v31, v94, v95
    s_nop 1
    v_mfma_f32_32x32x16_bf16 v[160:175], v[36:39], v[28:31], v[160:175]
    v_mfma_f32_16x16x32_bf16 v[184:187], v[40:43], v[28:31], v[184:187]
    v_pk_add_f32 v[128:129], v[208:209], v[96:97]
    v_pk_add_f32 v[130:131], v[210:211], v[98:99]
    v_pk_add_f32 v[132:133], v[212:213], v[100:101]
    v_pk_add_f32 v[134:135], v[214:215], v[102:103]
    v_pk_add_f32 v[136:137], v[216:217], v[104:105]
    v_pk_add_f32 v[138:139], v[218:219], v[106:107]
    v_pk_add_f32 v[140:141], v[220:221], v[108:109]
    v_pk_add_f32 v[142:143], v[222:223], v[110:111]
    s_cmp_lg_u32 s16, 0
    s_cbranch_scc1 KVW
    s_waitcnt vmcnt(2) lgkmcnt(0)
    s_branch KVB
KVW:
    s_waitcnt vmcnt(0) lgkmcnt(0)
KVB:
    s_barrier
    s_cmp_lt_u32 s38, 8
    s_cbranch_scc1 P2A_E2
    ds_read_b128 a[224:227], v14 offset:0
    ds_read_b128 a[228:231], v14 offset:4096
    ds_read_b128 a[232:235], v14 offset:2048
    ds_read_b128 a[236:239], v14 offset:3072
    s_waitcnt lgkmcnt(3)
    v_mfma_f32_32x32x16_bf16 v[64:79], a[224:227], v[48:51], v[128:143]
P2A_B2_8:
    s_waitcnt lgkmcnt(2)
    v_mfma_f32_32x32x16_bf16 v[80:95], a[228:231], v[48:51], v[96:111]
    ds_read_b128 a[224:227], v14 offset:8192
    ds_read_b128 a[240:243], v14 offset:6144
    ds_read_b128 a[244:247], v14 offset:7168
    s_nop 6
    v_exp_f32 v64, v64
    v_exp_f32 v65, v65
    v_exp_f32 v66, v66
    v_exp_f32 v67, v67
    s_add_u32 m0, s49, 0
    s_add_u32 s19, s43, 0
    buffer_load_dwordx4 v13, s[96:99], s19 offen lds
    v_exp_f32 v68, v68
    v_exp_f32 v69, v69
    v_exp_f32 v70, v70
    v_exp_f32 v71, v71
    v_cvt_pk_bf16_f32 v24, v64, v65
    v_cvt_pk_bf16_f32 v25, v66, v67
    v_cvt_pk_bf16_f32 v26, v68, v69
    v_cvt_pk_bf16_f32 v27, v70, v71
    s_add_u32 m0, s49, 1024
    s_add_u32 s19, s43, 8192
    buffer_load_dwordx4 v13, s[96:99], s19 offen lds
    v_exp_f32 v72, v72
    v_exp_f32 v73, v73
    v_exp_f32 v74, v74
    v_exp_f32 v75, v75
    s_waitcnt lgkmcnt(3)
    v_mfma_f32_32x32x16_bf16 v[144:159], a[232:235], v[24:27], v[144:159]
    v_exp_f32 v76, v76
    v_exp_f32 v77, v77
    v_exp_f32 v78, v78
    v_exp_f32 v79, v79
    v_mfma_f32_16x16x32_bf16 v[176:179], v[40:43], v[24:27], v[176:179]
    v_cvt_pk_bf16_f32 v28, v72, v73
    v_cvt_pk_bf16_f32 v29, v74, v75
    v_cvt_pk_bf16_f32 v30, v76, v77
    v_cvt_pk_bf16_f32 v31, v78, v79
P2A_B2_7:
    s_waitcnt lgkmcnt(2)
    v_mfma_f32_32x32x16_bf16 v[64:79], a[224:227], v[48:51], v[96:111]
    ds_read_b128 a[228:231], v14 offset:12288
    ds_read_b128 a[248:251], v14 offset:10240
    ds_read_b128 a[252:255], v14 offset:11264
    v_exp_f32 v80, v80
    v_exp_f32 v81, v81
    v_exp_f32 v82, v82
    v_exp_f32 v83, v83
    v_mfma_f32_32x32x16_bf16 v[144:159], a[236:239], v[28:31], v[144:159]
    s_add_u32 m0, s49, 2048
    s_add_u32 s19, s43, 16384
    buffer_load_dwordx4 v13, s[96:99], s19 offen lds
    v_exp_f32 v84, v84
    v_exp_f32 v85, v85
    v_exp_f32 v86, v86
    v_exp_f32 v87, v87
    v_mfma_f32_16x16x32_bf16 v[176:179], v[40:43], v[28:31], v[176:179]
    v_cvt_pk_bf16_f32 v24, v80, v81
    v_cvt_pk_bf16_f32 v25, v82, v83
    v_cvt_pk_bf16_f32 v26, v84, v85
    v_cvt_pk_bf16_f32 v27, v86, v87
    s_add_u32 m0, s49, 3072
    s_add_u32 s19, s43, 24576
    buffer_load_dwordx4 v13, s[96:99], s19 offen lds
    v_exp_f32 v88, v88
    v_exp_f32 v89, v89
    v_exp_f32 v90, v90
    v_exp_f32 v91, v91
    s_waitcnt lgkmcnt(3)
    v_mfma_f32_32x32x16_bf16 v[144:159], a[240:243], v[24:27], v[144:159]
    v_exp_f32 v92, v92
    v_exp_f32 v93, v93
    v_exp_f32 v94, v94
    v_exp_f32 v95, v95
    v_mfma_f32_16x16x32_bf16 v[176:179], v[40:43], v[24:27], v[176:179]
    v_cvt_pk_bf16_f32 v28, v88, v89
    v_cvt_pk_bf16_f32 v29, v90, v91
    v_cvt_pk_bf16_f32 v30, v92, v93
    v_cvt_pk_bf16_f32 v31, v94, v95
P2A_B2_6:
    s_waitcnt lgkmcnt(2)
    v_mfma_f32_32x32x16_bf16 v[80:95], a[228:231], v[48:51], v[96:111]
    ds_read_b128 a[224:227], v14 offset:16384
    ds_read_b128 a[232:235], v14 offset:14336
    ds_read_b128 a[236:239], v14 offset:15360
    v_exp_f32 v64, v64
    v_exp_f32 v65, v65
    v_exp_f32 v66, v66
    v_exp_f32 v67, v67
    v_mfma_f32_32x32x16_bf16 v[144:159], a[244:247], v[28:31], v[144:159]
    s_add_u32 m0, s49, 4096
    s_add_u32 s19, s43, 32768
    buffer_load_dwordx4 v13, s[96:99], s19 offen lds
    v_exp_f32 v68, v68
    v_exp_f32 v69, v69
    v_exp_f32 v70, v70
    v_exp_f32 v71, v71
    v_mfma_f32_16x16x32_bf16 v[176:179], v[40:43], v[28:31], v[176:179]
    v_cvt_pk_bf16_f32 v24, v64, v65
    v_cvt_pk_bf16_f32 v25, v66, v67
    v_cvt_pk_bf16_f32 v26, v68, v69
    v_cvt_pk_bf16_f32 v27, v70, v71
    s_add_u32 m0, s49, 5120
    s_add_u32 s19, s43, 40960
    buffer_load_dwordx4 v13, s[96:99], s19 offen lds
    v_exp_f32 v72, v72
    v_exp_f32 v73, v73
    v_exp_f32 v74, v74
    v_exp_f32 v75, v75
    s_waitcnt lgkmcnt(3)
    v_mfma_f32_32x32x16_bf16 v[144:159], a[248:251], v[24:27], v[144:159]
    v_exp_f32 v76, v76
    v_exp_f32 v77, v77
    v_exp_f32 v78, v78
    v_exp_f32 v79, v79
    v_mfma_f32_16x16x32_bf16 v[176:179], v[40:43], v[24:27], v[176:179]
    v_cvt_pk_bf16_f32 v28, v72, v73
    v_cvt_pk_bf16_f32 v29, v74, v75
    v_cvt_pk_bf16_f32 v30, v76, v77
    v_cvt_pk_bf16_f32 v31, v78, v79
P2A_B2_5:
    s_waitcnt lgkmcnt(2)
    v_mfma_f32_32x32x16_bf16 v[64:79], a[224:227], v[48:51], v[96:111]
    ds_read_b128 a[228:231], v14 offset:20480
    ds_read_b128 a[240:243], v14 offset:18432
    ds_read_b128 a[244:247], v14 offset:19456
    v_exp_f32 v80, v80
    v_exp_f32 v81, v81
    v_exp_f32 v82, v82
    v_exp_f32 v83, v83
    v_mfma_f32_32x32x16_bf16 v[144:159], a[252:255], v[28:31], v[144:159]
    s_add_u32 m0, s49, 6144
    s_add_u32 s19, s43, 49152
    buffer_load_dwordx4 v13, s[96:99], s19 offen lds
    v_exp_f32 v84, v84
    v_exp_f32 v85, v85
    v_exp_f32 v86, v86
    v_exp_f32 v87, v87
    v_mfma_f32_16x16x32_bf16 v[176:179], v[40:43], v[28:31], v[176:179]
    v_cvt_pk_bf16_f32 v24, v80, v81
    v_cvt_pk_bf16_f32 v25, v82, v83
    v_cvt_pk_bf16_f32 v26, v84, v85
    v_cvt_pk_bf16_f32 v27, v86, v87
    s_add_u32 m0, s49, 7168
    s_add_u32 s19, s43, 57344
    buffer_load_dwordx4 v13, s[96:99], s19 offen lds
    v_exp_f32 v88, v88
    v_exp_f32 v89, v89
    v_exp_f32 v90, v90
    v_exp_f32 v91, v91
    s_waitcnt lgkmcnt(3)
    v_mfma_f32_32x32x16_bf16 v[144:159], a[232:235], v[24:27], v[144:159]
    v_exp_f32 v92, v92
    v_exp_f32 v93, v93
    v_exp_f32 v94, v94
    v_exp_f32 v95, v95
    v_mfma_f32_16x16x32_bf16 v[176:179], v[40:43], v[24:27], v[176:179]
    v_cvt_pk_bf16_f32 v28, v88, v89
    v_cvt_pk_bf16_f32 v29, v90, v91
    v_cvt_pk_bf16_f32 v30, v92, v93
    v_cvt_pk_bf16_f32 v31, v94, v95
P2A_B2_4:
    s_waitcnt lgkmcnt(2)
    v_mfma_f32_32x32x16_bf16 v[80:95], a[228:231], v[48:51], v[96:111]
    ds_read_b128 a[224:227], v14 offset:24576
    ds_read_b128 a[248:251], v14 offset:22528
    ds_read_b128 a[252:255], v14 offset:23552
    v_exp_f32 v64, v64
    v_exp_f32 v65, v65
    v_exp_f32 v66, v66
    v_exp_f32 v67, v67
    v_mfma_f32_32x32x16_bf16 v[144:159], a[236:239], v[28:31], v[144:159]
    s_add_u32 m0, s49, 8192
    s_add_u32 s19, s43, 65536
    buffer_load_dwordx4 v13, s[96:99], s19 offen lds
    v_exp_f32 v68, v68
    v_exp_f32 v69, v69
    v_exp_f32 v70, v70
    v_exp_f32 v71, v71
    v_mfma_f32_16x16x32_bf16 v[176:179], v[40:43], v[28:31], v[176:179]
    v_cvt_pk_bf16_f32 v24, v64, v65
    v_cvt_pk_bf16_f32 v25, v66, v67
    v_cvt_pk_bf16_f32 v26, v68, v69
    v_cvt_pk_bf16_f32 v27, v70, v71
    s_add_u32 m0, s49, 9216
    s_add_u32 s19, s43, 73728
    buffer_load_dwordx4 v13, s[96:99], s19 offen lds
    v_exp_f32 v72, v72
    v_exp_f32 v73, v73
    v_exp_f32 v74, v74
    v_exp_f32 v75, v75
    s_waitcnt lgkmcnt(3)
    v_mfma_f32_32x32x16_bf16 v[144:159], a[240:243], v[24:27], v[144:159]
    v_exp_f32 v76, v76
    v_exp_f32 v77, v77
    v_exp_f32 v78, v78
    v_exp_f32 v79, v79
    v_mfma_f32_16x16x32_bf16 v[176:179], v[40:43], v[24:27], v[176:179]
    v_cvt_pk_bf16_f32 v28, v72, v73
    v_cvt_pk_bf16_f32 v29, v74, v75
    v_cvt_pk_bf16_f32 v30, v76, v77
    v_cvt_pk_bf16_f32 v31, v78, v79
    v_add_f32 v128, v208, v112
    v_add_f32 v129, v209, v113
    v_add_f32 v130, v210, v114
    v_add_f32 v131, v211, v115
    v_add_f32 v132, v212, v116
    v_add_f32 v133, v213, v117
    v_add_f32 v134, v214, v118
    v_add_f32 v135, v215, v119
P2A_B2_3:
    s_waitcnt lgkmcnt(2)
    v_mfma_f32_32x32x16_bf16 v[64:79], a[224:227], v[48:51], v[96:111]
    ds_read_b128 a[228:231], v14 offset:28672
    ds_read_b128 a[232:235], v14 offset:26624
    ds_read_b128 a[236:239], v14 offset:27648
    v_exp_f32 v80, v80
    v_exp_f32 v81, v81
    v_exp_f32 v82, v82
    v_exp_f32 v83, v83
    v_mfma_f32_32x32x16_bf16 v[144:159], a[244:247], v[28:31], v[144:159]
    s_add_u32 m0, s49, 10240
    s_add_u32 s19, s43, 81920
    buffer_load_dwordx4 v13, s[96:99], s19 offen lds
    v_exp_f32 v84, v84
    v_exp_f32 v85, v85
    v_exp_f32 v86, v86
    v_exp_f32 v87, v87
    v_mfma_f32_16x16x32_bf16 v[176:179], v[40:43], v[28:31], v[176:179]
    v_cvt_pk_bf16_f32 v24, v80, v81
    v_cvt_pk_bf16_f32 v25, v82, v83
    v_cvt_pk_bf16_f32 v26, v84, v85
    v_cvt_pk_bf16_f32 v27, v86, v87
    s_add_u32 m0, s49, 11264
    s_add_u32 s19, s43, 90112
    buffer_load_dwordx4 v13, s[96:99], s19 offen lds
    v_exp_f32 v88, v88
    v_exp_f32 v89, v89
    v_exp_f32 v90, v90
    v_exp_f32 v91, v91
    s_waitcnt lgkmcnt(3)
    v_mfma_f32_32x32x16_bf16 v[144:159], a[248:251], v[24:27], v[144:159]
    v_exp_f32 v92, v92
    v_exp_f32 v93, v93
    v_exp_f32 v94, v94
    v_exp_f32 v95, v95
    v_mfma_f32_16x16x32_bf16 v[176:179], v[40:43], v[24:27], v[176:179]
    v_cvt_pk_bf16_f32 v28, v88, v89
    v_cvt_pk_bf16_f32 v29, v90, v91
    v_cvt_pk_bf16_f32 v30, v92, v93
    v_cvt_pk_bf16_f32 v31, v94, v95
    v_add_f32 v136, v216, v120
    v_add_f32 v137, v217, v121
    v_add_f32 v138, v218, v122
    v_add_f32 v139, v219, v123
    v_add_f32 v140, v220, v124
    v_add_f32 v141, v221, v125
    v_add_f32 v142, v222, v126
    v_add_f32 v143, v223, v127
P2A_B2_2:
    s_waitcnt lgkmcnt(2)
    v_mfma_f32_32x32x16_bf16 v[80:95], a[228:231], v[48:51], v[96:111]
    ds_read_b128 a[224:227], v14 offset:1024
    ds_read_b128 a[240:243], v14 offset:30720
    ds_read_b128 a[244:247], v14 offset:31744
    v_exp_f32 v64, v64
    v_exp_f32 v65, v65
    v_exp_f32 v66, v66
    v_exp_f32 v67, v67
    v_mfma_f32_32x32x16_bf16 v[144:159], a[252:255], v[28:31], v[144:159]
    s_add_u32 m0, s49, 12288
    s_add_u32 s19, s43, 98304
    buffer_load_dwordx4 v13, s[96:99], s19 offen lds
    v_exp_f32 v68, v68
    v_exp_f32 v69, v69
    v_exp_f32 v70, v70
    v_exp_f32 v71, v71
    v_mfma_f32_16x16x32_bf16 v[176:179], v[40:43], v[28:31], v[176:179]
    v_cvt_pk_bf16_f32 v24, v64, v65
    v_cvt_pk_bf16_f32 v25, v66, v67
    v_cvt_pk_bf16_f32 v26, v68, v69
    v_cvt_pk_bf16_f32 v27, v70, v71
    s_add_u32 m0, s49, 13312
    s_add_u32 s19, s43, 106496
    buffer_load_dwordx4 v13, s[96:99], s19 offen lds
    v_exp_f32 v72, v72
    v_exp_f32 v73, v73
    v_exp_f32 v74, v74
    v_exp_f32 v75, v75
    s_waitcnt lgkmcnt(3)
    v_mfma_f32_32x32x16_bf16 v[144:159], a[232:235], v[24:27], v[144:159]
    v_exp_f32 v76, v76
    v_exp_f32 v77, v77
    v_exp_f32 v78, v78
    v_exp_f32 v79, v79
    v_mfma_f32_16x16x32_bf16 v[176:179], v[40:43], v[24:27], v[176:179]
    v_cvt_pk_bf16_f32 v28, v72, v73
    v_cvt_pk_bf16_f32 v29, v74, v75
    v_cvt_pk_bf16_f32 v30, v76, v77
    v_cvt_pk_bf16_f32 v31, v78, v79
    s_or_b32 s34, s12, s16
    s_cbranch_scc1 WRI1
    s_add_u32 s34, s26, 786
    s_mul_i32 s34, s34, 4352
    v_mov_b32 v11, s34
    s_add_u32 s34, s27, 794
    s_mul_i32 s34, s34, 4352
    v_writelane_b32 v11, s34, 1
    s_add_u32 s34, s26, 808
    s_mul_i32 s34, s34, 4352
    v_writelane_b32 v11, s34, 2
    s_add_u32 s34, s21, 770
    s_mul_i32 s34, s34, 4352
    v_writelane_b32 v11, s34, 3
    v_mov_b32 v12, 16
    v_writelane_b32 v12, 32, 1
    v_writelane_b32 v12, 56, 2
    v_writelane_b32 v12, 64, 3
    s_mov_b32 s3, 50331648
    s_mov_b64 exec, 2
    v_mov_b32 v15, 0
    buffer_atomic_add v15, v11, s[8:11], s3 offen offset:0 sc0 sc1
    s_mov_b64 exec, -1
WRI1:
P2A_B2_1:
    s_waitcnt lgkmcnt(2)
    v_mfma_f32_32x32x16_bf16 v[64:79], a[224:227], v[52:55], v[128:143]
    ds_read_b128 a[228:231], v14 offset:5120
    ds_read_b128 a[248:251], v14 offset:2048
    ds_read_b128 a[252:255], v14 offset:3072
    v_exp_f32 v80, v80
    v_exp_f32 v81, v81
    v_exp_f32 v82, v82
    v_exp_f32 v83, v83
    v_mfma_f32_32x32x16_bf16 v[144:159], a[236:239], v[28:31], v[144:159]
    s_add_u32 m0, s49, 14336
    s_add_u32 s19, s43, 114688
    buffer_load_dwordx4 v13, s[96:99], s19 offen lds
    v_exp_f32 v84, v84
    v_exp_f32 v85, v85
    v_exp_f32 v86, v86
    v_exp_f32 v87, v87
    v_mfma_f32_16x16x32_bf16 v[176:179], v[40:43], v[28:31], v[176:179]
    v_cvt_pk_bf16_f32 v24, v80, v81
    v_cvt_pk_bf16_f32 v25, v82, v83
    v_cvt_pk_bf16_f32 v26, v84, v85
    v_cvt_pk_bf16_f32 v27, v86, v87
    s_add_u32 m0, s49, 15360
    s_add_u32 s19, s43, 122880
    buffer_load_dwordx4 v13, s[96:99], s19 offen lds
    v_exp_f32 v88, v88
    v_exp_f32 v89, v89
    v_exp_f32 v90, v90
    v_exp_f32 v91, v91
    s_waitcnt lgkmcnt(3)
    v_mfma_f32_32x32x16_bf16 v[144:159], a[240:243], v[24:27], v[144:159]
    v_exp_f32 v92, v92
    v_exp_f32 v93, v93
    v_exp_f32 v94, v94
    v_exp_f32 v95, v95
    v_mfma_f32_16x16x32_bf16 v[176:179], v[40:43], v[24:27], v[176:179]
    v_cvt_pk_bf16_f32 v28, v88, v89
    v_cvt_pk_bf16_f32 v29, v90, v91
    v_cvt_pk_bf16_f32 v30, v92, v93
    v_cvt_pk_bf16_f32 v31, v94, v95
    s_nop 1
    v_mfma_f32_16x16x32_bf16 v[176:179], v[40:43], v[28:31], v[176:179]
    v_mfma_f32_32x32x16_bf16 v[144:159], a[244:247], v[28:31], v[144:159]
P2A_FIN:
    s_nop 6
    v_mov_b32 v9, v176
    v_cmp_nge_f32 vcc, 0x5d800000, v9
    s_nop 1
    s_cmp_lg_u64 vcc, 0
    s_cbranch_scc1 P2A_SLOW
P2A_OUT:
    v_rcp_f32 v8, v9
    s_nop 0
    v_pk_mul_f32 v[144:145], v[144:145], v[8:9] op_sel_hi:[1,0]
    v_pk_mul_f32 v[146:147], v[146:147], v[8:9] op_sel_hi:[1,0]
    v_pk_mul_f32 v[148:149], v[148:149], v[8:9] op_sel_hi:[1,0]
    v_pk_mul_f32 v[150:151], v[150:151], v[8:9] op_sel_hi:[1,0]
    v_cvt_pk_bf16_f32 v56, v144, v145
    v_cvt_pk_bf16_f32 v57, v146, v147
    v_cvt_pk_bf16_f32 v58, v148, v149
    v_cvt_pk_bf16_f32 v59, v150, v151
    buffer_store_dwordx4 v[56:59], v1, s[8:11], s45 offen offset:0 sc1
    s_cmp_lt_u32 s38, 8
    s_cbranch_scc1 P2B_E2
P2B_B2_8:
    s_waitcnt lgkmcnt(2)
    v_mfma_f32_32x32x16_bf16 v[80:95], a[228:231], v[52:55], v[112:127]
    ds_read_b128 a[224:227], v14 offset:9216
    ds_read_b128 a[232:235], v14 offset:6144
    ds_read_b128 a[236:239], v14 offset:7168
    v_exp_f32 v64, v64
    v_exp_f32 v65, v65
    v_exp_f32 v66, v66
    v_exp_f32 v67, v67
    v_exp_f32 v68, v68
    v_exp_f32 v69, v69
    v_exp_f32 v70, v70
    v_exp_f32 v71, v71
    v_cvt_pk_bf16_f32 v24, v64, v65
    v_cvt_pk_bf16_f32 v25, v66, v67
    v_cvt_pk_bf16_f32 v26, v68, v69
    v_cvt_pk_bf16_f32 v27, v70, v71
    v_exp_f32 v72, v72
    v_exp_f32 v73, v73
    v_exp_f32 v74, v74
    v_exp_f32 v75, v75
    s_waitcnt lgkmcnt(3)
    v_mfma_f32_32x32x16_bf16 v[160:175], a[248:251], v[24:27], v[160:175]
    v_exp_f32 v76, v76
    v_exp_f32 v77, v77
    v_exp_f32 v78, v78
    v_exp_f32 v79, v79
    v_mfma_f32_16x16x32_bf16 v[184:187], v[40:43], v[24:27], v[184:187]
    v_cvt_pk_bf16_f32 v28, v72, v73
    v_cvt_pk_bf16_f32 v29, v74, v75
    v_cvt_pk_bf16_f32 v30, v76, v77
    v_cvt_pk_bf16_f32 v31, v78, v79
    s_cmp_lg_u32 s16, 0
    s_cbranch_scc1 WRC2
    s_cmp_lg_u32 s12, 0
    s_cbranch_scc1 WRC2B
    s_waitcnt vmcnt(0)
    s_mov_b64 exec, 2
    v_cmp_le_u32 vcc, v12, v15
    s_nop 1
    s_cmp_eq_u64 vcc, exec
    s_cbranch_scc1 POLL3D
    s_mov_b32 s59, 262144
    s_nop 0
POLL3:
    v_mov_b32 v15, 0
    buffer_atomic_add v15, v11, s[8:11], s3 offen offset:0 sc0 sc1
    s_waitcnt vmcnt(0)
    v_cmp_le_u32 vcc, v12, v15
    s_nop 1
    s_cmp_eq_u64 vcc, exec
    s_cbranch_scc1 POLL3D
    s_sub_u32 s59, s59, 1
    s_cbranch_scc0 POLL3
POLL3D:
    s_mov_b64 exec, -1
WRC2B:
    s_barrier
WRC2:
    s_cmp_eq_u32 s16, 0
    s_cselect_b64 vcc, -1, 0
P2B_B2_7:
    s_waitcnt lgkmcnt(2)
    v_mfma_f32_32x32x16_bf16 v[64:79], a[224:227], v[52:55], v[112:127]
    ds_read_b128 a[228:231], v14 offset:13312
    ds_read_b128 a[240:243], v14 offset:10240
    ds_read_b128 a[244:247], v14 offset:11264
    v_exp_f32 v80, v80
    v_exp_f32 v81, v81
    v_exp_f32 v82, v82
    v_exp_f32 v83, v83
    v_mfma_f32_32x32x16_bf16 v[160:175], a[252:255], v[28:31], v[160:175]
    s_add_u32 m0, s17, 65536
    s_add_u32 s51, s30, 0
    buffer_load_dwordx4 v1, s[8:11], s51 offen offset:0 sc1 lds
    v_exp_f32 v84, v84
    v_exp_f32 v85, v85
    v_exp_f32 v86, v86
    v_exp_f32 v87, v87
    v_mfma_f32_16x16x32_bf16 v[184:187], v[40:43], v[28:31], v[184:187]
    v_cvt_pk_bf16_f32 v24, v80, v81
    v_cvt_pk_bf16_f32 v25, v82, v83
    v_cvt_pk_bf16_f32 v26, v84, v85
    v_cvt_pk_bf16_f32 v27, v86, v87
    buffer_load_dwordx4 v1, s[8:11], s51 offen offset:1024 sc1 lds
    v_exp_f32 v88, v88
    v_exp_f32 v89, v89
    v_exp_f32 v90, v90
    v_exp_f32 v91, v91
    s_waitcnt lgkmcnt(3)
    v_mfma_f32_32x32x16_bf16 v[160:175], a[232:235], v[24:27], v[160:175]
    s_add_u32 m0, s17, 67584
    s_add_u32 s51, s30, 2048
    buffer_load_dwordx4 v1, s[8:11], s51 offen offset:0 sc1 lds
    v_exp_f32 v92, v92
    v_exp_f32 v93, v93
    v_exp_f32 v94, v94
    v_exp_f32 v95, v95
    v_mfma_f32_16x16x32_bf16 v[184:187], v[40:43], v[24:27], v[184:187]
    v_cvt_pk_bf16_f32 v28, v88, v89
    v_cvt_pk_bf16_f32 v29, v90, v91
    v_cvt_pk_bf16_f32 v30, v92, v93
    v_cvt_pk_bf16_f32 v31, v94, v95
    buffer_load_dwordx4 v1, s[8:11], s51 offen offset:1024 sc1 lds
P2B_B2_6:
    s_waitcnt lgkmcnt(2)
    v_mfma_f32_32x32x16_bf16 v[80:95], a[228:231], v[52:55], v[112:127]
    ds_read_b128 a[224:227], v14 offset:17408
    ds_read_b128 a[248:251], v14 offset:14336
    ds_read_b128 a[252:255], v14 offset:15360
    v_exp_f32 v64, v64
    v_exp_f32 v65, v65
    v_exp_f32 v66, v66
    v_exp_f32 v67, v67
    v_mfma_f32_32x32x16_bf16 v[160:175], a[236:239], v[28:31], v[160:175]
    s_add_u32 m0, s17, 69632
    s_add_u32 s51, s30, 4096
    buffer_load_dwordx4 v1, s[8:11], s51 offen offset:0 sc1 lds
    v_exp_f32 v68, v68
    v_exp_f32 v69, v69
    v_exp_f32 v70, v70
    v_exp_f32 v71, v71
    v_mfma_f32_16x16x32_bf16 v[184:187], v[40:43], v[28:31], v[184:187]
    v_cvt_pk_bf16_f32 v24, v64, v65
    v_cvt_pk_bf16_f32 v25, v66, v67
    v_cvt_pk_bf16_f32 v26, v68, v69
    v_cvt_pk_bf16_f32 v27, v70, v71
    buffer_load_dwordx4 v1, s[8:11], s51 offen offset:1024 sc1 lds
    v_exp_f32 v72, v72
    v_exp_f32 v73, v73
    v_exp_f32 v74, v74
    v_exp_f32 v75, v75
    s_waitcnt lgkmcnt(3)
    v_mfma_f32_32x32x16_bf16 v[160:175], a[240:243], v[24:27], v[160:175]
    s_add_u32 m0, s17, 71680
    s_add_u32 s51, s30, 6144
    buffer_load_dwordx4 v1, s[8:11], s51 offen offset:0 sc1 lds
    v_exp_f32 v76, v76
    v_exp_f32 v77, v77
    v_exp_f32 v78, v78
    v_exp_f32 v79, v79
    v_mfma_f32_16x16x32_bf16 v[184:187], v[40:43], v[24:27], v[184:187]
    v_cvt_pk_bf16_f32 v28, v72, v73
    v_cvt_pk_bf16_f32 v29, v74, v75
    v_cvt_pk_bf16_f32 v30, v76, v77
    v_cvt_pk_bf16_f32 v31, v78, v79
    buffer_load_dwordx4 v1, s[8:11], s51 offen offset:1024 sc1 lds
P2B_B2_5:
    s_waitcnt lgkmcnt(2)
    v_mfma_f32_32x32x16_bf16 v[64:79], a[224:227], v[52:55], v[112:127]
    ds_read_b128 a[228:231], v14 offset:21504
    ds_read_b128 a[232:235], v14 offset:18432
    ds_read_b128 a[236:239], v14 offset:19456
    v_exp_f32 v80, v80
    v_exp_f32 v81, v81
    v_exp_f32 v82, v82
    v_exp_f32 v83, v83
    v_mfma_f32_32x32x16_bf16 v[160:175], a[244:247], v[28:31], v[160:175]
    s_lshl_b32 s19, s12, 10
    s_add_u32 m0, s19, 159744
    s_nop 0
    buffer_load_dwordx4 v1, s[8:11], s58 offen sc1 lds
    v_exp_f32 v84, v84
    v_exp_f32 v85, v85
    v_exp_f32 v86, v86
    v_exp_f32 v87, v87
    v_mfma_f32_16x16x32_bf16 v[184:187], v[40:43], v[28:31], v[184:187]
    v_cvt_pk_bf16_f32 v24, v80, v81
    v_cvt_pk_bf16_f32 v25, v82, v83
    v_cvt_pk_bf16_f32 v26, v84, v85
    v_cvt_pk_bf16_f32 v27, v86, v87
    v_exp_f32 v88, v88
    v_exp_f32 v89, v89
    v_exp_f32 v90, v90
    v_exp_f32 v91, v91
    s_waitcnt lgkmcnt(3)
    v_mfma_f32_32x32x16_bf16 v[160:175], a[248:251], v[24:27], v[160:175]
    v_exp_f32 v92, v92
    v_exp_f32 v93, v93
    v_exp_f32 v94, v94
    v_exp_f32 v95, v95
    v_mfma_f32_16x16x32_bf16 v[184:187], v[40:43], v[24:27], v[184:187]
    v_cvt_pk_bf16_f32 v28, v88, v89
    v_cvt_pk_bf16_f32 v29, v90, v91
    v_cvt_pk_bf16_f32 v30, v92, v93
    v_cvt_pk_bf16_f32 v31, v94, v95
P2B_B2_4:
    s_waitcnt lgkmcnt(2)
    v_mfma_f32_32x32x16_bf16 v[80:95], a[228:231], v[52:55], v[112:127]
    ds_read_b128 a[224:227], v14 offset:25600
    ds_read_b128 a[240:243], v14 offset:22528
    ds_read_b128 a[244:247], v14 offset:23552
    v_exp_f32 v64, v64
    v_exp_f32 v65, v65
    v_exp_f32 v66, v66
    v_exp_f32 v67, v67
    v_mfma_f32_32x32x16_bf16 v[160:175], a[252:255], v[28:31], v[160:175]
    v_exp_f32 v68, v68
    v_exp_f32 v69, v69
    v_exp_f32 v70, v70
    v_exp_f32 v71, v71
    v_mfma_f32_16x16x32_bf16 v[184:187], v[40:43], v[28:31], v[184:187]
    v_cvt_pk_bf16_f32 v24, v64, v65
    v_cvt_pk_bf16_f32 v25, v66, v67
    v_cvt_pk_bf16_f32 v26, v68, v69
    v_cvt_pk_bf16_f32 v27, v70, v71
    v_exp_f32 v72, v72
    v_exp_f32 v73, v73
    v_exp_f32 v74, v74
    v_exp_f32 v75, v75
    s_waitcnt lgkmcnt(3)
    v_mfma_f32_32x32x16_bf16 v[160:175], a[232:235], v[24:27], v[160:175]
    v_exp_f32 v76, v76
    v_exp_f32 v77, v77
    v_exp_f32 v78, v78
    v_exp_f32 v79, v79
    v_mfma_f32_16x16x32_bf16 v[184:187], v[40:43], v[24:27], v[184:187]
    v_cvt_pk_bf16_f32 v28, v72, v73
    v_cvt_pk_bf16_f32 v29, v74, v75
    v_cvt_pk_bf16_f32 v30, v76, v77
    v_cvt_pk_bf16_f32 v31, v78, v79
    s_waitcnt vmcnt(9)
    s_mov_b64 exec, 1
    buffer_atomic_add v7, v6, s[8:11], s40 offen offset:0 sc1
    s_mov_b64 exec, -1
    s_or_b32 s34, s12, s16
    s_cbranch_scc1 WRI3
    s_mov_b64 exec, 12
    v_mov_b32 v15, 0
    buffer_atomic_add v15, v11, s[8:11], s3 offen offset:0 sc0 sc1
    s_mov_b64 exec, -1
WRI3:
P2B_B2_3:
    s_waitcnt lgkmcnt(2)
    v_mfma_f32_32x32x16_bf16 v[64:79], a[224:227], v[52:55], v[112:127]
    ds_read_b128 a[228:231], v14 offset:29696
    ds_read_b128 a[248:251], v14 offset:26624
    ds_read_b128 a[252:255], v14 offset:27648
    v_exp_f32 v80, v80
    v_exp_f32 v81, v81
    v_exp_f32 v82, v82
    v_exp_f32 v83, v83
    v_mfma_f32_32x32x16_bf16 v[160:175], a[236:239], v[28:31], v[160:175]
    v_exp_f32 v84, v84
    v_exp_f32 v85, v85
    v_exp_f32 v86, v86
    v_exp_f32 v87, v87
    v_mfma_f32_16x16x32_bf16 v[184:187], v[40:43], v[28:31], v[184:187]
    v_cvt_pk_bf16_f32 v24, v80, v81
    v_cvt_pk_bf16_f32 v25, v82, v83
    v_cvt_pk_bf16_f32 v26, v84, v85
    v_cvt_pk_bf16_f32 v27, v86, v87
    v_exp_f32 v88, v88
    v_exp_f32 v89, v89
    v_exp_f32 v90, v90
    v_exp_f32 v91, v91
    s_waitcnt lgkmcnt(3)
    v_mfma_f32_32x32x16_bf16 v[160:175], a[240:243], v[24:27], v[160:175]
    v_exp_f32 v92, v92
    v_exp_f32 v93, v93
    v_exp_f32 v94, v94
    v_exp_f32 v95, v95
    v_mfma_f32_16x16x32_bf16 v[184:187], v[40:43], v[24:27], v[184:187]
    v_cvt_pk_bf16_f32 v28, v88, v89
    v_cvt_pk_bf16_f32 v29, v90, v91
    v_cvt_pk_bf16_f32 v30, v92, v93
    v_cvt_pk_bf16_f32 v31, v94, v95
P2B_B2_2:
    s_waitcnt lgkmcnt(2)
    v_mfma_f32_32x32x16_bf16 v[80:95], a[228:231], v[52:55], v[112:127]
    ds_read_b128 a[232:235], v14 offset:30720
    ds_read_b128 a[236:239], v14 offset:31744
    v_exp_f32 v64, v64
    v_exp_f32 v65, v65
    v_exp_f32 v66, v66
    v_exp_f32 v67, v67
    v_mfma_f32_32x32x16_bf16 v[160:175], a[244:247], v[28:31], v[160:175]
    v_exp_f32 v68, v68
    v_exp_f32 v69, v69
    v_exp_f32 v70, v70
    v_exp_f32 v71, v71
    v_mfma_f32_16x16x32_bf16 v[184:187], v[40:43], v[28:31], v[184:187]
    v_cvt_pk_bf16_f32 v24, v64, v65
    v_cvt_pk_bf16_f32 v25, v66, v67
    v_cvt_pk_bf16_f32 v26, v68, v69
    v_cvt_pk_bf16_f32 v27, v70, v71
    v_exp_f32 v72, v72
    v_exp_f32 v73, v73
    v_exp_f32 v74, v74
    v_exp_f32 v75, v75
    s_waitcnt lgkmcnt(2)
    v_mfma_f32_32x32x16_bf16 v[160:175], a[248:251], v[24:27], v[160:175]
    v_exp_f32 v76, v76
    v_exp_f32 v77, v77
    v_exp_f32 v78, v78
    v_exp_f32 v79, v79
    v_mfma_f32_16x16x32_bf16 v[184:187], v[40:43], v[24:27], v[184:187]
    v_cvt_pk_bf16_f32 v28, v72, v73
    v_cvt_pk_bf16_f32 v29, v74, v75
    v_cvt_pk_bf16_f32 v30, v76, v77
    v_cvt_pk_bf16_f32 v31, v78, v79
P2B_B2_1:
    v_exp_f32 v80, v80
    v_exp_f32 v81, v81
    v_exp_f32 v82, v82
    v_exp_f32 v83, v83
    v_mfma_f32_32x32x16_bf16 v[160:175], a[252:255], v[28:31], v[160:175]
    v_exp_f32 v84, v84
    v_exp_f32 v85, v85
    v_exp_f32 v86, v86
    v_exp_f32 v87, v87
    v_mfma_f32_16x16x32_bf16 v[184:187], v[40:43], v[28:31], v[184:187]
    v_cvt_pk_bf16_f32 v24, v80, v81
    v_cvt_pk_bf16_f32 v25, v82, v83
    v_cvt_pk_bf16_f32 v26, v84, v85
    v_cvt_pk_bf16_f32 v27, v86, v87
    v_exp_f32 v88, v88
    v_exp_f32 v89, v89
    v_exp_f32 v90, v90
    v_exp_f32 v91, v91
    s_waitcnt lgkmcnt(0)
    v_mfma_f32_32x32x16_bf16 v[160:175], a[232:235], v[24:27], v[160:175]
    v_exp_f32 v92, v92
    v_exp_f32 v93, v93
    v_exp_f32 v94, v94
    v_exp_f32 v95, v95
    v_mfma_f32_16x16x32_bf16 v[184:187], v[40:43], v[24:27], v[184:187]
    v_cvt_pk_bf16_f32 v28, v88, v89
    v_cvt_pk_bf16_f32 v29, v90, v91
    v_cvt_pk_bf16_f32 v30, v92, v93
    v_cvt_pk_bf16_f32 v31, v94, v95
    s_cmp_lg_u32 s16, 0
    s_cbranch_scc1 WRC4
    s_cmp_lg_u32 s12, 0
    s_cbranch_scc1 WRC4B
    s_waitcnt vmcnt(0)
    s_mov_b64 exec, 12
    v_cmp_le_u32 vcc, v12, v15
    s_nop 1
    s_cmp_eq_u64 vcc, exec
    s_cbranch_scc1 POLL4D
    s_mov_b32 s59, 262144
    s_nop 0
POLL4:
    v_mov_b32 v15, 0
    buffer_atomic_add v15, v11, s[8:11], s3 offen offset:0 sc0 sc1
    s_waitcnt vmcnt(0)
    v_cmp_le_u32 vcc, v12, v15
    s_nop 1
    s_cmp_eq_u64 vcc, exec
    s_cbranch_scc1 POLL4D
    s_sub_u32 s59, s59, 1
    s_cbranch_scc0 POLL4
POLL4D:
    s_mov_b64 exec, -1
WRC4B:
WRC4:
    v_mfma_f32_16x16x32_bf16 v[184:187], v[40:43], v[28:31], v[184:187]
    v_mfma_f32_32x32x16_bf16 v[160:175], a[236:239], v[28:31], v[160:175]
P2B_FIN:
    s_nop 6
    v_mov_b32 v9, v184
    v_cmp_nge_f32 vcc, 0x5d800000, v9
    s_nop 1
    s_cmp_lg_u64 vcc, 0
    s_cbranch_scc1 P2B_SLOW
P2B_OUT:
    v_rcp_f32 v8, v9
    s_nop 0
    v_pk_mul_f32 v[168:169], v[168:169], v[8:9] op_sel_hi:[1,0]
    v_pk_mul_f32 v[170:171], v[170:171], v[8:9] op_sel_hi:[1,0]
    v_pk_mul_f32 v[172:173], v[172:173], v[8:9] op_sel_hi:[1,0]
    v_pk_mul_f32 v[174:175], v[174:175], v[8:9] op_sel_hi:[1,0]
    v_cvt_pk_bf16_f32 v60, v168, v169
    v_cvt_pk_bf16_f32 v61, v170, v171
    v_cvt_pk_bf16_f32 v62, v172, v173
    v_cvt_pk_bf16_f32 v63, v174, v175
    buffer_store_dwordx4 v[60:63], v1, s[8:11], s45 offen offset:1024 sc1
    s_lshr_b32 s36, s12, 1
    s_lshl_b32 s34, s24, 1
    s_add_u32 s34, s34, s36
    s_mul_i32 s39, s34, 4352
    s_add_u32 s39, s39, 51454464
    s_mov_b64 exec, 1
    v_mov_b32 v15, 0
    buffer_atomic_add v15, v6, s[8:11], s39 offen offset:0 sc0 sc1
    s_mov_b64 exec, -1
    s_barrier
    s_lshl_b32 s34, s36, 14
    s_lshl_b32 s38, s24, 15
    s_add_u32 s38, s38, s34
    s_add_u32 s38, s38, s15
    s_add_u32 s38, s38, 8388608
    v_bfe_u32 v8, v1, 6, 2
    v_lshl_add_u32 v8, v5, 2, v8
    v_lshlrev_b32 v8, 7, v8
    v_bfe_u32 v9, v1, 7, 1
    v_lshl_add_u32 v8, v9, 6, v8
    v_bfe_u32 v9, v1, 8, 1
    v_lshl_add_u32 v8, v9, 5, v8
    v_bfe_u32 v9, v1, 4, 2
    v_lshl_add_u32 v8, v9, 3, v8
    s_mul_i32 s37, s36, 0x8040
    v_xor_b32 v8, s37, v8
    v_xor_b32 v9, 64, v8
    s_add_u32 s46, s16, 1
    s_lshl_b32 s45, s46, 4
    s_lshl_b32 s41, s46, 3
    s_lshl_b32 s46, s46, 2
    ds_read_b64_tr_b16 v[144:145], v8 offset:0
    ds_read_b64_tr_b16 v[146:147], v8 offset:1024
    ds_read_b64_tr_b16 v[148:149], v9 offset:0
    ds_read_b64_tr_b16 v[150:151], v9 offset:1024
    ds_read_b64_tr_b16 v[160:161], v8 offset:4096
    ds_read_b64_tr_b16 v[162:163], v8 offset:5120
    ds_read_b64_tr_b16 v[164:165], v9 offset:4096
    ds_read_b64_tr_b16 v[166:167], v9 offset:5120
    ds_read_b64_tr_b16 v[176:177], v8 offset:8192
    ds_read_b64_tr_b16 v[178:179], v8 offset:9216
    ds_read_b64_tr_b16 v[180:181], v9 offset:8192
    ds_read_b64_tr_b16 v[182:183], v9 offset:9216
    s_waitcnt lgkmcnt(6)
    ds_read_b64_tr_b16 v[192:193], v8 offset:12288
    ds_read_b64_tr_b16 v[194:195], v8 offset:13312
    ds_read_b64_tr_b16 v[196:197], v9 offset:12288
    ds_read_b64_tr_b16 v[198:199], v9 offset:13312
    ds_read_b64_tr_b16 v[208:209], v8 offset:16384
    ds_read_b64_tr_b16 v[210:211], v8 offset:17408
    ds_read_b64_tr_b16 v[212:213], v9 offset:16384
    ds_read_b64_tr_b16 v[214:215], v9 offset:17408
    s_waitcnt lgkmcnt(6)
    ds_read_b64_tr_b16 v[224:225], v8 offset:20480
    ds_read_b64_tr_b16 v[226:227], v8 offset:21504
    ds_read_b64_tr_b16 v[228:229], v9 offset:20480
    ds_read_b64_tr_b16 v[230:231], v9 offset:21504
    ds_read_b64_tr_b16 a[224:225], v8 offset:24576
    ds_read_b64_tr_b16 a[226:227], v8 offset:25600
    ds_read_b64_tr_b16 a[228:229], v9 offset:24576
    ds_read_b64_tr_b16 a[230:231], v9 offset:25600
    s_waitcnt lgkmcnt(6)
    ds_read_b64_tr_b16 a[240:241], v8 offset:28672
    ds_read_b64_tr_b16 a[242:243], v8 offset:29696
    ds_read_b64_tr_b16 a[244:245], v9 offset:28672
    ds_read_b64_tr_b16 a[246:247], v9 offset:29696
    s_waitcnt vmcnt(1)
    s_mov_b64 exec, 1
    buffer_atomic_add v7, v6, s[8:11], s40 offen offset:4 sc1
    s_mov_b64 exec, -1
    s_waitcnt vmcnt(1)
    s_mov_b64 exec, 1
    v_cmp_le_u32 vcc, s41, v15
    s_nop 1
    s_cmp_eq_u64 vcc, exec
    s_cbranch_scc1 POLL5D
    s_mov_b32 s59, 262144
    s_nop 0
POLL5:
    v_mov_b32 v15, 0
    buffer_atomic_add v15, v6, s[8:11], s39 offen offset:0 sc0 sc1
    s_waitcnt vmcnt(0)
    v_cmp_le_u32 vcc, s41, v15
    s_nop 1
    s_cmp_eq_u64 vcc, exec
    s_cbranch_scc1 POLL5D
    s_sub_u32 s59, s59, 1
    s_cbranch_scc0 POLL5
POLL5D:
    s_mov_b64 exec, -1
    s_add_u32 s19, s38, 0
    buffer_load_dwordx4 v[80:83], v1, s[8:11], s19 offen offset:0 sc1
    buffer_load_dwordx4 v[88:91], v1, s[8:11], s19 offen offset:2048 sc1
    s_add_u32 s19, s38, 4096
    buffer_load_dwordx4 v[96:99], v1, s[8:11], s19 offen offset:0 sc1
    buffer_load_dwordx4 v[104:107], v1, s[8:11], s19 offen offset:2048 sc1
    s_add_u32 s19, s38, 8192
    buffer_load_dwordx4 v[112:115], v1, s[8:11], s19 offen offset:0 sc1
    buffer_load_dwordx4 v[120:123], v1, s[8:11], s19 offen offset:2048 sc1
    s_add_u32 s19, s38, 12288
    buffer_load_dwordx4 v[128:131], v1, s[8:11], s19 offen offset:0 sc1
    buffer_load_dwordx4 v[136:139], v1, s[8:11], s19 offen offset:2048 sc1
    s_add_u32 m0, s17, 98304
    s_add_u32 s19, s30, 473088
    buffer_load_dwordx4 v1, s[8:11], s19 offen offset:0 sc1 lds
    buffer_load_dwordx4 v1, s[8:11], s19 offen offset:1024 sc1 lds
    s_add_u32 m0, s17, 100352
    s_add_u32 s19, s30, 475136
    buffer_load_dwordx4 v1, s[8:11], s19 offen offset:0 sc1 lds
    buffer_load_dwordx4 v1, s[8:11], s19 offen offset:1024 sc1 lds
    s_add_u32 m0, s17, 102400
    s_add_u32 s19, s30, 477184
    buffer_load_dwordx4 v1, s[8:11], s19 offen offset:0 sc1 lds
    buffer_load_dwordx4 v1, s[8:11], s19 offen offset:1024 sc1 lds
    s_add_u32 m0, s17, 104448
    s_add_u32 s19, s30, 479232
    buffer_load_dwordx4 v1, s[8:11], s19 offen offset:0 sc1 lds
    buffer_load_dwordx4 v1, s[8:11], s19 offen offset:1024 sc1 lds
    s_cmp_lg_u32 s16, 0
    s_cbranch_scc1 L0_1
    s_add_u32 s19, s31, 0
    buffer_load_dwordx4 a[0:3], v1, s[8:11], s19 offen sc1
    s_add_u32 s19, s44, 0
    buffer_load_dwordx4 a[4:7], v1, s[8:11], s19 offen sc1
    s_add_u32 s19, s31, 1024
    buffer_load_dwordx4 a[8:11], v1, s[8:11], s19 offen sc1
    s_add_u32 s19, s44, 1024
    buffer_load_dwordx4 a[12:15], v1, s[8:11], s19 offen sc1
    s_add_u32 s19, s31, 2048
    buffer_load_dwordx4 a[16:19], v1, s[8:11], s19 offen sc1
    s_add_u32 s19, s44, 2048
    buffer_load_dwordx4 a[20:23], v1, s[8:11], s19 offen sc1
L0_1:
    ds_read_b64_tr_b16 v[152:153], v8 offset:2048
    ds_read_b64_tr_b16 v[154:155], v8 offset:3072
    ds_read_b64_tr_b16 v[156:157], v9 offset:2048
    ds_read_b64_tr_b16 v[158:159], v9 offset:3072
    s_waitcnt lgkmcnt(6)
    ds_read_b64_tr_b16 v[168:169], v8 offset:6144
    ds_read_b64_tr_b16 v[170:171], v8 offset:7168
    ds_read_b64_tr_b16 v[172:173], v9 offset:6144
    ds_read_b64_tr_b16 v[174:175], v9 offset:7168
    ds_read_b64_tr_b16 v[184:185], v8 offset:10240
    ds_read_b64_tr_b16 v[186:187], v8 offset:11264
    ds_read_b64_tr_b16 v[188:189], v9 offset:10240
    ds_read_b64_tr_b16 v[190:191], v9 offset:11264
    s_waitcnt lgkmcnt(6)
    ds_read_b64_tr_b16 v[200:201], v8 offset:14336
    ds_read_b64_tr_b16 v[202:203], v8 offset:15360
    ds_read_b64_tr_b16 v[204:205], v9 offset:14336
    ds_read_b64_tr_b16 v[206:207], v9 offset:15360
    ds_read_b64_tr_b16 v[216:217], v8 offset:18432
    ds_read_b64_tr_b16 v[218:219], v8 offset:19456
    ds_read_b64_tr_b16 v[220:221], v9 offset:18432
    ds_read_b64_tr_b16 v[222:223], v9 offset:19456
    s_waitcnt lgkmcnt(6)
    ds_read_b64_tr_b16 v[232:233], v8 offset:22528
    ds_read_b64_tr_b16 v[234:235], v8 offset:23552
    ds_read_b64_tr_b16 v[236:237], v9 offset:22528
    ds_read_b64_tr_b16 v[238:239], v9 offset:23552
    ds_read_b64_tr_b16 a[232:233], v8 offset:26624
    ds_read_b64_tr_b16 a[234:235], v8 offset:27648
    ds_read_b64_tr_b16 a[236:237], v9 offset:26624
    ds_read_b64_tr_b16 a[238:239], v9 offset:27648
    s_waitcnt lgkmcnt(6)
    ds_read_b64_tr_b16 a[248:249], v8 offset:30720
    ds_read_b64_tr_b16 a[250:251], v8 offset:31744
    ds_read_b64_tr_b16 a[252:253], v9 offset:30720
    ds_read_b64_tr_b16 a[254:255], v9 offset:31744
    s_mov_b64 exec, 1
    v_mov_b32 v15, 0
    buffer_atomic_add v15, v6, s[8:11], s39 offen offset:4 sc0 sc1
    s_mov_b64 exec, -1
    s_xor_b32 s37, s12, 2
    s_lshl_b32 s37, s37, 12
    s_add_u32 s37, s37, 139264
    v_add_u32 v12, s37, v1
    s_lshl_b32 s37, s12, 12
    s_add_u32 s37, s37, 139264
    v_add_u32 v13, s37, v1
    s_add_u32 s43, s33, s15
    s_add_u32 s43, s43, 20447232
    s_lshl_b32 s34, s18, 1
    s_lshl_b32 s19, s12, 6
    s_add_u32 s34, s34, s19
    s_mul_i32 s23, s34, 4352
    s_add_u32 s23, s23, 52290048
    s_mul_i32 s35, s24, 4352
    s_add_u32 s35, s35, 52011520
    s_waitcnt vmcnt(16)
    v_mfma_f32_32x32x16_bf16 v[32:47], v[148:151], v[80:83], 0
    v_mfma_f32_32x32x16_bf16 v[16:31], v[144:147], v[80:83], v[240:255]
    s_waitcnt vmcnt(15)
    v_mfma_f32_32x32x16_bf16 v[32:47], v[164:167], v[88:91], v[32:47]
    v_mfma_f32_32x32x16_bf16 v[16:31], v[160:163], v[88:91], v[16:31]
    s_waitcnt vmcnt(14)
    v_mfma_f32_32x32x16_bf16 v[32:47], v[180:183], v[96:99], v[32:47]
    v_mfma_f32_32x32x16_bf16 v[16:31], v[176:179], v[96:99], v[16:31]
    s_waitcnt vmcnt(13)
    v_mfma_f32_32x32x16_bf16 v[32:47], v[196:199], v[104:107], v[32:47]
    v_mfma_f32_32x32x16_bf16 v[16:31], v[192:195], v[104:107], v[16:31]
    s_waitcnt vmcnt(12)
    v_mfma_f32_32x32x16_bf16 v[32:47], v[212:215], v[112:115], v[32:47]
    v_mfma_f32_32x32x16_bf16 v[16:31], v[208:211], v[112:115], v[16:31]
    s_waitcnt vmcnt(11)
    v_mfma_f32_32x32x16_bf16 v[32:47], v[228:231], v[120:123], v[32:47]
    v_mfma_f32_32x32x16_bf16 v[16:31], v[224:227], v[120:123], v[16:31]
    s_waitcnt vmcnt(10)
    v_mfma_f32_32x32x16_bf16 v[32:47], a[228:231], v[128:131], v[32:47]
    v_mfma_f32_32x32x16_bf16 v[16:31], a[224:227], v[128:131], v[16:31]
    s_waitcnt vmcnt(9)
    v_mfma_f32_32x32x16_bf16 v[32:47], a[244:247], v[136:139], v[32:47]
    v_mfma_f32_32x32x16_bf16 v[16:31], a[240:243], v[136:139], v[16:31]
    s_waitcnt vmcnt(0)
    s_mov_b64 exec, 1
    v_cmp_le_u32 vcc, s41, v15
    s_nop 1
    s_cmp_eq_u64 vcc, exec
    s_cbranch_scc1 POLL6D
    s_mov_b32 s59, 262144
    s_nop 3
POLL6:
    v_mov_b32 v15, 0
    buffer_atomic_add v15, v6, s[8:11], s39 offen offset:4 sc0 sc1
    s_waitcnt vmcnt(0)
    v_cmp_le_u32 vcc, s41, v15
    s_nop 1
    s_cmp_eq_u64 vcc, exec
    s_cbranch_scc1 POLL6D
    s_sub_u32 s59, s59, 1
    s_cbranch_scc0 POLL6
POLL6D:
    s_mov_b64 exec, -1
    s_add_u32 s19, s38, 0
    buffer_load_dwordx4 v[84:87], v1, s[8:11], s19 offen offset:1024 sc1
    buffer_load_dwordx4 v[92:95], v1, s[8:11], s19 offen offset:3072 sc1
    s_add_u32 s19, s38, 4096
    buffer_load_dwordx4 v[100:103], v1, s[8:11], s19 offen offset:1024 sc1
    buffer_load_dwordx4 v[108:111], v1, s[8:11], s19 offen offset:3072 sc1
    s_add_u32 s19, s38, 8192
    buffer_load_dwordx4 v[116:119], v1, s[8:11], s19 offen offset:1024 sc1
    buffer_load_dwordx4 v[124:127], v1, s[8:11], s19 offen offset:3072 sc1
    s_add_u32 s19, s38, 12288
    buffer_load_dwordx4 v[132:135], v1, s[8:11], s19 offen offset:1024 sc1
    buffer_load_dwordx4 v[140:143], v1, s[8:11], s19 offen offset:3072 sc1
    s_add_u32 s38, s32, s15
    s_add_u32 s38, s38, 10485760
    s_mul_i32 s39, s22, 4352
    s_add_u32 s39, s39, 52011520
    s_waitcnt lgkmcnt(0)
    s_waitcnt vmcnt(7)
    v_mfma_f32_32x32x16_bf16 v[32:47], v[156:159], v[84:87], v[32:47]
    v_mfma_f32_32x32x16_bf16 v[16:31], v[152:155], v[84:87], v[16:31]
    s_waitcnt vmcnt(6)
    v_mfma_f32_32x32x16_bf16 v[32:47], v[172:175], v[92:95], v[32:47]
    v_mfma_f32_32x32x16_bf16 v[16:31], v[168:171], v[92:95], v[16:31]
    s_waitcnt vmcnt(5)
    v_mfma_f32_32x32x16_bf16 v[32:47], v[188:191], v[100:103], v[32:47]
    v_mfma_f32_32x32x16_bf16 v[16:31], v[184:187], v[100:103], v[16:31]
    s_waitcnt vmcnt(4)
    v_mfma_f32_32x32x16_bf16 v[32:47], v[204:207], v[108:111], v[32:47]
    v_mfma_f32_32x32x16_bf16 v[16:31], v[200:203], v[108:111], v[16:31]
    s_waitcnt vmcnt(3)
    v_mfma_f32_32x32x16_bf16 v[32:47], v[220:223], v[116:119], v[32:47]
    v_mfma_f32_32x32x16_bf16 v[16:31], v[216:219], v[116:119], v[16:31]
    s_waitcnt vmcnt(2)
    v_mfma_f32_32x32x16_bf16 v[32:47], v[236:239], v[124:127], v[32:47]
    v_mfma_f32_32x32x16_bf16 v[16:31], v[232:235], v[124:127], v[16:31]
    s_waitcnt vmcnt(1)
    v_mfma_f32_32x32x16_bf16 v[32:47], a[236:239], v[132:135], v[32:47]
    v_mfma_f32_32x32x16_bf16 v[16:31], a[232:235], v[132:135], v[16:31]
    s_waitcnt vmcnt(0)
    v_mfma_f32_32x32x16_bf16 v[32:47], a[252:255], v[140:143], v[32:47]
    v_mfma_f32_32x32x16_bf16 v[16:31], a[248:251], v[140:143], v[16:31]
    s_nop 10
    ds_write_b128 v12, v[32:35] offset:0
    ds_write_b128 v12, v[36:39] offset:1024
    ds_write_b128 v12, v[40:43] offset:2048
    ds_write_b128 v12, v[44:47] offset:3072
    s_waitcnt lgkmcnt(0)
    s_barrier
    ds_read_b128 v[48:51], v13 offset:0
    ds_read_b128 v[52:55], v13 offset:1024
    ds_read_b128 v[56:59], v13 offset:2048
    ds_read_b128 v[60:63], v13 offset:3072
    v_lshlrev_b32 v14, 3, v4
    s_waitcnt lgkmcnt(3)
    v_pk_add_f32 v[240:241], v[16:17], v[48:49]
    v_pk_add_f32 v[242:243], v[18:19], v[50:51]
    v_cvt_pk_bf16_f32 v64, v240, v241
    v_cvt_pk_bf16_f32 v65, v242, v243
    v_pk_mul_f32 v[10:11], v[240:241], v[240:241]
    v_pk_fma_f32 v[10:11], v[242:243], v[242:243], v[10:11]
    v_pk_add_f32 v[8:9], v[240:241], v[242:243]
    s_waitcnt lgkmcnt(2)
    v_pk_add_f32 v[244:245], v[20:21], v[52:53]
    v_pk_add_f32 v[246:247], v[22:23], v[54:55]
    v_cvt_pk_bf16_f32 v66, v244, v245
    v_cvt_pk_bf16_f32 v67, v246, v247
    buffer_store_dwordx4 v[64:67], v1, s[8:11], s38 offen sc1
    v_pk_fma_f32 v[10:11], v[244:245], v[244:245], v[10:11]
    v_pk_add_f32 v[8:9], v[8:9], v[244:245]
    v_pk_fma_f32 v[10:11], v[246:247], v[246:247], v[10:11]
    v_pk_add_f32 v[8:9], v[8:9], v[246:247]
    s_waitcnt lgkmcnt(1)
    v_pk_add_f32 v[248:249], v[24:25], v[56:57]
    v_pk_add_f32 v[250:251], v[26:27], v[58:59]
    v_cvt_pk_bf16_f32 v68, v248, v249
    v_cvt_pk_bf16_f32 v69, v250, v251
    v_pk_fma_f32 v[10:11], v[248:249], v[248:249], v[10:11]
    v_pk_add_f32 v[8:9], v[8:9], v[248:249]
    v_pk_fma_f32 v[10:11], v[250:251], v[250:251], v[10:11]
    v_pk_add_f32 v[8:9], v[8:9], v[250:251]
    s_waitcnt lgkmcnt(0)
    v_pk_add_f32 v[252:253], v[28:29], v[60:61]
    v_pk_add_f32 v[254:255], v[30:31], v[62:63]
    v_cvt_pk_bf16_f32 v70, v252, v253
    v_cvt_pk_bf16_f32 v71, v254, v255
    v_pk_fma_f32 v[10:11], v[252:253], v[252:253], v[10:11]
    v_pk_add_f32 v[8:9], v[8:9], v[252:253]
    v_pk_fma_f32 v[10:11], v[254:255], v[254:255], v[10:11]
    v_pk_add_f32 v[8:9], v[8:9], v[254:255]
    v_add_f32 v8, v8, v9
    v_add_f32 v9, v10, v11
    v_mov_b32 v10, v8
    v_mov_b32 v11, v9
    buffer_store_dwordx4 v[68:71], v1, s[8:11], s38 offen offset:1024 sc1
    v_permlane32_swap_b32 v8, v10
    v_permlane32_swap_b32 v9, v11
    v_add_f32 v8, v8, v10
    v_add_f32 v9, v9, v11
    buffer_store_dwordx2 v[8:9], v14, s[8:11], s43 offen sc1
    s_add_u32 m0, s17, 0
    s_add_u32 s19, s30, 946176
    buffer_load_dwordx4 v1, s[8:11], s19 offen offset:0 sc1 lds
    buffer_load_dwordx4 v1, s[8:11], s19 offen offset:1024 sc1 lds
    s_add_u32 m0, s17, 2048
    s_add_u32 s19, s30, 948224
    buffer_load_dwordx4 v1, s[8:11], s19 offen offset:0 sc1 lds
    buffer_load_dwordx4 v1, s[8:11], s19 offen offset:1024 sc1 lds
    s_waitcnt vmcnt(4)
    s_mov_b64 exec, 1
    buffer_atomic_add v7, v6, s[8:11], s35 offen offset:0 sc1
    s_mov_b64 exec, -1
    s_add_u32 m0, s17, 4096
    s_add_u32 s19, s30, 950272
    buffer_load_dwordx4 v1, s[8:11], s19 offen offset:0 sc1 lds
    buffer_load_dwordx4 v1, s[8:11], s19 offen offset:1024 sc1 lds
    s_add_u32 m0, s17, 6144
    s_add_u32 s19, s30, 952320
    buffer_load_dwordx4 v1, s[8:11], s19 offen offset:0 sc1 lds
    buffer_load_dwordx4 v1, s[8:11], s19 offen offset:1024 sc1 lds
    s_cmp_lg_u32 s16, 0
    s_cbranch_scc1 L0_2
    s_add_u32 s19, s31, 3072
    buffer_load_dwordx4 a[24:27], v1, s[8:11], s19 offen sc1
    s_add_u32 s19, s44, 3072
    buffer_load_dwordx4 a[28:31], v1, s[8:11], s19 offen sc1
    s_add_u32 s19, s31, 4096
    buffer_load_dwordx4 a[32:35], v1, s[8:11], s19 offen sc1
    s_add_u32 s19, s44, 4096
    buffer_load_dwordx4 a[36:39], v1, s[8:11], s19 offen sc1
    s_add_u32 s19, s31, 5120
    buffer_load_dwordx4 a[40:43], v1, s[8:11], s19 offen sc1
    s_add_u32 s19, s44, 5120
    buffer_load_dwordx4 a[44:47], v1, s[8:11], s19 offen sc1
    s_add_u32 s19, s31, 6144
    buffer_load_dwordx4 a[48:51], v1, s[8:11], s19 offen sc1
    s_add_u32 s19, s44, 6144
    buffer_load_dwordx4 a[52:55], v1, s[8:11], s19 offen sc1
    s_add_u32 s19, s31, 28672
    buffer_load_dwordx4 a[56:59], v1, s[8:11], s19 offen sc1
    s_add_u32 s19, s44, 28672
    buffer_load_dwordx4 a[60:63], v1, s[8:11], s19 offen sc1
L0_2:
    s_mul_i32 s47, s24, 114688
    s_add_u32 s47, s47, s42
    s_add_u32 s47, s47, s15
    s_add_u32 s47, s47, 12582912
    s_xor_b32 s48, s24, 1
    s_mul_i32 s48, s48, 114688
    s_add_u32 s48, s48, s42
    s_add_u32 s48, s48, s15
    s_add_u32 s48, s48, 12582912
    s_lshl_b32 s49, s25, 6
    s_lshl_b32 s50, s46, 1
    s_mov_b32 s52, s100
    s_mov_b32 s53, s101
    s_movk_i32 s54, 1024
    s_mov_b32 s55, 0x00020000
    s_cmp_ge_u32 s14, 28
    s_cbranch_scc1 P4_SKIP
    s_mov_b64 exec, 1
    v_mov_b32 v15, 0
    buffer_atomic_add v15, v6, s[8:11], s39 offen offset:0 sc0 sc1
    s_mov_b64 exec, -1
    s_lshl_b32 s36, s22, 15
    s_add_u32 s36, s36, s15
    s_add_u32 s36, s36, 10485760
    s_lshl_b32 s37, s22, 12
    s_add_u32 s37, s37, s15
    s_add_u32 s37, s37, 20447232
    v_lshlrev_b32 v12, 3, v4
    v_lshl_add_u32 v12, v5, 11, v12
    s_mul_i32 s38, s22, 114688
    s_add_u32 s38, s38, s15
    s_add_u32 s38, s38, 12582912
    s_lshl_b32 s34, s27, 11
    s_add_u32 s38, s38, s34
    s_mul_i32 s34, s27, 19
    s_and_b32 s34, s34, 0xc0
    s_add_u32 s34, s34, s22
    s_mul_i32 s35, s34, 4352
    s_add_u32 s35, s35, 52290048
    s_bitcmp1_b32 0x408, s27
    s_cselect_b32 s62, 3, 1
    s_mov_b32 s63, 0
    v_lshlrev_b32 v13, 6, v0
    s_waitcnt vmcnt(0)
    s_mov_b64 exec, 1
    v_cmp_le_u32 vcc, s45, v15
    s_nop 1
    s_cmp_eq_u64 vcc, exec
    s_cbranch_scc1 POLL7D
    s_mov_b32 s59, 262144
    s_nop 0
POLL7:
    v_mov_b32 v15, 0
    buffer_atomic_add v15, v6, s[8:11], s39 offen offset:0 sc0 sc1
    s_waitcnt vmcnt(0)
    v_cmp_le_u32 vcc, s45, v15
    s_nop 1
    s_cmp_eq_u64 vcc, exec
    s_cbranch_scc1 POLL7D
    s_sub_u32 s59, s59, 1
    s_cbranch_scc0 POLL7
POLL7D:
    s_mov_b64 exec, -1
    buffer_load_dwordx4 v[80:83], v1, s[8:11], s36 offen offset:0 sc1
    buffer_load_dwordx4 v[84:87], v1, s[8:11], s36 offen offset:1024 sc1
    buffer_load_dwordx4 v[88:91], v1, s[8:11], s36 offen offset:2048 sc1
    buffer_load_dwordx4 v[92:95], v1, s[8:11], s36 offen offset:3072 sc1
    s_add_u32 s36, s36, 4096
    buffer_load_dwordx4 v[96:99], v1, s[8:11], s36 offen offset:0 sc1
    buffer_load_dwordx4 v[100:103], v1, s[8:11], s36 offen offset:1024 sc1
    buffer_load_dwordx4 v[104:107], v1, s[8:11], s36 offen offset:2048 sc1
    buffer_load_dwordx4 v[108:111], v1, s[8:11], s36 offen offset:3072 sc1
    s_add_u32 s36, s36, 4096
    buffer_load_dwordx4 v[112:115], v1, s[8:11], s36 offen offset:0 sc1
    buffer_load_dwordx4 v[116:119], v1, s[8:11], s36 offen offset:1024 sc1
    s_barrier
    ds_read_b128 a[224:227], v2 offset:0
    ds_read_b128 a[228:231], v2 offset:32768
    ds_read_b128 a[232:235], v1 offset:0
    ds_read_b128 a[236:239], v2 offset:1024
    ds_read_b128 a[240:243], v2 offset:33792
    ds_read_b128 a[244:247], v1 offset:1024
    s_cmp_eq_u32 s16, 0
    s_cselect_b64 vcc, -1, 0
    s_waitcnt vmcnt(9)
    s_waitcnt lgkmcnt(5)
    v_mfma_f32_32x32x16_bf16 v[16:31], a[224:227], v[80:83], 0
    ds_read_b128 a[248:251], v2 offset:2048
    buffer_load_dwordx4 v[120:123], v1, s[8:11], s36 offen offset:2048 sc1
    s_waitcnt lgkmcnt(5)
    v_mfma_f32_32x32x16_bf16 v[32:47], a[228:231], v[80:83], 0
    ds_read_b128 a[252:255], v2 offset:34816
    buffer_load_dwordx4 v[124:127], v1, s[8:11], s36 offen offset:3072 sc1
    s_add_u32 s36, s36, 4096
    s_waitcnt lgkmcnt(5)
    v_mfma_f32_32x32x16_bf16 v[48:63], a[232:235], v[80:83], 0
    ds_read_b128 a[224:227], v2 offset:3072
    buffer_load_dwordx4 v[128:131], v1, s[8:11], s36 offen offset:0 sc1
    s_waitcnt vmcnt(11)
    s_waitcnt lgkmcnt(5)
    v_mfma_f32_32x32x16_bf16 v[16:31], a[236:239], v[84:87], v[16:31]
    ds_read_b128 a[228:231], v2 offset:35840
    buffer_load_dwordx4 v[132:135], v1, s[8:11], s36 offen offset:1024 sc1
    s_waitcnt lgkmcnt(5)
    v_mfma_f32_32x32x16_bf16 v[32:47], a[240:243], v[84:87], v[32:47]
    ds_read_b128 a[232:235], v1 offset:2048
    buffer_load_dwordx4 v[136:139], v1, s[8:11], s36 offen offset:2048 sc1
    s_waitcnt lgkmcnt(5)
    v_mfma_f32_32x32x16_bf16 v[48:63], a[244:247], v[84:87], v[48:63]
    ds_read_b128 a[236:239], v2 offset:4096
    s_waitcnt vmcnt(12)
    s_waitcnt lgkmcnt(5)
    v_mfma_f32_32x32x16_bf16 v[16:31], a[248:251], v[88:91], v[16:31]
    ds_read_b128 a[240:243], v2 offset:36864
    buffer_load_dwordx4 v[140:143], v1, s[8:11], s36 offen offset:3072 sc1
    s_add_u32 s36, s36, 4096
    s_waitcnt lgkmcnt(5)
    v_mfma_f32_32x32x16_bf16 v[32:47], a[252:255], v[88:91], v[32:47]
    ds_read_b128 a[244:247], v1 offset:3072
    s_waitcnt vmcnt(12)
    s_waitcnt lgkmcnt(5)
    v_mfma_f32_32x32x16_bf16 v[16:31], a[224:227], v[92:95], v[16:31]
    ds_read_b128 a[248:251], v2 offset:5120
    buffer_load_dwordx4 v[144:147], v1, s[8:11], s36 offen offset:0 sc1
    s_waitcnt lgkmcnt(5)
    v_mfma_f32_32x32x16_bf16 v[32:47], a[228:231], v[92:95], v[32:47]
    ds_read_b128 a[252:255], v2 offset:37888
    buffer_load_dwordx2 v[208:209], v12, s[8:11], s37 offen offset:0 sc1
    buffer_load_dwordx2 v[210:211], v12, s[8:11], s37 offen offset:256 sc1
    buffer_load_dwordx2 v[212:213], v12, s[8:11], s37 offen offset:512 sc1
    buffer_load_dwordx2 v[214:215], v12, s[8:11], s37 offen offset:768 sc1
    buffer_load_dwordx2 v[216:217], v12, s[8:11], s37 offen offset:1024 sc1
    buffer_load_dwordx2 v[218:219], v12, s[8:11], s37 offen offset:1280 sc1
    buffer_load_dwordx2 v[220:221], v12, s[8:11], s37 offen offset:1536 sc1
    buffer_load_dwordx2 v[222:223], v12, s[8:11], s37 offen offset:1792 sc1
    s_waitcnt lgkmcnt(5)
    v_mfma_f32_32x32x16_bf16 v[48:63], a[232:235], v[88:91], v[48:63]
    ds_read_b128 a[224:227], v2 offset:6144
    s_waitcnt vmcnt(20)
    s_waitcnt lgkmcnt(5)
    v_mfma_f32_32x32x16_bf16 v[16:31], a[236:239], v[96:99], v[16:31]
    ds_read_b128 a[228:231], v2 offset:38912
    buffer_load_dwordx4 v[148:151], v1, s[8:11], s36 offen offset:1024 sc1
    s_waitcnt lgkmcnt(5)
    v_mfma_f32_32x32x16_bf16 v[32:47], a[240:243], v[96:99], v[32:47]
    ds_read_b128 a[232:235], v1 offset:4096
    s_waitcnt lgkmcnt(5)
    v_mfma_f32_32x32x16_bf16 v[48:63], a[244:247], v[92:95], v[48:63]
    ds_read_b128 a[236:239], v2 offset:7168
    s_waitcnt vmcnt(20)
    s_waitcnt lgkmcnt(5)
    v_mfma_f32_32x32x16_bf16 v[16:31], a[248:251], v[100:103], v[16:31]
    ds_read_b128 a[240:243], v2 offset:39936
    buffer_load_dwordx4 v[152:155], v1, s[8:11], s36 offen offset:2048 sc1
    s_waitcnt lgkmcnt(5)
    v_mfma_f32_32x32x16_bf16 v[32:47], a[252:255], v[100:103], v[32:47]
    ds_read_b128 a[244:247], v2 offset:8192
    s_waitcnt vmcnt(20)
    s_waitcnt lgkmcnt(5)
    v_mfma_f32_32x32x16_bf16 v[16:31], a[224:227], v[104:107], v[16:31]
    ds_read_b128 a[248:251], v2 offset:40960
    buffer_load_dwordx4 v[156:159], v1, s[8:11], s36 offen offset:3072 sc1
    s_add_u32 s36, s36, 4096
    s_waitcnt lgkmcnt(5)
    v_mfma_f32_32x32x16_bf16 v[32:47], a[228:231], v[104:107], v[32:47]
    ds_read_b128 a[252:255], v1 offset:5120
    s_waitcnt lgkmcnt(5)
    v_mfma_f32_32x32x16_bf16 v[48:63], a[232:235], v[96:99], v[48:63]
    ds_read_b128 a[224:227], v2 offset:9216
    s_waitcnt vmcnt(20)
    s_waitcnt lgkmcnt(5)
    v_mfma_f32_32x32x16_bf16 v[16:31], a[236:239], v[108:111], v[16:31]
    ds_read_b128 a[228:231], v2 offset:41984
    buffer_load_dwordx4 v[160:163], v1, s[8:11], s36 offen offset:0 sc1
    s_waitcnt lgkmcnt(5)
    v_mfma_f32_32x32x16_bf16 v[32:47], a[240:243], v[108:111], v[32:47]
    ds_read_b128 a[232:235], v1 offset:6144
    s_waitcnt vmcnt(20)
    s_waitcnt lgkmcnt(5)
    v_mfma_f32_32x32x16_bf16 v[16:31], a[244:247], v[112:115], v[16:31]
    ds_read_b128 a[236:239], v2 offset:10240
    buffer_load_dwordx4 v[164:167], v1, s[8:11], s36 offen offset:1024 sc1
    s_waitcnt lgkmcnt(5)
    v_mfma_f32_32x32x16_bf16 v[32:47], a[248:251], v[112:115], v[32:47]
    ds_read_b128 a[240:243], v2 offset:43008
    s_waitcnt lgkmcnt(5)
    v_mfma_f32_32x32x16_bf16 v[48:63], a[252:255], v[100:103], v[48:63]
    ds_read_b128 a[244:247], v2 offset:11264
    s_waitcnt vmcnt(20)
    s_waitcnt lgkmcnt(5)
    v_mfma_f32_32x32x16_bf16 v[16:31], a[224:227], v[116:119], v[16:31]
    ds_read_b128 a[248:251], v2 offset:44032
    buffer_load_dwordx4 v[168:171], v1, s[8:11], s36 offen offset:2048 sc1
    s_waitcnt lgkmcnt(5)
    v_mfma_f32_32x32x16_bf16 v[32:47], a[228:231], v[116:119], v[32:47]
    ds_read_b128 a[252:255], v1 offset:7168
    s_waitcnt lgkmcnt(5)
    v_mfma_f32_32x32x16_bf16 v[48:63], a[232:235], v[104:107], v[48:63]
    ds_read_b128 a[224:227], v2 offset:12288
    s_waitcnt vmcnt(20)
    s_waitcnt lgkmcnt(5)
    v_mfma_f32_32x32x16_bf16 v[16:31], a[236:239], v[120:123], v[16:31]
    ds_read_b128 a[228:231], v2 offset:45056
    buffer_load_dwordx4 v[172:175], v1, s[8:11], s36 offen offset:3072 sc1
    s_add_u32 s36, s36, 4096
    s_waitcnt lgkmcnt(5)
    v_mfma_f32_32x32x16_bf16 v[32:47], a[240:243], v[120:123], v[32:47]
    ds_read_b128 a[232:235], v1 offset:8192
    s_waitcnt vmcnt(20)
    s_waitcnt lgkmcnt(5)
    v_mfma_f32_32x32x16_bf16 v[16:31], a[244:247], v[124:127], v[16:31]
    ds_read_b128 a[236:239], v2 offset:13312
    buffer_load_dwordx4 v[176:179], v1, s[8:11], s36 offen offset:0 sc1
    s_waitcnt lgkmcnt(5)
    v_mfma_f32_32x32x16_bf16 v[32:47], a[248:251], v[124:127], v[32:47]
    ds_read_b128 a[240:243], v2 offset:46080
    s_waitcnt lgkmcnt(5)
    v_mfma_f32_32x32x16_bf16 v[48:63], a[252:255], v[108:111], v[48:63]
    ds_read_b128 a[244:247], v2 offset:14336
    s_waitcnt vmcnt(20)
    s_waitcnt lgkmcnt(5)
    v_mfma_f32_32x32x16_bf16 v[16:31], a[224:227], v[128:131], v[16:31]
    ds_read_b128 a[248:251], v2 offset:47104
    buffer_load_dwordx4 v[180:183], v1, s[8:11], s36 offen offset:1024 sc1
    s_waitcnt lgkmcnt(5)
    v_mfma_f32_32x32x16_bf16 v[32:47], a[228:231], v[128:131], v[32:47]
    ds_read_b128 a[252:255], v1 offset:9216
    s_waitcnt lgkmcnt(5)
    v_mfma_f32_32x32x16_bf16 v[48:63], a[232:235], v[112:115], v[48:63]
    ds_read_b128 a[224:227], v2 offset:15360
    s_waitcnt vmcnt(20)
    s_waitcnt lgkmcnt(5)
    v_mfma_f32_32x32x16_bf16 v[16:31], a[236:239], v[132:135], v[16:31]
    ds_read_b128 a[228:231], v2 offset:48128
    buffer_load_dwordx4 v[184:187], v1, s[8:11], s36 offen offset:2048 sc1
    s_waitcnt lgkmcnt(5)
    v_mfma_f32_32x32x16_bf16 v[32:47], a[240:243], v[132:135], v[32:47]
    ds_read_b128 a[232:235], v2 offset:16384
    s_waitcnt vmcnt(20)
    s_waitcnt lgkmcnt(5)
    v_mfma_f32_32x32x16_bf16 v[16:31], a[244:247], v[136:139], v[16:31]
    ds_read_b128 a[236:239], v2 offset:49152
    buffer_load_dwordx4 v[188:191], v1, s[8:11], s36 offen offset:3072 sc1
    s_add_u32 s36, s36, 4096
    s_waitcnt lgkmcnt(5)
    v_mfma_f32_32x32x16_bf16 v[32:47], a[248:251], v[136:139], v[32:47]
    ds_read_b128 a[240:243], v1 offset:10240
    s_waitcnt lgkmcnt(5)
    v_mfma_f32_32x32x16_bf16 v[48:63], a[252:255], v[116:119], v[48:63]
    ds_read_b128 a[244:247], v2 offset:17408
    s_waitcnt vmcnt(20)
    s_waitcnt lgkmcnt(5)
    v_mfma_f32_32x32x16_bf16 v[16:31], a[224:227], v[140:143], v[16:31]
    ds_read_b128 a[248:251], v2 offset:50176
    buffer_load_dwordx4 v[192:195], v1, s[8:11], s36 offen offset:0 sc1
    s_waitcnt lgkmcnt(5)
    v_mfma_f32_32x32x16_bf16 v[32:47], a[228:231], v[140:143], v[32:47]
    ds_read_b128 a[252:255], v1 offset:11264
    s_waitcnt vmcnt(20)
    s_waitcnt lgkmcnt(5)
    v_mfma_f32_32x32x16_bf16 v[16:31], a[232:235], v[144:147], v[16:31]
    ds_read_b128 a[224:227], v2 offset:18432
    buffer_load_dwordx4 v[196:199], v1, s[8:11], s36 offen offset:1024 sc1
    s_waitcnt lgkmcnt(5)
    v_mfma_f32_32x32x16_bf16 v[32:47], a[236:239], v[144:147], v[32:47]
    ds_read_b128 a[228:231], v2 offset:51200
    s_waitcnt lgkmcnt(5)
    v_mfma_f32_32x32x16_bf16 v[48:63], a[240:243], v[120:123], v[48:63]
    ds_read_b128 a[232:235], v2 offset:19456
    s_waitcnt vmcnt(12)
    s_waitcnt lgkmcnt(5)
    v_mfma_f32_32x32x16_bf16 v[16:31], a[244:247], v[148:151], v[16:31]
    ds_read_b128 a[236:239], v2 offset:52224
    buffer_load_dwordx4 v[200:203], v1, s[8:11], s36 offen offset:2048 sc1
    v_add_f32 v208, v208, v216
    v_add_f32 v209, v209, v217
    v_add_f32 v210, v210, v218
    v_add_f32 v211, v211, v219
    s_waitcnt lgkmcnt(5)
    v_mfma_f32_32x32x16_bf16 v[32:47], a[248:251], v[148:151], v[32:47]
    ds_read_b128 a[240:243], v1 offset:12288
    v_add_f32 v212, v212, v220
    v_add_f32 v213, v213, v221
    v_add_f32 v214, v214, v222
    v_add_f32 v215, v215, v223
    s_waitcnt lgkmcnt(5)
    v_mfma_f32_32x32x16_bf16 v[48:63], a[252:255], v[124:127], v[48:63]
    ds_read_b128 a[244:247], v2 offset:20480
    v_add_f32 v208, v208, v212
    v_add_f32 v209, v209, v213
    v_add_f32 v210, v210, v214
    v_add_f32 v211, v211, v215
    s_waitcnt vmcnt(12)
    s_waitcnt lgkmcnt(5)
    v_mfma_f32_32x32x16_bf16 v[16:31], a[224:227], v[152:155], v[16:31]
    ds_read_b128 a[248:251], v2 offset:53248
    buffer_load_dwordx4 v[204:207], v1, s[8:11], s36 offen offset:3072 sc1
    s_add_u32 s36, s36, 4096
    v_add_f32 v208, v208, v210
    v_add_f32 v209, v209, v211
    v_mov_b32 v8, v208
    v_mov_b32 v9, v209
    s_waitcnt lgkmcnt(5)
    v_mfma_f32_32x32x16_bf16 v[32:47], a[228:231], v[152:155], v[32:47]
    ds_read_b128 a[252:255], v1 offset:13312
    s_nop 0
    v_permlane32_swap_b32 v208, v8
    v_permlane32_swap_b32 v209, v9
    v_add_f32 v8, v208, v8
    s_waitcnt vmcnt(12)
    s_waitcnt lgkmcnt(5)
    v_mfma_f32_32x32x16_bf16 v[16:31], a[232:235], v[156:159], v[16:31]
    ds_read_b128 a[224:227], v2 offset:21504
    v_add_f32 v9, v209, v9
    v_mul_f32 v8, 0xbb000000, v8
    v_mul_f32 v9, 0x3b000000, v9
    v_fma_f32 v9, -v8, v8, v9
    s_waitcnt lgkmcnt(5)
    v_mfma_f32_32x32x16_bf16 v[32:47], a[236:239], v[156:159], v[32:47]
    ds_read_b128 a[228:231], v2 offset:54272
    v_max_f32 v9, 0, v9
    v_add_f32 v9, 0x3727c5ac, v9
    v_sqrt_f32 v9, v9
    s_waitcnt lgkmcnt(5)
    v_mfma_f32_32x32x16_bf16 v[48:63], a[240:243], v[128:131], v[48:63]
    ds_read_b128 a[232:235], v2 offset:22528
    v_cvt_pk_bf16_f32 v224, v8, v8
    v_lshlrev_b32 v10, 16, v224
    v_sub_f32 v10, v8, v10
    s_waitcnt vmcnt(11)
    s_waitcnt lgkmcnt(5)
    v_mfma_f32_32x32x16_bf16 v[16:31], a[244:247], v[160:163], v[16:31]
    ds_read_b128 a[236:239], v2 offset:55296
    v_rcp_f32 v14, v9
    v_cvt_pk_bf16_f32 v225, v10, v9
    v_and_b32 v10, 0xffff0000, v225
    s_waitcnt lgkmcnt(5)
    v_mfma_f32_32x32x16_bf16 v[32:47], a[248:251], v[160:163], v[32:47]
    ds_read_b128 a[240:243], v1 offset:14336
    s_add_u32 m0, s17, 32768
    s_add_u32 s51, s30, 1419264
    buffer_load_dwordx4 v1, s[8:11], s51 offen offset:0 sc1 lds
    v_sub_f32 v10, v9, v10
    v_cvt_pk_bf16_f32 v226, v10, 0
    v_mov_b32 v227, 0
    v_mul_f32 v10, 0xc0135761, v14
    s_waitcnt lgkmcnt(5)
    v_mfma_f32_32x32x16_bf16 v[48:63], a[252:255], v[132:135], v[48:63]
    ds_read_b128 a[244:247], v2 offset:23552
    v_mul_f32 v11, v14, v14
    v_mul_f32 v11, v11, v14
    v_mul_f32 v12, 0xbdd2d3e8, v11
    v_mov_b32 v8, v9
    s_waitcnt vmcnt(11)
    s_waitcnt lgkmcnt(5)
    v_mfma_f32_32x32x16_bf16 v[16:31], a[224:227], v[164:167], v[16:31]
    ds_read_b128 a[248:251], v2 offset:56320
    buffer_load_dwordx4 v1, s[8:11], s51 offen offset:1024 sc1 lds
    s_waitcnt lgkmcnt(5)
    v_mfma_f32_32x32x16_bf16 v[32:47], a[228:231], v[164:167], v[32:47]
    ds_read_b128 a[252:255], v2 offset:24576
    s_waitcnt vmcnt(11)
    s_waitcnt lgkmcnt(5)
    v_mfma_f32_32x32x16_bf16 v[16:31], a[232:235], v[168:171], v[16:31]
    ds_read_b128 a[224:227], v2 offset:57344
    s_add_u32 m0, s17, 34816
    s_add_u32 s51, s30, 1421312
    buffer_load_dwordx4 v1, s[8:11], s51 offen offset:0 sc1 lds
    s_waitcnt lgkmcnt(5)
    v_mfma_f32_32x32x16_bf16 v[32:47], a[236:239], v[168:171], v[32:47]
    ds_read_b128 a[228:231], v1 offset:15360
    s_waitcnt lgkmcnt(5)
    v_mfma_f32_32x32x16_bf16 v[48:63], a[240:243], v[136:139], v[48:63]
    ds_read_b128 a[232:235], v2 offset:25600
    buffer_load_dwordx4 v1, s[8:11], s51 offen offset:1024 sc1 lds
    s_waitcnt vmcnt(12)
    s_waitcnt lgkmcnt(5)
    v_mfma_f32_32x32x16_bf16 v[16:31], a[244:247], v[172:175], v[16:31]
    ds_read_b128 a[236:239], v2 offset:58368
    s_waitcnt lgkmcnt(5)
    v_mfma_f32_32x32x16_bf16 v[32:47], a[248:251], v[172:175], v[32:47]
    ds_read_b128 a[240:243], v1 offset:16384
    s_add_u32 m0, s17, 36864
    s_add_u32 s51, s30, 1423360
    buffer_load_dwordx4 v1, s[8:11], s51 offen offset:0 sc1 lds
    s_waitcnt vmcnt(12)
    s_waitcnt lgkmcnt(5)
    v_mfma_f32_32x32x16_bf16 v[16:31], a[252:255], v[176:179], v[16:31]
    ds_read_b128 a[244:247], v2 offset:26624
    s_waitcnt lgkmcnt(5)
    v_mfma_f32_32x32x16_bf16 v[32:47], a[224:227], v[176:179], v[32:47]
    ds_read_b128 a[248:251], v2 offset:59392
    buffer_load_dwordx4 v1, s[8:11], s51 offen offset:1024 sc1 lds
    s_waitcnt lgkmcnt(5)
    v_mfma_f32_32x32x16_bf16 v[48:63], a[228:231], v[140:143], v[48:63]
    ds_read_b128 a[252:255], v2 offset:27648
    s_waitcnt vmcnt(12)
    s_waitcnt lgkmcnt(5)
    v_mfma_f32_32x32x16_bf16 v[16:31], a[232:235], v[180:183], v[16:31]
    ds_read_b128 a[224:227], v2 offset:60416
    s_add_u32 m0, s17, 38912
    s_add_u32 s51, s30, 1425408
    buffer_load_dwordx4 v1, s[8:11], s51 offen offset:0 sc1 lds
    s_waitcnt lgkmcnt(5)
    v_mfma_f32_32x32x16_bf16 v[32:47], a[236:239], v[180:183], v[32:47]
    ds_read_b128 a[228:231], v1 offset:17408
    s_waitcnt lgkmcnt(5)
    v_mfma_f32_32x32x16_bf16 v[48:63], a[240:243], v[144:147], v[48:63]
    ds_read_b128 a[232:235], v2 offset:28672
    buffer_load_dwordx4 v1, s[8:11], s51 offen offset:1024 sc1 lds
    s_waitcnt vmcnt(13)
    s_waitcnt lgkmcnt(5)
    v_mfma_f32_32x32x16_bf16 v[16:31], a[244:247], v[184:187], v[16:31]
    ds_read_b128 a[236:239], v2 offset:61440
    s_waitcnt lgkmcnt(5)
    v_mfma_f32_32x32x16_bf16 v[32:47], a[248:251], v[184:187], v[32:47]
    ds_read_b128 a[240:243], v1 offset:18432
    s_cbranch_vccz L0_3
    s_add_u32 s19, s31, 29696
    buffer_load_dwordx4 a[64:67], v1, s[8:11], s19 offen sc1
L0_3:
    s_waitcnt vmcnt(12)
    s_waitcnt lgkmcnt(5)
    v_mfma_f32_32x32x16_bf16 v[16:31], a[252:255], v[188:191], v[16:31]
    ds_read_b128 a[244:247], v2 offset:29696
    s_waitcnt lgkmcnt(5)
    v_mfma_f32_32x32x16_bf16 v[32:47], a[224:227], v[188:191], v[32:47]
    ds_read_b128 a[248:251], v2 offset:62464
    s_cbranch_vccz L0_4
    s_add_u32 s19, s44, 29696
    buffer_load_dwordx4 a[68:71], v1, s[8:11], s19 offen sc1
L0_4:
    s_waitcnt lgkmcnt(5)
    v_mfma_f32_32x32x16_bf16 v[48:63], a[228:231], v[148:151], v[48:63]
    ds_read_b128 a[252:255], v2 offset:30720
    s_waitcnt vmcnt(11)
    s_waitcnt lgkmcnt(5)
    v_mfma_f32_32x32x16_bf16 v[16:31], a[232:235], v[192:195], v[16:31]
    ds_read_b128 a[224:227], v2 offset:63488
    s_cbranch_vccz L0_5
    s_add_u32 s19, s31, 30720
    buffer_load_dwordx4 a[72:75], v1, s[8:11], s19 offen sc1
L0_5:
    s_waitcnt lgkmcnt(5)
    v_mfma_f32_32x32x16_bf16 v[32:47], a[236:239], v[192:195], v[32:47]
    ds_read_b128 a[228:231], v1 offset:19456
    s_waitcnt lgkmcnt(5)
    v_mfma_f32_32x32x16_bf16 v[48:63], a[240:243], v[152:155], v[48:63]
    ds_read_b128 a[232:235], v2 offset:31744
    s_cbranch_vccz L0_6
    s_add_u32 s19, s44, 30720
    buffer_load_dwordx4 a[76:79], v1, s[8:11], s19 offen sc1
L0_6:
    s_waitcnt vmcnt(10)
    s_waitcnt lgkmcnt(5)
    v_mfma_f32_32x32x16_bf16 v[16:31], a[244:247], v[196:199], v[16:31]
    ds_read_b128 a[236:239], v2 offset:64512
    s_waitcnt lgkmcnt(5)
    v_mfma_f32_32x32x16_bf16 v[32:47], a[248:251], v[196:199], v[32:47]
    ds_read_b128 a[240:243], v3 offset:28672
    s_cbranch_vccz L0_7
    s_add_u32 s19, s31, 31744
    buffer_load_dwordx4 a[80:83], v1, s[8:11], s19 offen sc1
L0_7:
    s_waitcnt vmcnt(9)
    s_waitcnt lgkmcnt(5)
    v_mfma_f32_32x32x16_bf16 v[16:31], a[252:255], v[200:203], v[16:31]
    ds_read_b128 a[244:247], v3 offset:29696
    s_waitcnt lgkmcnt(5)
    v_mfma_f32_32x32x16_bf16 v[32:47], a[224:227], v[200:203], v[32:47]
    ds_read_b128 a[248:251], v3 offset:30720
    s_cbranch_vccz L0_8
    s_add_u32 s19, s44, 31744
    buffer_load_dwordx4 a[84:87], v1, s[8:11], s19 offen sc1
L0_8:
    s_waitcnt lgkmcnt(5)
    v_mfma_f32_32x32x16_bf16 v[48:63], a[228:231], v[156:159], v[48:63]
    ds_read_b128 a[252:255], v1 offset:20480
    s_waitcnt vmcnt(8)
    s_waitcnt lgkmcnt(5)
    v_mfma_f32_32x32x16_bf16 v[16:31], a[232:235], v[204:207], v[16:31]
    ds_read_b128 a[224:227], v1 offset:21504
    s_cbranch_vccz L0_9
    s_add_u32 s19, s31, 32768
    buffer_load_dwordx4 a[88:91], v1, s[8:11], s19 offen sc1
L0_9:
    s_waitcnt lgkmcnt(5)
    v_mfma_f32_32x32x16_bf16 v[32:47], a[236:239], v[204:207], v[32:47]
    ds_read_b128 a[228:231], v1 offset:22528
    s_waitcnt lgkmcnt(5)
    v_mfma_f32_32x32x16_bf16 v[16:31], a[240:243], v[224:227], v[16:31]
    ds_read_b128 a[232:235], v1 offset:23552
    s_cbranch_vccz L0_10
    s_add_u32 s19, s44, 32768
    buffer_load_dwordx4 a[92:95], v1, s[8:11], s19 offen sc1
L0_10:
    s_waitcnt lgkmcnt(5)
    v_mfma_f32_32x32x16_bf16 v[32:47], a[244:247], v[224:227], v[32:47]
    ds_read_b128 a[236:239], v1 offset:24576
    s_waitcnt lgkmcnt(5)
    v_mfma_f32_32x32x16_bf16 v[48:63], a[248:251], v[224:227], v[48:63]
    ds_read_b128 a[240:243], v1 offset:25600
    s_cbranch_vccz L0_11
    s_add_u32 s19, s31, 33792
    buffer_load_dwordx4 a[96:99], v1, s[8:11], s19 offen sc1
L0_11:
    s_waitcnt lgkmcnt(5)
    v_mfma_f32_32x32x16_bf16 v[48:63], a[252:255], v[160:163], v[48:63]
    ds_read_b128 a[244:247], v1 offset:26624
    s_waitcnt lgkmcnt(5)
    v_mfma_f32_32x32x16_bf16 v[48:63], a[224:227], v[164:167], v[48:63]
    ds_read_b128 a[248:251], v1 offset:27648
    s_cbranch_vccz L0_12
    s_add_u32 s19, s44, 33792
    buffer_load_dwordx4 a[100:103], v1, s[8:11], s19 offen sc1
L0_12:
    v_mul_f32 v208, v16, v16
    v_mul_f32 v209, v17, v17
    v_mul_f32 v210, v18, v18
    v_mul_f32 v211, v19, v19
    v_fma_f32 v208, v208, v12, v10
    v_fma_f32 v209, v209, v12, v10
    s_waitcnt lgkmcnt(5)
    v_mfma_f32_32x32x16_bf16 v[48:63], a[228:231], v[168:171], v[48:63]
    ds_read_b128 a[252:255], v1 offset:28672
    v_fma_f32 v210, v210, v12, v10
    v_fma_f32 v211, v211, v12, v10
    v_mul_f32 v208, v208, v16
    v_mul_f32 v209, v209, v17
    v_mul_f32 v210, v210, v18
    v_mul_f32 v211, v211, v19
    s_waitcnt lgkmcnt(5)
    v_mfma_f32_32x32x16_bf16 v[48:63], a[232:235], v[172:175], v[48:63]
    ds_read_b128 a[224:227], v1 offset:29696
    s_cbranch_vccz L0_13
    s_add_u32 s19, s31, 34816
    buffer_load_dwordx4 a[104:107], v1, s[8:11], s19 offen sc1
L0_13:
    v_exp_f32 v208, v208
    v_exp_f32 v209, v209
    v_exp_f32 v210, v210
    s_waitcnt lgkmcnt(5)
    v_mfma_f32_32x32x16_bf16 v[48:63], a[236:239], v[176:179], v[48:63]
    ds_read_b128 a[228:231], v1 offset:30720
    v_exp_f32 v211, v211
    v_fma_f32 v208, v208, v8, v8
    v_fma_f32 v209, v209, v8, v8
    v_fma_f32 v210, v210, v8, v8
    v_fma_f32 v211, v211, v8, v8
    s_waitcnt lgkmcnt(5)
    v_mfma_f32_32x32x16_bf16 v[48:63], a[240:243], v[180:183], v[48:63]
    ds_read_b128 a[232:235], v1 offset:31744
    s_cbranch_vccz L0_14
    s_add_u32 s19, s44, 34816
    buffer_load_dwordx4 a[108:111], v1, s[8:11], s19 offen sc1
L0_14:
    v_rcp_f32 v208, v208
    v_rcp_f32 v209, v209
    v_rcp_f32 v210, v210
    s_waitcnt lgkmcnt(5)
    v_mfma_f32_32x32x16_bf16 v[48:63], a[244:247], v[184:187], v[48:63]
    s_waitcnt vmcnt(0)
    s_barrier
    ds_read_b128 a[236:239], v1 offset:32768
    v_rcp_f32 v211, v211
    v_mul_f32 v208, v208, v16
    v_mul_f32 v209, v209, v17
    v_mul_f32 v210, v210, v18
    v_mul_f32 v211, v211, v19
    s_waitcnt lgkmcnt(5)
    v_mfma_f32_32x32x16_bf16 v[48:63], a[248:251], v[188:191], v[48:63]
    ds_read_b128 a[240:243], v1 offset:33792
    s_cbranch_vccz L0_15
    s_add_u32 s19, s31, 57344
    buffer_load_dwordx4 a[112:115], v1, s[8:11], s19 offen sc1
L0_15:
    v_cvt_pk_bf16_f32 v228, v208, v209
    v_cvt_pk_bf16_f32 v229, v210, v211
    v_mul_f32 v212, v20, v20
    v_mul_f32 v213, v21, v21
    v_mul_f32 v214, v22, v22
    v_mul_f32 v215, v23, v23
    s_waitcnt lgkmcnt(5)
    v_mfma_f32_32x32x16_bf16 v[48:63], a[252:255], v[192:195], v[48:63]
    ds_read_b128 a[244:247], v1 offset:34816
    v_fma_f32 v212, v212, v12, v10
    v_fma_f32 v213, v213, v12, v10
    v_fma_f32 v214, v214, v12, v10
    v_fma_f32 v215, v215, v12, v10
    v_mul_f32 v212, v212, v20
    v_mul_f32 v213, v213, v21
    s_waitcnt lgkmcnt(5)
    v_mfma_f32_32x32x16_bf16 v[48:63], a[224:227], v[196:199], v[48:63]
    ds_read_b128 a[248:251], v1 offset:35840
    s_cbranch_vccz L0_16
    s_add_u32 s19, s44, 57344
    buffer_load_dwordx4 a[116:119], v1, s[8:11], s19 offen sc1
L0_16:
    v_mul_f32 v214, v214, v22
    v_mul_f32 v215, v215, v23
    v_exp_f32 v212, v212
    v_exp_f32 v213, v213
    s_waitcnt lgkmcnt(5)
    v_mfma_f32_32x32x16_bf16 v[48:63], a[228:231], v[200:203], v[48:63]
    ds_read_b128 a[252:255], v1 offset:36864
    v_exp_f32 v214, v214
    v_exp_f32 v215, v215
    v_fma_f32 v212, v212, v8, v8
    v_fma_f32 v213, v213, v8, v8
    s_waitcnt lgkmcnt(5)
    v_mfma_f32_32x32x16_bf16 v[48:63], a[232:235], v[204:207], v[48:63]
    ds_read_b128 a[224:227], v1 offset:37888
    s_cbranch_vccz L0_17
    s_add_u32 s19, s31, 58368
    buffer_load_dwordx4 a[120:123], v1, s[8:11], s19 offen sc1
L0_17:
    v_fma_f32 v214, v214, v8, v8
    v_fma_f32 v215, v215, v8, v8
    v_rcp_f32 v212, v212
    v_rcp_f32 v213, v213
    s_waitcnt lgkmcnt(5)
    v_mfma_f32_32x32x16_bf16 v[64:79], a[236:239], v[80:83], 0
    ds_read_b128 a[228:231], v1 offset:38912
    v_rcp_f32 v214, v214
    v_rcp_f32 v215, v215
    v_mul_f32 v212, v212, v20
    v_mul_f32 v213, v213, v21
    s_waitcnt lgkmcnt(5)
    v_mfma_f32_32x32x16_bf16 v[64:79], a[240:243], v[84:87], v[64:79]
    ds_read_b128 a[232:235], v1 offset:39936
    s_cbranch_vccz L0_18
    s_add_u32 s19, s44, 58368
    buffer_load_dwordx4 a[124:127], v1, s[8:11], s19 offen sc1
L0_18:
    v_mul_f32 v214, v214, v22
    v_mul_f32 v215, v215, v23
    v_cvt_pk_bf16_f32 v230, v212, v213
    v_cvt_pk_bf16_f32 v231, v214, v215
    buffer_store_dwordx4 v[228:231], v1, s[8:11], s38 offen offset:0 sc1
    v_mul_f32 v208, v24, v24
    s_waitcnt lgkmcnt(5)
    v_mfma_f32_32x32x16_bf16 v[64:79], a[244:247], v[88:91], v[64:79]
    ds_read_b128 a[236:239], v1 offset:40960
    v_mul_f32 v209, v25, v25
    v_mul_f32 v210, v26, v26
    v_mul_f32 v211, v27, v27
    v_fma_f32 v208, v208, v12, v10
    v_fma_f32 v209, v209, v12, v10
    v_fma_f32 v210, v210, v12, v10
    s_waitcnt lgkmcnt(5)
    v_mfma_f32_32x32x16_bf16 v[64:79], a[248:251], v[92:95], v[64:79]
    ds_read_b128 a[240:243], v1 offset:41984
    s_cbranch_vccz L0_19
    s_add_u32 s19, s31, 59392
    buffer_load_dwordx4 a[128:131], v1, s[8:11], s19 offen sc1
L0_19:
    v_fma_f32 v211, v211, v12, v10
    v_mul_f32 v208, v208, v24
    v_mul_f32 v209, v209, v25
    v_mul_f32 v210, v210, v26
    v_mul_f32 v211, v211, v27
    s_waitcnt lgkmcnt(5)
    v_mfma_f32_32x32x16_bf16 v[64:79], a[252:255], v[96:99], v[64:79]
    ds_read_b128 a[244:247], v1 offset:43008
    v_exp_f32 v208, v208
    v_exp_f32 v209, v209
    v_exp_f32 v210, v210
    s_waitcnt lgkmcnt(5)
    v_mfma_f32_32x32x16_bf16 v[64:79], a[224:227], v[100:103], v[64:79]
    ds_read_b128 a[248:251], v1 offset:44032
    s_cbranch_vccz L0_20
    s_add_u32 s19, s44, 59392
    buffer_load_dwordx4 a[132:135], v1, s[8:11], s19 offen sc1
L0_20:
    v_exp_f32 v211, v211
    v_fma_f32 v208, v208, v8, v8
    v_fma_f32 v209, v209, v8, v8
    v_fma_f32 v210, v210, v8, v8
    v_fma_f32 v211, v211, v8, v8
    s_waitcnt lgkmcnt(5)
    v_mfma_f32_32x32x16_bf16 v[64:79], a[228:231], v[104:107], v[64:79]
    ds_read_b128 a[252:255], v1 offset:45056
    v_rcp_f32 v208, v208
    v_rcp_f32 v209, v209
    v_rcp_f32 v210, v210
    s_waitcnt lgkmcnt(5)
    v_mfma_f32_32x32x16_bf16 v[64:79], a[232:235], v[108:111], v[64:79]
    ds_read_b128 a[224:227], v1 offset:46080
    s_cbranch_vccz L0_21
    s_add_u32 s19, s31, 60416
    buffer_load_dwordx4 a[136:139], v1, s[8:11], s19 offen sc1
L0_21:
    v_rcp_f32 v211, v211
    v_mul_f32 v208, v208, v24
    v_mul_f32 v209, v209, v25
    v_mul_f32 v210, v210, v26
    v_mul_f32 v211, v211, v27
    s_waitcnt lgkmcnt(5)
    v_mfma_f32_32x32x16_bf16 v[64:79], a[236:239], v[112:115], v[64:79]
    ds_read_b128 a[228:231], v1 offset:47104
    v_cvt_pk_bf16_f32 v232, v208, v209
    v_cvt_pk_bf16_f32 v233, v210, v211
    v_mul_f32 v212, v28, v28
    v_mul_f32 v213, v29, v29
    v_mul_f32 v214, v30, v30
    v_mul_f32 v215, v31, v31
    s_waitcnt lgkmcnt(5)
    v_mfma_f32_32x32x16_bf16 v[64:79], a[240:243], v[116:119], v[64:79]
    ds_read_b128 a[232:235], v1 offset:48128
    s_cbranch_vccz L0_22
    s_add_u32 s19, s44, 60416
    buffer_load_dwordx4 a[140:143], v1, s[8:11], s19 offen sc1
L0_22:
    v_fma_f32 v212, v212, v12, v10
    v_fma_f32 v213, v213, v12, v10
    v_fma_f32 v214, v214, v12, v10
    v_fma_f32 v215, v215, v12, v10
    v_mul_f32 v212, v212, v28
    v_mul_f32 v213, v213, v29
    s_waitcnt lgkmcnt(5)
    v_mfma_f32_32x32x16_bf16 v[64:79], a[244:247], v[120:123], v[64:79]
    ds_read_b128 a[236:239], v1 offset:49152
    v_mul_f32 v214, v214, v30
    v_mul_f32 v215, v215, v31
    v_exp_f32 v212, v212
    v_exp_f32 v213, v213
    s_waitcnt lgkmcnt(5)
    v_mfma_f32_32x32x16_bf16 v[64:79], a[248:251], v[124:127], v[64:79]
    ds_read_b128 a[240:243], v1 offset:50176
    s_cbranch_vccz L0_23
    s_add_u32 s19, s31, 61440
    buffer_load_dwordx4 a[144:147], v1, s[8:11], s19 offen sc1
L0_23:
    v_exp_f32 v214, v214
    v_exp_f32 v215, v215
    v_fma_f32 v212, v212, v8, v8
    v_fma_f32 v213, v213, v8, v8
    s_waitcnt lgkmcnt(5)
    v_mfma_f32_32x32x16_bf16 v[64:79], a[252:255], v[128:131], v[64:79]
    ds_read_b128 a[244:247], v1 offset:51200
    v_fma_f32 v214, v214, v8, v8
    v_fma_f32 v215, v215, v8, v8
    v_rcp_f32 v212, v212
    v_rcp_f32 v213, v213
    s_waitcnt lgkmcnt(5)
    v_mfma_f32_32x32x16_bf16 v[64:79], a[224:227], v[132:135], v[64:79]
    ds_read_b128 a[248:251], v1 offset:52224
    s_cbranch_vccz L0_24
    s_add_u32 s19, s44, 61440
    buffer_load_dwordx4 a[148:151], v1, s[8:11], s19 offen sc1
L0_24:
    v_rcp_f32 v214, v214
    v_rcp_f32 v215, v215
    v_mul_f32 v212, v212, v28
    v_mul_f32 v213, v213, v29
    s_waitcnt lgkmcnt(5)
    v_mfma_f32_32x32x16_bf16 v[64:79], a[228:231], v[136:139], v[64:79]
    ds_read_b128 a[252:255], v1 offset:53248
    v_mul_f32 v214, v214, v30
    v_mul_f32 v215, v215, v31
    v_cvt_pk_bf16_f32 v234, v212, v213
    v_cvt_pk_bf16_f32 v235, v214, v215
    buffer_store_dwordx4 v[232:235], v1, s[8:11], s38 offen offset:1024 sc1
    s_add_u32 s38, s38, 28672
    s_waitcnt lgkmcnt(5)
    v_mfma_f32_32x32x16_bf16 v[64:79], a[232:235], v[140:143], v[64:79]
    ds_read_b128 a[224:227], v1 offset:54272
    s_cbranch_vccz L0_25
    s_add_u32 s19, s31, 62464
    buffer_load_dwordx4 a[152:155], v1, s[8:11], s19 offen sc1
L0_25:
    v_mul_f32 v208, v32, v32
    v_mul_f32 v209, v33, v33
    v_mul_f32 v210, v34, v34
    v_mul_f32 v211, v35, v35
    v_fma_f32 v208, v208, v12, v10
    v_fma_f32 v209, v209, v12, v10
    s_waitcnt lgkmcnt(5)
    v_mfma_f32_32x32x16_bf16 v[64:79], a[236:239], v[144:147], v[64:79]
    ds_read_b128 a[228:231], v1 offset:55296
    v_fma_f32 v210, v210, v12, v10
    v_fma_f32 v211, v211, v12, v10
    v_mul_f32 v208, v208, v32
    v_mul_f32 v209, v209, v33
    v_mul_f32 v210, v210, v34
    v_mul_f32 v211, v211, v35
    s_waitcnt lgkmcnt(5)
    v_mfma_f32_32x32x16_bf16 v[64:79], a[240:243], v[148:151], v[64:79]
    ds_read_b128 a[232:235], v1 offset:56320
    s_cbranch_vccz L0_26
    s_add_u32 s19, s44, 62464
    buffer_load_dwordx4 a[156:159], v1, s[8:11], s19 offen sc1
L0_26:
    v_exp_f32 v208, v208
    v_exp_f32 v209, v209
    v_exp_f32 v210, v210
    s_waitcnt lgkmcnt(5)
    v_mfma_f32_32x32x16_bf16 v[64:79], a[244:247], v[152:155], v[64:79]
    ds_read_b128 a[236:239], v1 offset:57344
    v_exp_f32 v211, v211
    v_fma_f32 v208, v208, v8, v8
    v_fma_f32 v209, v209, v8, v8
    v_fma_f32 v210, v210, v8, v8
    v_fma_f32 v211, v211, v8, v8
    s_waitcnt lgkmcnt(5)
    v_mfma_f32_32x32x16_bf16 v[64:79], a[248:251], v[156:159], v[64:79]
    ds_read_b128 a[240:243], v1 offset:58368
    s_cbranch_vccz L0_27
    s_add_u32 s19, s31, 63488
    buffer_load_dwordx4 a[160:163], v1, s[8:11], s19 offen sc1
L0_27:
    v_rcp_f32 v208, v208
    v_rcp_f32 v209, v209
    v_rcp_f32 v210, v210
    s_waitcnt lgkmcnt(5)
    v_mfma_f32_32x32x16_bf16 v[64:79], a[252:255], v[160:163], v[64:79]
    ds_read_b128 a[244:247], v1 offset:59392
    v_rcp_f32 v211, v211
    v_mul_f32 v208, v208, v32
    v_mul_f32 v209, v209, v33
    v_mul_f32 v210, v210, v34
    v_mul_f32 v211, v211, v35
    s_waitcnt lgkmcnt(5)
    v_mfma_f32_32x32x16_bf16 v[64:79], a[224:227], v[164:167], v[64:79]
    ds_read_b128 a[248:251], v1 offset:60416
    s_cbranch_vccz L0_28
    s_add_u32 s19, s44, 63488
    buffer_load_dwordx4 a[164:167], v1, s[8:11], s19 offen sc1
L0_28:
    v_cvt_pk_bf16_f32 v228, v208, v209
    v_cvt_pk_bf16_f32 v229, v210, v211
    v_mul_f32 v212, v36, v36
    v_mul_f32 v213, v37, v37
    v_mul_f32 v214, v38, v38
    v_mul_f32 v215, v39, v39
    s_waitcnt lgkmcnt(5)
    v_mfma_f32_32x32x16_bf16 v[64:79], a[228:231], v[168:171], v[64:79]
    ds_read_b128 a[252:255], v1 offset:61440
    v_fma_f32 v212, v212, v12, v10
    v_fma_f32 v213, v213, v12, v10
    v_fma_f32 v214, v214, v12, v10
    v_fma_f32 v215, v215, v12, v10
    v_mul_f32 v212, v212, v36
    v_mul_f32 v213, v213, v37
    s_waitcnt lgkmcnt(5)
    v_mfma_f32_32x32x16_bf16 v[64:79], a[232:235], v[172:175], v[64:79]
    ds_read_b128 a[224:227], v1 offset:62464
    s_cbranch_vccz L0_29
    s_add_u32 s19, s31, 86016
    buffer_load_dwordx4 a[168:171], v1, s[8:11], s19 offen sc1
L0_29:
    v_mul_f32 v214, v214, v38
    v_mul_f32 v215, v215, v39
    v_exp_f32 v212, v212
    v_exp_f32 v213, v213
    s_waitcnt lgkmcnt(5)
    v_mfma_f32_32x32x16_bf16 v[64:79], a[236:239], v[176:179], v[64:79]
    ds_read_b128 a[228:231], v1 offset:63488
    v_exp_f32 v214, v214
    v_exp_f32 v215, v215
    v_fma_f32 v212, v212, v8, v8
    v_fma_f32 v213, v213, v8, v8
    s_waitcnt lgkmcnt(5)
    v_mfma_f32_32x32x16_bf16 v[64:79], a[240:243], v[180:183], v[64:79]
    ds_read_b128 a[232:235], v1 offset:64512
    s_cbranch_vccz L0_30
    s_add_u32 s19, s44, 86016
    buffer_load_dwordx4 a[172:175], v1, s[8:11], s19 offen sc1
L0_30:
    v_fma_f32 v214, v214, v8, v8
    v_fma_f32 v215, v215, v8, v8
    v_rcp_f32 v212, v212
    v_rcp_f32 v213, v213
    s_waitcnt lgkmcnt(5)
    v_mfma_f32_32x32x16_bf16 v[64:79], a[244:247], v[184:187], v[64:79]
    ds_read_b128 a[236:239], v3 offset:31744
    v_rcp_f32 v214, v214
    v_rcp_f32 v215, v215
    v_mul_f32 v212, v212, v36
    v_mul_f32 v213, v213, v37
    s_waitcnt lgkmcnt(5)
    v_mfma_f32_32x32x16_bf16 v[64:79], a[248:251], v[188:191], v[64:79]
    s_cbranch_vccz L0_31
    s_add_u32 s19, s31, 87040
    buffer_load_dwordx4 a[176:179], v1, s[8:11], s19 offen sc1
L0_31:
    v_mul_f32 v214, v214, v38
    v_mul_f32 v215, v215, v39
    v_cvt_pk_bf16_f32 v230, v212, v213
    v_cvt_pk_bf16_f32 v231, v214, v215
    buffer_store_dwordx4 v[228:231], v1, s[8:11], s38 offen offset:0 sc1
    v_mul_f32 v208, v40, v40
    s_waitcnt lgkmcnt(4)
    v_mfma_f32_32x32x16_bf16 v[64:79], a[252:255], v[192:195], v[64:79]
    v_mul_f32 v209, v41, v41
    v_mul_f32 v210, v42, v42
    v_mul_f32 v211, v43, v43
    v_fma_f32 v208, v208, v12, v10
    v_fma_f32 v209, v209, v12, v10
    v_fma_f32 v210, v210, v12, v10
    s_waitcnt lgkmcnt(3)
    v_mfma_f32_32x32x16_bf16 v[64:79], a[224:227], v[196:199], v[64:79]
    s_cbranch_vccz L0_32
    s_add_u32 s19, s44, 87040
    buffer_load_dwordx4 a[180:183], v1, s[8:11], s19 offen sc1
L0_32:
    v_fma_f32 v211, v211, v12, v10
    v_mul_f32 v208, v208, v40
    v_mul_f32 v209, v209, v41
    v_mul_f32 v210, v210, v42
    v_mul_f32 v211, v211, v43
    s_waitcnt lgkmcnt(2)
    v_mfma_f32_32x32x16_bf16 v[64:79], a[228:231], v[200:203], v[64:79]
    v_exp_f32 v208, v208
    v_exp_f32 v209, v209
    v_exp_f32 v210, v210
    s_waitcnt lgkmcnt(1)
    v_mfma_f32_32x32x16_bf16 v[64:79], a[232:235], v[204:207], v[64:79]
    s_cbranch_vccz L0_33
    s_add_u32 s19, s31, 88064
    buffer_load_dwordx4 a[184:187], v1, s[8:11], s19 offen sc1
L0_33:
    v_exp_f32 v211, v211
    v_fma_f32 v208, v208, v8, v8
    v_fma_f32 v209, v209, v8, v8
    v_fma_f32 v210, v210, v8, v8
    v_fma_f32 v211, v211, v8, v8
    s_waitcnt lgkmcnt(0)
    v_mfma_f32_32x32x16_bf16 v[64:79], a[236:239], v[224:227], v[64:79]
    v_rcp_f32 v208, v208
    v_rcp_f32 v209, v209
    v_rcp_f32 v210, v210
    v_rcp_f32 v211, v211
    v_mul_f32 v208, v208, v40
    v_mul_f32 v209, v209, v41
    v_mul_f32 v210, v210, v42
    v_mul_f32 v211, v211, v43
    v_cvt_pk_bf16_f32 v232, v208, v209
    v_cvt_pk_bf16_f32 v233, v210, v211
    v_pk_mul_f32 v[212:213], v[44:45], v[44:45]
    v_pk_mul_f32 v[214:215], v[46:47], v[46:47]
    v_pk_fma_f32 v[212:213], v[212:213], v[12:13], v[10:11] op_sel_hi:[1,0,0]
    v_pk_fma_f32 v[214:215], v[214:215], v[12:13], v[10:11] op_sel_hi:[1,0,0]
    v_pk_mul_f32 v[212:213], v[212:213], v[44:45]
    v_pk_mul_f32 v[214:215], v[214:215], v[46:47]
    v_exp_f32 v212, v212
    v_exp_f32 v213, v213
    v_exp_f32 v214, v214
    v_exp_f32 v215, v215
    v_pk_fma_f32 v[212:213], v[212:213], v[8:9], v[8:9]
    v_pk_fma_f32 v[214:215], v[214:215], v[8:9], v[8:9]
    v_rcp_f32 v212, v212
    v_rcp_f32 v213, v213
    v_rcp_f32 v214, v214
    v_rcp_f32 v215, v215
    v_pk_mul_f32 v[212:213], v[212:213], v[44:45]
    v_pk_mul_f32 v[214:215], v[214:215], v[46:47]
    v_cvt_pk_bf16_f32 v234, v212, v213
    v_cvt_pk_bf16_f32 v235, v214, v215
    buffer_store_dwordx4 v[232:235], v1, s[8:11], s38 offen offset:1024 sc1
    s_add_u32 s38, s38, 28672
    v_pk_mul_f32 v[208:209], v[48:49], v[48:49]
    v_pk_mul_f32 v[210:211], v[50:51], v[50:51]
    v_pk_fma_f32 v[208:209], v[208:209], v[12:13], v[10:11] op_sel_hi:[1,0,0]
    v_pk_fma_f32 v[210:211], v[210:211], v[12:13], v[10:11] op_sel_hi:[1,0,0]
    s_cbranch_vccz L0_34
    s_add_u32 s19, s44, 88064
    buffer_load_dwordx4 a[188:191], v1, s[8:11], s19 offen sc1
L0_34:
    v_pk_mul_f32 v[208:209], v[208:209], v[48:49]
    v_pk_mul_f32 v[210:211], v[210:211], v[50:51]
    v_exp_f32 v208, v208
    v_exp_f32 v209, v209
    v_exp_f32 v210, v210
    v_exp_f32 v211, v211
    s_cbranch_vccz L0_35
    s_add_u32 s19, s31, 89088
    buffer_load_dwordx4 a[192:195], v1, s[8:11], s19 offen sc1
L0_35:
    v_pk_fma_f32 v[208:209], v[208:209], v[8:9], v[8:9]
    v_pk_fma_f32 v[210:211], v[210:211], v[8:9], v[8:9]
    v_rcp_f32 v208, v208
    v_rcp_f32 v209, v209
    v_rcp_f32 v210, v210
    v_rcp_f32 v211, v211
    s_cbranch_vccz L0_36
    s_add_u32 s19, s44, 89088
    buffer_load_dwordx4 a[196:199], v1, s[8:11], s19 offen sc1
L0_36:
    v_pk_mul_f32 v[208:209], v[208:209], v[48:49]
    v_pk_mul_f32 v[210:211], v[210:211], v[50:51]
    v_cvt_pk_bf16_f32 v228, v208, v209
    v_cvt_pk_bf16_f32 v229, v210, v211
    v_pk_mul_f32 v[212:213], v[52:53], v[52:53]
    v_pk_mul_f32 v[214:215], v[54:55], v[54:55]
    s_cbranch_vccz L0_37
    s_add_u32 s19, s31, 90112
    buffer_load_dwordx4 a[200:203], v1, s[8:11], s19 offen sc1
L0_37:
    v_pk_fma_f32 v[212:213], v[212:213], v[12:13], v[10:11] op_sel_hi:[1,0,0]
    v_pk_fma_f32 v[214:215], v[214:215], v[12:13], v[10:11] op_sel_hi:[1,0,0]
    v_pk_mul_f32 v[212:213], v[212:213], v[52:53]
    v_pk_mul_f32 v[214:215], v[214:215], v[54:55]
    v_exp_f32 v212, v212
    v_exp_f32 v213, v213
    s_cbranch_vccz L0_38
    s_add_u32 s19, s44, 90112
    buffer_load_dwordx4 a[204:207], v1, s[8:11], s19 offen sc1
L0_38:
    v_exp_f32 v214, v214
    v_exp_f32 v215, v215
    v_pk_fma_f32 v[212:213], v[212:213], v[8:9], v[8:9]
    v_pk_fma_f32 v[214:215], v[214:215], v[8:9], v[8:9]
    v_rcp_f32 v212, v212
    v_rcp_f32 v213, v213
    s_cbranch_vccz L0_39
    s_add_u32 s19, s31, 91136
    buffer_load_dwordx4 a[208:211], v1, s[8:11], s19 offen sc1
L0_39:
    v_rcp_f32 v214, v214
    v_rcp_f32 v215, v215
    v_pk_mul_f32 v[212:213], v[212:213], v[52:53]
    v_pk_mul_f32 v[214:215], v[214:215], v[54:55]
    v_cvt_pk_bf16_f32 v230, v212, v213
    v_cvt_pk_bf16_f32 v231, v214, v215
    s_cbranch_vccz L0_40
    s_add_u32 s19, s44, 91136
    buffer_load_dwordx4 a[212:215], v1, s[8:11], s19 offen sc1
L0_40:
    buffer_store_dwordx4 v[228:231], v1, s[8:11], s38 offen offset:0 sc1
    v_pk_mul_f32 v[208:209], v[56:57], v[56:57]
    v_pk_mul_f32 v[210:211], v[58:59], v[58:59]
    v_pk_fma_f32 v[208:209], v[208:209], v[12:13], v[10:11] op_sel_hi:[1,0,0]
    v_pk_fma_f32 v[210:211], v[210:211], v[12:13], v[10:11] op_sel_hi:[1,0,0]
    v_pk_mul_f32 v[208:209], v[208:209], v[56:57]
    s_cbranch_vccz L0_41
    s_add_u32 s19, s31, 92160
    buffer_load_dwordx4 a[216:219], v1, s[8:11], s19 offen sc1
L0_41:
    v_pk_mul_f32 v[210:211], v[210:211], v[58:59]
    v_exp_f32 v208, v208
    v_exp_f32 v209, v209
    v_exp_f32 v210, v210
    v_exp_f32 v211, v211
    v_pk_fma_f32 v[208:209], v[208:209], v[8:9], v[8:9]
    s_cbranch_vccz L0_42
    s_add_u32 s19, s44, 92160
    buffer_load_dwordx4 a[220:223], v1, s[8:11], s19 offen sc1
L0_42:
    v_pk_fma_f32 v[210:211], v[210:211], v[8:9], v[8:9]
    v_rcp_f32 v208, v208
    v_rcp_f32 v209, v209
    v_rcp_f32 v210, v210
    v_rcp_f32 v211, v211
    v_pk_mul_f32 v[208:209], v[208:209], v[56:57]
    v_pk_mul_f32 v[210:211], v[210:211], v[58:59]
    v_cvt_pk_bf16_f32 v232, v208, v209
    v_cvt_pk_bf16_f32 v233, v210, v211
    v_pk_mul_f32 v[212:213], v[60:61], v[60:61]
    v_pk_mul_f32 v[214:215], v[62:63], v[62:63]
    v_pk_fma_f32 v[212:213], v[212:213], v[12:13], v[10:11] op_sel_hi:[1,0,0]
    v_pk_fma_f32 v[214:215], v[214:215], v[12:13], v[10:11] op_sel_hi:[1,0,0]
    v_pk_mul_f32 v[212:213], v[212:213], v[60:61]
    v_pk_mul_f32 v[214:215], v[214:215], v[62:63]
    v_exp_f32 v212, v212
    v_exp_f32 v213, v213
    v_exp_f32 v214, v214
    v_exp_f32 v215, v215
    v_pk_fma_f32 v[212:213], v[212:213], v[8:9], v[8:9]
    v_pk_fma_f32 v[214:215], v[214:215], v[8:9], v[8:9]
    v_rcp_f32 v212, v212
    v_rcp_f32 v213, v213
    v_rcp_f32 v214, v214
    v_rcp_f32 v215, v215
    v_pk_mul_f32 v[212:213], v[212:213], v[60:61]
    v_pk_mul_f32 v[214:215], v[214:215], v[62:63]
    v_cvt_pk_bf16_f32 v234, v212, v213
    v_cvt_pk_bf16_f32 v235, v214, v215
    buffer_store_dwordx4 v[232:235], v1, s[8:11], s38 offen offset:1024 sc1
    s_add_u32 s38, s38, 28672
    s_waitcnt vmcnt(2)
    s_mov_b64 exec, s[62:63]
    buffer_atomic_add v7, v13, s[8:11], s35 offen offset:0 sc1
    s_mov_b64 exec, -1
    v_pk_mul_f32 v[208:209], v[64:65], v[64:65]
    v_pk_mul_f32 v[210:211], v[66:67], v[66:67]
    v_pk_fma_f32 v[208:209], v[208:209], v[12:13], v[10:11] op_sel_hi:[1,0,0]
    v_pk_fma_f32 v[210:211], v[210:211], v[12:13], v[10:11] op_sel_hi:[1,0,0]
    v_pk_mul_f32 v[208:209], v[208:209], v[64:65]
    v_pk_mul_f32 v[210:211], v[210:211], v[66:67]
    v_exp_f32 v208, v208
    v_exp_f32 v209, v209
    v_exp_f32 v210, v210
    v_exp_f32 v211, v211
    v_pk_fma_f32 v[208:209], v[208:209], v[8:9], v[8:9]
    v_pk_fma_f32 v[210:211], v[210:211], v[8:9], v[8:9]
    v_rcp_f32 v208, v208
    v_rcp_f32 v209, v209
    v_rcp_f32 v210, v210
    v_rcp_f32 v211, v211
    v_pk_mul_f32 v[208:209], v[208:209], v[64:65]
    v_pk_mul_f32 v[210:211], v[210:211], v[66:67]
    v_cvt_pk_bf16_f32 v228, v208, v209
    v_cvt_pk_bf16_f32 v229, v210, v211
    v_pk_mul_f32 v[212:213], v[68:69], v[68:69]
    v_pk_mul_f32 v[214:215], v[70:71], v[70:71]
    v_pk_fma_f32 v[212:213], v[212:213], v[12:13], v[10:11] op_sel_hi:[1,0,0]
    v_pk_fma_f32 v[214:215], v[214:215], v[12:13], v[10:11] op_sel_hi:[1,0,0]
    v_pk_mul_f32 v[212:213], v[212:213], v[68:69]
    v_pk_mul_f32 v[214:215], v[214:215], v[70:71]
    v_exp_f32 v212, v212
    v_exp_f32 v213, v213
    v_exp_f32 v214, v214
    v_exp_f32 v215, v215
    v_pk_fma_f32 v[212:213], v[212:213], v[8:9], v[8:9]
    v_pk_fma_f32 v[214:215], v[214:215], v[8:9], v[8:9]
    v_rcp_f32 v212, v212
    v_rcp_f32 v213, v213
    v_rcp_f32 v214, v214
    v_rcp_f32 v215, v215
    v_pk_mul_f32 v[212:213], v[212:213], v[68:69]
    v_pk_mul_f32 v[214:215], v[214:215], v[70:71]
    v_cvt_pk_bf16_f32 v230, v212, v213
    v_cvt_pk_bf16_f32 v231, v214, v215
    buffer_store_dwordx4 v[228:231], v1, s[8:11], s38 offen offset:0 sc1
    v_pk_mul_f32 v[208:209], v[72:73], v[72:73]
    v_pk_mul_f32 v[210:211], v[74:75], v[74:75]
    v_pk_fma_f32 v[208:209], v[208:209], v[12:13], v[10:11] op_sel_hi:[1,0,0]
    v_pk_fma_f32 v[210:211], v[210:211], v[12:13], v[10:11] op_sel_hi:[1,0,0]
    v_pk_mul_f32 v[208:209], v[208:209], v[72:73]
    v_pk_mul_f32 v[210:211], v[210:211], v[74:75]
    v_exp_f32 v208, v208
    v_exp_f32 v209, v209
    v_exp_f32 v210, v210
    v_exp_f32 v211, v211
    v_pk_fma_f32 v[208:209], v[208:209], v[8:9], v[8:9]
    v_pk_fma_f32 v[210:211], v[210:211], v[8:9], v[8:9]
    v_rcp_f32 v208, v208
    v_rcp_f32 v209, v209
    v_rcp_f32 v210, v210
    v_rcp_f32 v211, v211
    v_pk_mul_f32 v[208:209], v[208:209], v[72:73]
    v_pk_mul_f32 v[210:211], v[210:211], v[74:75]
    v_cvt_pk_bf16_f32 v232, v208, v209
    v_cvt_pk_bf16_f32 v233, v210, v211
    v_pk_mul_f32 v[212:213], v[76:77], v[76:77]
    v_pk_mul_f32 v[214:215], v[78:79], v[78:79]
    v_pk_fma_f32 v[212:213], v[212:213], v[12:13], v[10:11] op_sel_hi:[1,0,0]
    v_pk_fma_f32 v[214:215], v[214:215], v[12:13], v[10:11] op_sel_hi:[1,0,0]
    v_pk_mul_f32 v[212:213], v[212:213], v[76:77]
    v_pk_mul_f32 v[214:215], v[214:215], v[78:79]
    v_exp_f32 v212, v212
    v_exp_f32 v213, v213
    v_exp_f32 v214, v214
    v_exp_f32 v215, v215
    v_pk_fma_f32 v[212:213], v[212:213], v[8:9], v[8:9]
    v_pk_fma_f32 v[214:215], v[214:215], v[8:9], v[8:9]
    v_rcp_f32 v212, v212
    v_rcp_f32 v213, v213
    v_rcp_f32 v214, v214
    v_rcp_f32 v215, v215
    v_pk_mul_f32 v[212:213], v[212:213], v[76:77]
    v_pk_mul_f32 v[214:215], v[214:215], v[78:79]
    v_cvt_pk_bf16_f32 v234, v212, v213
    v_cvt_pk_bf16_f32 v235, v214, v215
    buffer_store_dwordx4 v[232:235], v1, s[8:11], s38 offen offset:1024 sc1
    s_mov_b64 exec, 3
    v_mov_b32 v15, 0
    buffer_atomic_add v15, v0, s[8:11], s23 offen offset:0 sc0 sc1
    s_mov_b64 exec, -1
    s_waitcnt vmcnt(1)
    s_mov_b64 exec, s[62:63]
    buffer_atomic_add v7, v13, s[8:11], s35 offen offset:4 sc1
    s_mov_b64 exec, -1
    s_branch P5_START
P4_SKIP:
    s_sub_u32 s34, s46, 3
    s_cmp_lg_u32 s16, 0
    s_cbranch_scc1 L0_43
    s_add_u32 s19, s31, 29696
    buffer_load_dwordx4 a[64:67], v1, s[8:11], s19 offen sc1
    s_add_u32 s19, s44, 29696
    buffer_load_dwordx4 a[68:71], v1, s[8:11], s19 offen sc1
    s_add_u32 s19, s31, 30720
    buffer_load_dwordx4 a[72:75], v1, s[8:11], s19 offen sc1
    s_add_u32 s19, s44, 30720
    buffer_load_dwordx4 a[76:79], v1, s[8:11], s19 offen sc1
L0_43:
    s_cmp_lg_u32 s16, 0
    s_cbranch_scc1 L0_44
    s_add_u32 s19, s31, 31744
    buffer_load_dwordx4 a[80:83], v1, s[8:11], s19 offen sc1
    s_add_u32 s19, s44, 31744
    buffer_load_dwordx4 a[84:87], v1, s[8:11], s19 offen sc1
    s_add_u32 s19, s31, 32768
    buffer_load_dwordx4 a[88:91], v1, s[8:11], s19 offen sc1
    s_add_u32 s19, s44, 32768
    buffer_load_dwordx4 a[92:95], v1, s[8:11], s19 offen sc1
L0_44:
    s_cmp_lg_u32 s16, 0
    s_cbranch_scc1 L0_45
    s_add_u32 s19, s31, 33792
    buffer_load_dwordx4 a[96:99], v1, s[8:11], s19 offen sc1
    s_add_u32 s19, s44, 33792
    buffer_load_dwordx4 a[100:103], v1, s[8:11], s19 offen sc1
    s_add_u32 s19, s31, 34816
    buffer_load_dwordx4 a[104:107], v1, s[8:11], s19 offen sc1
    s_add_u32 s19, s44, 34816
    buffer_load_dwordx4 a[108:111], v1, s[8:11], s19 offen sc1
L0_45:
    s_cmp_lg_u32 s16, 0
    s_cbranch_scc1 L0_46
    s_add_u32 s19, s31, 57344
    buffer_load_dwordx4 a[112:115], v1, s[8:11], s19 offen sc1
    s_add_u32 s19, s44, 57344
    buffer_load_dwordx4 a[116:119], v1, s[8:11], s19 offen sc1
    s_add_u32 s19, s31, 58368
    buffer_load_dwordx4 a[120:123], v1, s[8:11], s19 offen sc1
    s_add_u32 s19, s44, 58368
    buffer_load_dwordx4 a[124:127], v1, s[8:11], s19 offen sc1
L0_46:
    s_cmp_lg_u32 s16, 0
    s_cbranch_scc1 L0_47
    s_add_u32 s19, s31, 59392
    buffer_load_dwordx4 a[128:131], v1, s[8:11], s19 offen sc1
    s_add_u32 s19, s44, 59392
    buffer_load_dwordx4 a[132:135], v1, s[8:11], s19 offen sc1
    s_add_u32 s19, s31, 60416
    buffer_load_dwordx4 a[136:139], v1, s[8:11], s19 offen sc1
    s_add_u32 s19, s44, 60416
    buffer_load_dwordx4 a[140:143], v1, s[8:11], s19 offen sc1
L0_47:
    s_cmp_lg_u32 s16, 0
    s_cbranch_scc1 L0_48
    s_add_u32 s19, s31, 61440
    buffer_load_dwordx4 a[144:147], v1, s[8:11], s19 offen sc1
    s_add_u32 s19, s44, 61440
    buffer_load_dwordx4 a[148:151], v1, s[8:11], s19 offen sc1
    s_add_u32 s19, s31, 62464
    buffer_load_dwordx4 a[152:155], v1, s[8:11], s19 offen sc1
    s_add_u32 s19, s44, 62464
    buffer_load_dwordx4 a[156:159], v1, s[8:11], s19 offen sc1
L0_48:
    s_cmp_lg_u32 s16, 0
    s_cbranch_scc1 L0_49
    s_add_u32 s19, s31, 63488
    buffer_load_dwordx4 a[160:163], v1, s[8:11], s19 offen sc1
    s_add_u32 s19, s44, 63488
    buffer_load_dwordx4 a[164:167], v1, s[8:11], s19 offen sc1
    s_add_u32 s19, s31, 86016
    buffer_load_dwordx4 a[168:171], v1, s[8:11], s19 offen sc1
    s_add_u32 s19, s44, 86016
    buffer_load_dwordx4 a[172:175], v1, s[8:11], s19 offen sc1
L0_49:
    s_cmp_lg_u32 s16, 0
    s_cbranch_scc1 L0_50
    s_add_u32 s19, s31, 87040
    buffer_load_dwordx4 a[176:179], v1, s[8:11], s19 offen sc1
    s_add_u32 s19, s44, 87040
    buffer_load_dwordx4 a[180:183], v1, s[8:11], s19 offen sc1
    s_add_u32 s19, s31, 88064
    buffer_load_dwordx4 a[184:187], v1, s[8:11], s19 offen sc1
    s_add_u32 s19, s44, 88064
    buffer_load_dwordx4 a[188:191], v1, s[8:11], s19 offen sc1
L0_50:
    s_cmp_lg_u32 s16, 0
    s_cbranch_scc1 L0_51
    s_add_u32 s19, s31, 89088
    buffer_load_dwordx4 a[192:195], v1, s[8:11], s19 offen sc1
    s_add_u32 s19, s44, 89088
    buffer_load_dwordx4 a[196:199], v1, s[8:11], s19 offen sc1
    s_add_u32 s19, s31, 90112
    buffer_load_dwordx4 a[200:203], v1, s[8:11], s19 offen sc1
    s_add_u32 s19, s44, 90112
    buffer_load_dwordx4 a[204:207], v1, s[8:11], s19 offen sc1
L0_51:
    s_cmp_lg_u32 s16, 0
    s_cbranch_scc1 L0_52
    s_add_u32 s19, s31, 91136
    buffer_load_dwordx4 a[208:211], v1, s[8:11], s19 offen sc1
    s_add_u32 s19, s44, 91136
    buffer_load_dwordx4 a[212:215], v1, s[8:11], s19 offen sc1
    s_add_u32 s19, s31, 92160
    buffer_load_dwordx4 a[216:219], v1, s[8:11], s19 offen sc1
    s_add_u32 s19, s44, 92160
    buffer_load_dwordx4 a[220:223], v1, s[8:11], s19 offen sc1
L0_52:
    s_mov_b64 exec, 1
    v_mov_b32 v15, 0
    buffer_atomic_add v15, v0, s[8:11], s23 offen offset:0 sc0 sc1
    s_mov_b64 exec, -1
    s_waitcnt vmcnt(0)
    s_mov_b64 exec, 1
    v_cmp_le_u32 vcc, s34, v15
    s_nop 1
    s_cmp_eq_u64 vcc, exec
    s_cbranch_scc1 POLL8D
    s_mov_b32 s59, 262144
    s_nop 0
POLL8:
    s_sleep 4
    v_mov_b32 v15, 0
    buffer_atomic_add v15, v0, s[8:11], s23 offen offset:0 sc0 sc1
    s_waitcnt vmcnt(0)
    v_cmp_le_u32 vcc, s34, v15
    s_nop 1
    s_cmp_eq_u64 vcc, exec
    s_cbranch_scc1 POLL8D
    s_sub_u32 s59, s59, 1
    s_cbranch_scc0 POLL8
POLL8D:
    s_mov_b64 exec, -1
    s_mov_b64 exec, 3
    v_mov_b32 v15, 0
    buffer_atomic_add v15, v0, s[8:11], s23 offen offset:0 sc0 sc1
    s_mov_b64 exec, -1
    s_waitcnt vmcnt(0)
P5_START:
    s_waitcnt vmcnt(1)
    s_mov_b64 exec, 3
    v_cmp_le_u32 vcc, s46, v15
    s_nop 1
    s_cmp_eq_u64 vcc, exec
    s_cbranch_scc1 POLL9D
    s_mov_b32 s59, 262144
    s_nop 0
POLL9:
    v_mov_b32 v15, 0
    buffer_atomic_add v15, v0, s[8:11], s23 offen offset:0 sc0 sc1
    s_waitcnt vmcnt(0)
    v_cmp_le_u32 vcc, s46, v15
    s_nop 1
    s_cmp_eq_u64 vcc, exec
    s_cbranch_scc1 POLL9D
    s_sub_u32 s59, s59, 1
    s_cbranch_scc0 POLL9
POLL9D:
    s_mov_b64 exec, -1
    s_add_u32 s19, s47, 0
    buffer_load_dwordx4 v[80:83], v1, s[8:11], s19 offen sc1
    s_add_u32 s19, s48, 0
    buffer_load_dwordx4 v[84:87], v1, s[8:11], s19 offen sc1
    s_add_u32 s19, s47, 1024
    buffer_load_dwordx4 v[88:91], v1, s[8:11], s19 offen sc1
    s_add_u32 s19, s48, 1024
    buffer_load_dwordx4 v[92:95], v1, s[8:11], s19 offen sc1
    s_add_u32 s19, s47, 2048
    buffer_load_dwordx4 v[96:99], v1, s[8:11], s19 offen sc1
    s_add_u32 s19, s48, 2048
    buffer_load_dwordx4 v[100:103], v1, s[8:11], s19 offen sc1
    s_add_u32 s19, s47, 3072
    buffer_load_dwordx4 v[104:107], v1, s[8:11], s19 offen sc1
    s_add_u32 s19, s48, 3072
    buffer_load_dwordx4 v[108:111], v1, s[8:11], s19 offen sc1
    s_add_u32 s19, s47, 4096
    buffer_load_dwordx4 v[112:115], v1, s[8:11], s19 offen sc1
    s_add_u32 s19, s48, 4096
    buffer_load_dwordx4 v[116:119], v1, s[8:11], s19 offen sc1
    s_add_u32 s19, s47, 5120
    buffer_load_dwordx4 v[120:123], v1, s[8:11], s19 offen sc1
    s_add_u32 s19, s48, 5120
    buffer_load_dwordx4 v[124:127], v1, s[8:11], s19 offen sc1
    s_add_u32 s19, s47, 6144
    buffer_load_dwordx4 v[128:131], v1, s[8:11], s19 offen sc1
    s_add_u32 s19, s48, 6144
    buffer_load_dwordx4 v[132:135], v1, s[8:11], s19 offen sc1
    s_mov_b64 exec, 3
    v_mov_b32 v15, 0
    buffer_atomic_add v15, v0, s[8:11], s23 offen offset:4 sc0 sc1
    s_mov_b64 exec, -1
    s_waitcnt vmcnt(13)
    v_mfma_f32_32x32x16_bf16 v[192:207], a[4:7], v[84:87], 0
    s_add_u32 s19, s47, 28672
    buffer_load_dwordx4 v[136:139], v1, s[8:11], s19 offen sc1
    v_mfma_f32_32x32x16_bf16 v[32:47], a[0:3], v[84:87], 0
    v_mfma_f32_32x32x16_bf16 v[176:191], a[4:7], v[80:83], 0
    s_add_u32 s19, s48, 28672
    buffer_load_dwordx4 v[140:143], v1, s[8:11], s19 offen sc1
    v_mfma_f32_32x32x16_bf16 v[16:31], a[0:3], v[80:83], v[240:255]
    s_waitcnt vmcnt(13)
    v_mfma_f32_32x32x16_bf16 v[192:207], a[12:15], v[92:95], v[192:207]
    s_add_u32 s19, s47, 29696
    buffer_load_dwordx4 v[144:147], v1, s[8:11], s19 offen sc1
    v_mfma_f32_32x32x16_bf16 v[32:47], a[8:11], v[92:95], v[32:47]
    v_mfma_f32_32x32x16_bf16 v[176:191], a[12:15], v[88:91], v[176:191]
    s_add_u32 s19, s48, 29696
    buffer_load_dwordx4 v[148:151], v1, s[8:11], s19 offen sc1
    v_mfma_f32_32x32x16_bf16 v[16:31], a[8:11], v[88:91], v[16:31]
    s_waitcnt vmcnt(13)
    v_mfma_f32_32x32x16_bf16 v[192:207], a[20:23], v[100:103], v[192:207]
    s_add_u32 s19, s47, 30720
    buffer_load_dwordx4 v[152:155], v1, s[8:11], s19 offen sc1
    v_mfma_f32_32x32x16_bf16 v[32:47], a[16:19], v[100:103], v[32:47]
    v_mfma_f32_32x32x16_bf16 v[176:191], a[20:23], v[96:99], v[176:191]
    s_add_u32 s19, s48, 30720
    buffer_load_dwordx4 v[156:159], v1, s[8:11], s19 offen sc1
    v_mfma_f32_32x32x16_bf16 v[16:31], a[16:19], v[96:99], v[16:31]
    s_waitcnt vmcnt(13)
    v_mfma_f32_32x32x16_bf16 v[192:207], a[28:31], v[108:111], v[192:207]
    s_add_u32 s19, s47, 31744
    buffer_load_dwordx4 v[160:163], v1, s[8:11], s19 offen sc1
    v_mfma_f32_32x32x16_bf16 v[32:47], a[24:27], v[108:111], v[32:47]
    v_mfma_f32_32x32x16_bf16 v[176:191], a[28:31], v[104:107], v[176:191]
    s_add_u32 s19, s48, 31744
    buffer_load_dwordx4 v[164:167], v1, s[8:11], s19 offen sc1
    v_mfma_f32_32x32x16_bf16 v[16:31], a[24:27], v[104:107], v[16:31]
    s_waitcnt vmcnt(13)
    v_mfma_f32_32x32x16_bf16 v[192:207], a[36:39], v[116:119], v[192:207]
    s_add_u32 s19, s47, 32768
    buffer_load_dwordx4 v[168:171], v1, s[8:11], s19 offen sc1
    v_mfma_f32_32x32x16_bf16 v[32:47], a[32:35], v[116:119], v[32:47]
    v_mfma_f32_32x32x16_bf16 v[176:191], a[36:39], v[112:115], v[176:191]
    s_add_u32 s19, s48, 32768
    buffer_load_dwordx4 v[172:175], v1, s[8:11], s19 offen sc1
    v_mfma_f32_32x32x16_bf16 v[16:31], a[32:35], v[112:115], v[16:31]
    s_waitcnt vmcnt(13)
    v_mfma_f32_32x32x16_bf16 v[192:207], a[44:47], v[124:127], v[192:207]
    s_add_u32 s19, s47, 33792
    buffer_load_dwordx4 v[80:83], v1, s[8:11], s19 offen sc1
    v_mfma_f32_32x32x16_bf16 v[32:47], a[40:43], v[124:127], v[32:47]
    v_mfma_f32_32x32x16_bf16 v[176:191], a[44:47], v[120:123], v[176:191]
    s_add_u32 s19, s48, 33792
    buffer_load_dwordx4 v[84:87], v1, s[8:11], s19 offen sc1
    v_mfma_f32_32x32x16_bf16 v[16:31], a[40:43], v[120:123], v[16:31]
    s_waitcnt vmcnt(13)
    v_mfma_f32_32x32x16_bf16 v[192:207], a[52:55], v[132:135], v[192:207]
    s_add_u32 s19, s47, 34816
    buffer_load_dwordx4 v[88:91], v1, s[8:11], s19 offen sc1
    v_mfma_f32_32x32x16_bf16 v[32:47], a[48:51], v[132:135], v[32:47]
    v_mfma_f32_32x32x16_bf16 v[176:191], a[52:55], v[128:131], v[176:191]
    s_add_u32 s19, s48, 34816
    buffer_load_dwordx4 v[92:95], v1, s[8:11], s19 offen sc1
    v_mfma_f32_32x32x16_bf16 v[16:31], a[48:51], v[128:131], v[16:31]
    s_waitcnt vmcnt(14)
    s_mov_b64 exec, 3
    v_cmp_le_u32 vcc, s46, v15
    s_nop 1
    s_cmp_eq_u64 vcc, exec
    s_cbranch_scc1 POLL10D
    s_mov_b32 s59, 262144
    s_nop 3
POLL10:
    v_mov_b32 v15, 0
    buffer_atomic_add v15, v0, s[8:11], s23 offen offset:4 sc0 sc1
    s_waitcnt vmcnt(0)
    v_cmp_le_u32 vcc, s46, v15
    s_nop 1
    s_cmp_eq_u64 vcc, exec
    s_cbranch_scc1 POLL10D
    s_sub_u32 s59, s59, 1
    s_cbranch_scc0 POLL10
POLL10D:
    s_mov_b64 exec, -1
    s_waitcnt vmcnt(12)
    v_mfma_f32_32x32x16_bf16 v[192:207], a[60:63], v[140:143], v[192:207]
    s_add_u32 s19, s47, 57344
    buffer_load_dwordx4 v[96:99], v1, s[8:11], s19 offen sc1
    v_mfma_f32_32x32x16_bf16 v[32:47], a[56:59], v[140:143], v[32:47]
    v_mfma_f32_32x32x16_bf16 v[176:191], a[60:63], v[136:139], v[176:191]
    s_add_u32 s19, s48, 57344
    buffer_load_dwordx4 v[100:103], v1, s[8:11], s19 offen sc1
    v_mfma_f32_32x32x16_bf16 v[16:31], a[56:59], v[136:139], v[16:31]
    s_waitcnt vmcnt(12)
    v_mfma_f32_32x32x16_bf16 v[192:207], a[68:71], v[148:151], v[192:207]
    s_add_u32 s19, s47, 58368
    buffer_load_dwordx4 v[104:107], v1, s[8:11], s19 offen sc1
    v_mfma_f32_32x32x16_bf16 v[32:47], a[64:67], v[148:151], v[32:47]
    v_lshlrev_b32 v10, 3, v5
    buffer_load_dwordx2 v[64:65], v10, s[52:55], s49 offen offset:0
    buffer_load_dwordx2 v[66:67], v10, s[52:55], s49 offen offset:16
    buffer_load_dwordx2 v[68:69], v10, s[52:55], s49 offen offset:32
    v_mfma_f32_32x32x16_bf16 v[176:191], a[68:71], v[144:147], v[176:191]
    s_add_u32 s19, s48, 58368
    buffer_load_dwordx4 v[108:111], v1, s[8:11], s19 offen sc1
    v_mfma_f32_32x32x16_bf16 v[16:31], a[64:67], v[144:147], v[16:31]
    buffer_load_dwordx2 v[70:71], v10, s[52:55], s49 offen offset:48
    s_xor_b32 s39, s12, 1
    s_mul_i32 s39, s39, 12288
    s_add_u32 s39, s39, 106496
    s_waitcnt vmcnt(16)
    v_mfma_f32_32x32x16_bf16 v[192:207], a[76:79], v[156:159], v[192:207]
    s_add_u32 s19, s47, 59392
    buffer_load_dwordx4 v[112:115], v1, s[8:11], s19 offen sc1
    v_mfma_f32_32x32x16_bf16 v[32:47], a[72:75], v[156:159], v[32:47]
    v_add_u32 v9, s39, v1
    s_xor_b32 s39, s12, 2
    s_mul_i32 s39, s39, 12288
    s_add_u32 s39, s39, 110592
    v_mfma_f32_32x32x16_bf16 v[176:191], a[76:79], v[152:155], v[176:191]
    s_add_u32 s19, s48, 59392
    buffer_load_dwordx4 v[116:119], v1, s[8:11], s19 offen sc1
    v_mfma_f32_32x32x16_bf16 v[16:31], a[72:75], v[152:155], v[16:31]
    v_add_u32 v10, s39, v1
    s_xor_b32 s39, s12, 3
    s_mul_i32 s39, s39, 12288
    s_add_u32 s39, s39, 114688
    s_waitcnt vmcnt(16)
    v_mfma_f32_32x32x16_bf16 v[192:207], a[84:87], v[164:167], v[192:207]
    s_add_u32 s19, s47, 60416
    buffer_load_dwordx4 v[120:123], v1, s[8:11], s19 offen sc1
    v_mfma_f32_32x32x16_bf16 v[32:47], a[80:83], v[164:167], v[32:47]
    v_add_u32 v11, s39, v1
    s_mul_i32 s39, s12, 12288
    s_add_u32 s39, s39, 106496
    v_add_u32 v12, s39, v1
    v_mfma_f32_32x32x16_bf16 v[176:191], a[84:87], v[160:163], v[176:191]
    s_add_u32 s19, s48, 60416
    buffer_load_dwordx4 v[124:127], v1, s[8:11], s19 offen sc1
    v_mfma_f32_32x32x16_bf16 v[16:31], a[80:83], v[160:163], v[16:31]
    s_add_u32 s36, s32, 20971520
    s_add_u32 s37, s33, 40894464
    s_waitcnt vmcnt(16)
    v_mfma_f32_32x32x16_bf16 v[192:207], a[92:95], v[172:175], v[192:207]
    s_add_u32 s19, s47, 61440
    buffer_load_dwordx4 v[128:131], v1, s[8:11], s19 offen sc1
    v_mfma_f32_32x32x16_bf16 v[32:47], a[88:91], v[172:175], v[32:47]
    v_mfma_f32_32x32x16_bf16 v[176:191], a[92:95], v[168:171], v[176:191]
    s_add_u32 s19, s48, 61440
    buffer_load_dwordx4 v[132:135], v1, s[8:11], s19 offen sc1
    v_mfma_f32_32x32x16_bf16 v[16:31], a[88:91], v[168:171], v[16:31]
    s_barrier
    s_waitcnt vmcnt(16)
    v_mfma_f32_32x32x16_bf16 v[192:207], a[100:103], v[84:87], v[192:207]
    s_add_u32 s19, s47, 62464
    buffer_load_dwordx4 v[136:139], v1, s[8:11], s19 offen sc1
    v_mfma_f32_32x32x16_bf16 v[32:47], a[96:99], v[84:87], v[32:47]
    v_mfma_f32_32x32x16_bf16 v[176:191], a[100:103], v[80:83], v[176:191]
    s_add_u32 s19, s48, 62464
    buffer_load_dwordx4 v[140:143], v1, s[8:11], s19 offen sc1
    v_mfma_f32_32x32x16_bf16 v[16:31], a[96:99], v[80:83], v[16:31]
    s_waitcnt vmcnt(16)
    v_mfma_f32_32x32x16_bf16 v[192:207], a[108:111], v[92:95], v[192:207]
    s_add_u32 s19, s47, 63488
    buffer_load_dwordx4 v[144:147], v1, s[8:11], s19 offen sc1
    v_mfma_f32_32x32x16_bf16 v[32:47], a[104:107], v[92:95], v[32:47]
    v_mfma_f32_32x32x16_bf16 v[176:191], a[108:111], v[88:91], v[176:191]
    s_add_u32 s19, s48, 63488
    buffer_load_dwordx4 v[148:151], v1, s[8:11], s19 offen sc1
    v_mfma_f32_32x32x16_bf16 v[16:31], a[104:107], v[88:91], v[16:31]
    s_waitcnt vmcnt(16)
    v_mfma_f32_32x32x16_bf16 v[192:207], a[116:119], v[100:103], v[192:207]
    s_add_u32 s19, s47, 86016
    buffer_load_dwordx4 v[152:155], v1, s[8:11], s19 offen sc1
    v_mfma_f32_32x32x16_bf16 v[32:47], a[112:115], v[100:103], v[32:47]
    v_mfma_f32_32x32x16_bf16 v[176:191], a[116:119], v[96:99], v[176:191]
    s_add_u32 s19, s48, 86016
    buffer_load_dwordx4 v[156:159], v1, s[8:11], s19 offen sc1
    v_mfma_f32_32x32x16_bf16 v[16:31], a[112:115], v[96:99], v[16:31]
    s_waitcnt vmcnt(13)
    v_mfma_f32_32x32x16_bf16 v[192:207], a[124:127], v[108:111], v[192:207]
    s_add_u32 s19, s47, 87040
    buffer_load_dwordx4 v[160:163], v1, s[8:11], s19 offen sc1
    v_mfma_f32_32x32x16_bf16 v[32:47], a[120:123], v[108:111], v[32:47]
    v_mfma_f32_32x32x16_bf16 v[176:191], a[124:127], v[104:107], v[176:191]
    s_add_u32 s19, s48, 87040
    buffer_load_dwordx4 v[164:167], v1, s[8:11], s19 offen sc1
    v_mfma_f32_32x32x16_bf16 v[16:31], a[120:123], v[104:107], v[16:31]
    s_waitcnt vmcnt(12)
    v_mfma_f32_32x32x16_bf16 v[192:207], a[132:135], v[116:119], v[192:207]
    s_add_u32 s19, s47, 88064
    buffer_load_dwordx4 v[168:171], v1, s[8:11], s19 offen sc1
    v_mfma_f32_32x32x16_bf16 v[32:47], a[128:131], v[116:119], v[32:47]
    v_mfma_f32_32x32x16_bf16 v[176:191], a[132:135], v[112:115], v[176:191]
    s_add_u32 s19, s48, 88064
    buffer_load_dwordx4 v[172:175], v1, s[8:11], s19 offen sc1
    v_mfma_f32_32x32x16_bf16 v[16:31], a[128:131], v[112:115], v[16:31]
    s_waitcnt vmcnt(12)
    v_mfma_f32_32x32x16_bf16 v[192:207], a[140:143], v[124:127], v[192:207]
    s_add_u32 s19, s47, 89088
    buffer_load_dwordx4 v[80:83], v1, s[8:11], s19 offen sc1
    v_mfma_f32_32x32x16_bf16 v[32:47], a[136:139], v[124:127], v[32:47]
    v_mfma_f32_32x32x16_bf16 v[176:191], a[140:143], v[120:123], v[176:191]
    s_add_u32 s19, s48, 89088
    buffer_load_dwordx4 v[84:87], v1, s[8:11], s19 offen sc1
    v_mfma_f32_32x32x16_bf16 v[16:31], a[136:139], v[120:123], v[16:31]
    s_waitcnt vmcnt(12)
    v_mfma_f32_32x32x16_bf16 v[192:207], a[148:151], v[132:135], v[192:207]
    s_add_u32 s19, s47, 90112
    buffer_load_dwordx4 v[88:91], v1, s[8:11], s19 offen sc1
    v_mfma_f32_32x32x16_bf16 v[32:47], a[144:147], v[132:135], v[32:47]
    v_mfma_f32_32x32x16_bf16 v[176:191], a[148:151], v[128:131], v[176:191]
    s_add_u32 s19, s48, 90112
    buffer_load_dwordx4 v[92:95], v1, s[8:11], s19 offen sc1
    v_mfma_f32_32x32x16_bf16 v[16:31], a[144:147], v[128:131], v[16:31]
    s_waitcnt vmcnt(12)
    v_mfma_f32_32x32x16_bf16 v[192:207], a[156:159], v[140:143], v[192:207]
    s_add_u32 s19, s47, 91136
    buffer_load_dwordx4 v[96:99], v1, s[8:11], s19 offen sc1
    v_mfma_f32_32x32x16_bf16 v[32:47], a[152:155], v[140:143], v[32:47]
    v_mfma_f32_32x32x16_bf16 v[176:191], a[156:159], v[136:139], v[176:191]
    s_add_u32 s19, s48, 91136
    buffer_load_dwordx4 v[100:103], v1, s[8:11], s19 offen sc1
    v_mfma_f32_32x32x16_bf16 v[16:31], a[152:155], v[136:139], v[16:31]
    s_waitcnt vmcnt(12)
    v_mfma_f32_32x32x16_bf16 v[192:207], a[164:167], v[148:151], v[192:207]
    s_add_u32 s19, s47, 92160
    buffer_load_dwordx4 v[104:107], v1, s[8:11], s19 offen sc1
    v_mfma_f32_32x32x16_bf16 v[32:47], a[160:163], v[148:151], v[32:47]
    v_mfma_f32_32x32x16_bf16 v[176:191], a[164:167], v[144:147], v[176:191]
    s_add_u32 s19, s48, 92160
    buffer_load_dwordx4 v[108:111], v1, s[8:11], s19 offen sc1
    v_mfma_f32_32x32x16_bf16 v[16:31], a[160:163], v[144:147], v[16:31]
    s_waitcnt vmcnt(12)
    v_mfma_f32_32x32x16_bf16 v[192:207], a[172:175], v[156:159], v[192:207]
    v_mfma_f32_32x32x16_bf16 v[32:47], a[168:171], v[156:159], v[32:47]
    v_mfma_f32_32x32x16_bf16 v[176:191], a[172:175], v[152:155], v[176:191]
    v_mfma_f32_32x32x16_bf16 v[16:31], a[168:171], v[152:155], v[16:31]
    s_waitcnt vmcnt(10)
    v_mfma_f32_32x32x16_bf16 v[192:207], a[180:183], v[164:167], v[192:207]
    v_lshlrev_b32 v48, 16, v64
    v_and_b32 v49, 0xffff0000, v64
    v_lshlrev_b32 v50, 16, v65
    v_and_b32 v51, 0xffff0000, v65
    v_mfma_f32_32x32x16_bf16 v[32:47], a[176:179], v[164:167], v[32:47]
    v_lshlrev_b32 v52, 16, v66
    v_and_b32 v53, 0xffff0000, v66
    v_lshlrev_b32 v54, 16, v67
    v_and_b32 v55, 0xffff0000, v67
    v_mfma_f32_32x32x16_bf16 v[176:191], a[180:183], v[160:163], v[176:191]
    v_lshlrev_b32 v56, 16, v68
    v_and_b32 v57, 0xffff0000, v68
    v_lshlrev_b32 v58, 16, v69
    v_and_b32 v59, 0xffff0000, v69
    v_mfma_f32_32x32x16_bf16 v[16:31], a[176:179], v[160:163], v[16:31]
    v_lshlrev_b32 v60, 16, v70
    v_and_b32 v61, 0xffff0000, v70
    v_lshlrev_b32 v62, 16, v71
    v_and_b32 v63, 0xffff0000, v71
    s_waitcnt vmcnt(8)
    v_mfma_f32_32x32x16_bf16 v[192:207], a[188:191], v[172:175], v[192:207]
    s_mul_i32 s35, s24, 4352
    s_add_u32 s35, s35, 53404160
    v_mfma_f32_32x32x16_bf16 v[32:47], a[184:187], v[172:175], v[32:47]
    v_mfma_f32_32x32x16_bf16 v[176:191], a[188:191], v[168:171], v[176:191]
    v_mfma_f32_32x32x16_bf16 v[16:31], a[184:187], v[168:171], v[16:31]
    s_waitcnt vmcnt(6)
    v_mfma_f32_32x32x16_bf16 v[192:207], a[196:199], v[84:87], v[192:207]
    v_mfma_f32_32x32x16_bf16 v[32:47], a[192:195], v[84:87], v[32:47]
    v_mfma_f32_32x32x16_bf16 v[176:191], a[196:199], v[80:83], v[176:191]
    v_mfma_f32_32x32x16_bf16 v[16:31], a[192:195], v[80:83], v[16:31]
    s_waitcnt vmcnt(4)
    v_mfma_f32_32x32x16_bf16 v[192:207], a[204:207], v[92:95], v[192:207]
    v_mfma_f32_32x32x16_bf16 v[32:47], a[200:203], v[92:95], v[32:47]
    v_mfma_f32_32x32x16_bf16 v[176:191], a[204:207], v[88:91], v[176:191]
    s_waitcnt vmcnt(2)
    v_mfma_f32_32x32x16_bf16 v[192:207], a[212:215], v[100:103], v[192:207]
    v_mfma_f32_32x32x16_bf16 v[32:47], a[208:211], v[100:103], v[32:47]
    v_mfma_f32_32x32x16_bf16 v[176:191], a[212:215], v[96:99], v[176:191]
    s_waitcnt vmcnt(0)
    v_mfma_f32_32x32x16_bf16 v[192:207], a[220:223], v[108:111], v[192:207]
    v_mfma_f32_32x32x16_bf16 v[32:47], a[216:219], v[108:111], v[32:47]
    v_mfma_f32_32x32x16_bf16 v[176:191], a[220:223], v[104:107], v[176:191]
    v_mfma_f32_32x32x16_bf16 v[16:31], a[200:203], v[88:91], v[16:31]
    s_nop 8
    ds_write_b128 v11, v[192:195] offset:0
    ds_write_b128 v11, v[196:199] offset:1024
    ds_write_b128 v11, v[200:203] offset:2048
    ds_write_b128 v11, v[204:207] offset:3072
    v_mfma_f32_32x32x16_bf16 v[16:31], a[208:211], v[96:99], v[16:31]
    ds_write_b128 v9, v[32:35] offset:0
    ds_write_b128 v9, v[36:39] offset:1024
    ds_write_b128 v9, v[40:43] offset:2048
    ds_write_b128 v9, v[44:47] offset:3072
    v_mfma_f32_32x32x16_bf16 v[16:31], a[216:219], v[104:107], v[16:31]
    ds_write_b128 v10, v[176:179] offset:0
    ds_write_b128 v10, v[180:183] offset:1024
    ds_write_b128 v10, v[184:187] offset:2048
    ds_write_b128 v10, v[188:191] offset:3072
    s_nop 7
    v_pk_add_f32 v[16:17], v[16:17], v[48:49]
    v_pk_add_f32 v[18:19], v[18:19], v[50:51]
    v_pk_add_f32 v[20:21], v[20:21], v[52:53]
    v_pk_add_f32 v[22:23], v[22:23], v[54:55]
    v_pk_add_f32 v[24:25], v[24:25], v[56:57]
    v_pk_add_f32 v[26:27], v[26:27], v[58:59]
    v_pk_add_f32 v[28:29], v[28:29], v[60:61]
    v_pk_add_f32 v[30:31], v[30:31], v[62:63]
    s_waitcnt lgkmcnt(0)
    s_barrier
    ds_read_b128 v[80:83], v12 offset:0
    ds_read_b128 v[96:99], v12 offset:4096
    ds_read_b128 v[112:115], v12 offset:8192
    ds_read_b128 v[84:87], v12 offset:1024
    ds_read_b128 v[100:103], v12 offset:5120
    ds_read_b128 v[116:119], v12 offset:9216
    ds_read_b128 v[88:91], v12 offset:2048
    ds_read_b128 v[104:107], v12 offset:6144
    ds_read_b128 v[120:123], v12 offset:10240
    ds_read_b128 v[92:95], v12 offset:3072
    ds_read_b128 v[108:111], v12 offset:7168
    ds_read_b128 v[124:127], v12 offset:11264
    v_lshlrev_b32 v14, 3, v4
    s_cmp_eq_u32 s16, 1
    s_cbranch_scc1 M_FIN
    s_waitcnt lgkmcnt(9)
    v_pk_add_f32 v[16:17], v[16:17], v[80:81]
    v_pk_add_f32 v[18:19], v[18:19], v[82:83]
    v_pk_add_f32 v[96:97], v[96:97], v[112:113]
    v_pk_add_f32 v[98:99], v[98:99], v[114:115]
    v_pk_add_f32 v[240:241], v[16:17], v[96:97]
    v_pk_add_f32 v[242:243], v[18:19], v[98:99]
    v_cvt_pk_bf16_f32 v64, v240, v241
    v_cvt_pk_bf16_f32 v65, v242, v243
    v_pk_mul_f32 v[10:11], v[240:241], v[240:241]
    v_pk_fma_f32 v[10:11], v[242:243], v[242:243], v[10:11]
    v_pk_add_f32 v[8:9], v[240:241], v[242:243]
    s_waitcnt lgkmcnt(6)
    v_pk_add_f32 v[20:21], v[20:21], v[84:85]
    v_pk_add_f32 v[22:23], v[22:23], v[86:87]
    v_pk_add_f32 v[100:101], v[100:101], v[116:117]
    v_pk_add_f32 v[102:103], v[102:103], v[118:119]
    v_pk_add_f32 v[244:245], v[20:21], v[100:101]
    v_pk_add_f32 v[246:247], v[22:23], v[102:103]
    v_cvt_pk_bf16_f32 v66, v244, v245
    v_cvt_pk_bf16_f32 v67, v246, v247
    buffer_store_dwordx4 v[64:67], v1, s[8:11], s36 offen sc1
    v_pk_fma_f32 v[10:11], v[244:245], v[244:245], v[10:11]
    v_pk_add_f32 v[8:9], v[8:9], v[244:245]
    v_pk_fma_f32 v[10:11], v[246:247], v[246:247], v[10:11]
    v_pk_add_f32 v[8:9], v[8:9], v[246:247]
    s_waitcnt lgkmcnt(3)
    v_pk_add_f32 v[24:25], v[24:25], v[88:89]
    v_pk_add_f32 v[26:27], v[26:27], v[90:91]
    v_pk_add_f32 v[104:105], v[104:105], v[120:121]
    v_pk_add_f32 v[106:107], v[106:107], v[122:123]
    v_pk_add_f32 v[248:249], v[24:25], v[104:105]
    v_pk_add_f32 v[250:251], v[26:27], v[106:107]
    v_cvt_pk_bf16_f32 v68, v248, v249
    v_cvt_pk_bf16_f32 v69, v250, v251
    v_pk_fma_f32 v[10:11], v[248:249], v[248:249], v[10:11]
    v_pk_add_f32 v[8:9], v[8:9], v[248:249]
    v_pk_fma_f32 v[10:11], v[250:251], v[250:251], v[10:11]
    v_pk_add_f32 v[8:9], v[8:9], v[250:251]
    s_waitcnt lgkmcnt(0)
    v_pk_add_f32 v[28:29], v[28:29], v[92:93]
    v_pk_add_f32 v[30:31], v[30:31], v[94:95]
    v_pk_add_f32 v[108:109], v[108:109], v[124:125]
    v_pk_add_f32 v[110:111], v[110:111], v[126:127]
    v_pk_add_f32 v[252:253], v[28:29], v[108:109]
    v_pk_add_f32 v[254:255], v[30:31], v[110:111]
    v_cvt_pk_bf16_f32 v70, v252, v253
    v_cvt_pk_bf16_f32 v71, v254, v255
    v_pk_fma_f32 v[10:11], v[252:253], v[252:253], v[10:11]
    v_pk_add_f32 v[8:9], v[8:9], v[252:253]
    v_pk_fma_f32 v[10:11], v[254:255], v[254:255], v[10:11]
    v_pk_add_f32 v[8:9], v[8:9], v[254:255]
    v_add_f32 v8, v8, v9
    v_add_f32 v9, v10, v11
    v_mov_b32 v10, v8
    v_mov_b32 v11, v9
    buffer_store_dwordx4 v[68:71], v1, s[8:11], s36 offen offset:1024 sc1
    v_permlane32_swap_b32 v8, v10
    v_permlane32_swap_b32 v9, v11
    v_add_f32 v8, v8, v10
    v_add_f32 v9, v9, v11
    buffer_store_dwordx2 v[8:9], v14, s[8:11], s37 offen sc1
    s_add_u32 m0, s17, 33792
    s_add_u32 s19, s29, 540672
    buffer_load_dwordx4 v1, s[8:11], s19 offen offset:0 sc1 lds
    buffer_load_dwordx4 v1, s[8:11], s19 offen offset:1024 sc1 lds
    s_add_u32 m0, s17, 67584
    s_add_u32 s19, s29, 1081344
    buffer_load_dwordx4 v1, s[8:11], s19 offen offset:0 sc1 lds
    buffer_load_dwordx4 v1, s[8:11], s19 offen offset:1024 sc1 lds
    s_add_u32 m0, s17, 0
    s_add_u32 s19, s29, 0
    buffer_load_dwordx4 v1, s[8:11], s19 offen offset:0 sc1 lds
    buffer_load_dwordx4 v1, s[8:11], s19 offen offset:1024 sc1 lds
    s_add_u32 m0, s17, 35840
    s_add_u32 s19, s29, 542720
    buffer_load_dwordx4 v1, s[8:11], s19 offen offset:0 sc1 lds
    buffer_load_dwordx4 v1, s[8:11], s19 offen offset:1024 sc1 lds
    s_add_u32 m0, s17, 69632
    s_add_u32 s19, s29, 1083392
    buffer_load_dwordx4 v1, s[8:11], s19 offen offset:0 sc1 lds
    buffer_load_dwordx4 v1, s[8:11], s19 offen offset:1024 sc1 lds
    s_waitcnt vmcnt(10)
    s_mov_b64 exec, 1
    buffer_atomic_add v7, v6, s[8:11], s35 offen offset:0 sc1
    s_mov_b64 exec, -1
    s_add_u32 m0, s17, 2048
    s_add_u32 s19, s29, 2048
    buffer_load_dwordx4 v1, s[8:11], s19 offen offset:0 sc1 lds
    buffer_load_dwordx4 v1, s[8:11], s19 offen offset:1024 sc1 lds
    s_add_u32 m0, s17, 37888
    s_add_u32 s19, s29, 544768
    buffer_load_dwordx4 v1, s[8:11], s19 offen offset:0 sc1 lds
    buffer_load_dwordx4 v1, s[8:11], s19 offen offset:1024 sc1 lds
    s_add_u32 m0, s17, 71680
    s_add_u32 s19, s29, 1085440
    buffer_load_dwordx4 v1, s[8:11], s19 offen offset:0 sc1 lds
    buffer_load_dwordx4 v1, s[8:11], s19 offen offset:1024 sc1 lds
    s_add_u32 m0, s17, 4096
    s_add_u32 s19, s29, 4096
    buffer_load_dwordx4 v1, s[8:11], s19 offen offset:0 sc1 lds
    buffer_load_dwordx4 v1, s[8:11], s19 offen offset:1024 sc1 lds
    s_add_u32 m0, s17, 39936
    s_add_u32 s19, s29, 546816
    buffer_load_dwordx4 v1, s[8:11], s19 offen offset:0 sc1 lds
    buffer_load_dwordx4 v1, s[8:11], s19 offen offset:1024 sc1 lds
    s_add_u32 m0, s17, 73728
    s_add_u32 s19, s29, 1087488
    buffer_load_dwordx4 v1, s[8:11], s19 offen offset:0 sc1 lds
    buffer_load_dwordx4 v1, s[8:11], s19 offen offset:1024 sc1 lds
    s_add_u32 m0, s17, 6144
    s_add_u32 s19, s29, 6144
    buffer_load_dwordx4 v1, s[8:11], s19 offen offset:0 sc1 lds
    buffer_load_dwordx4 v1, s[8:11], s19 offen offset:1024 sc1 lds
    s_min_u32 s34, s12, 2
    s_mul_i32 s19, s34, 33792
    s_add_u32 m0, s19, 32768
    s_nop 0
    buffer_load_dwordx4 v1, s[8:11], s28 offen sc1 lds
    s_mov_b32 s15, 20971520
    s_mov_b32 s16, 1
    s_nop 2
    s_branch LAYER
M_FIN:
    s_mov_b32 s6, 2097152
    s_mov_b32 s7, 0x00020000
    v_lshlrev_b32 v13, 10, v4
    v_lshl_add_u32 v13, v5, 4, v13
    s_lshl_b32 s40, s24, 15
    s_lshl_b32 s41, s25, 6
    s_add_u32 s40, s40, s41
    s_waitcnt lgkmcnt(9)
    v_pk_add_f32 v[16:17], v[16:17], v[80:81]
    v_pk_add_f32 v[18:19], v[18:19], v[82:83]
    v_pk_add_f32 v[96:97], v[96:97], v[112:113]
    v_pk_add_f32 v[98:99], v[98:99], v[114:115]
    v_pk_add_f32 v[240:241], v[16:17], v[96:97]
    v_pk_add_f32 v[242:243], v[18:19], v[98:99]
    v_cvt_pk_bf16_f32 v64, v240, v241
    v_cvt_pk_bf16_f32 v65, v242, v243
    s_waitcnt lgkmcnt(6)
    v_pk_add_f32 v[20:21], v[20:21], v[84:85]
    v_pk_add_f32 v[22:23], v[22:23], v[86:87]
    v_pk_add_f32 v[100:101], v[100:101], v[116:117]
    v_pk_add_f32 v[102:103], v[102:103], v[118:119]
    v_pk_add_f32 v[244:245], v[20:21], v[100:101]
    v_pk_add_f32 v[246:247], v[22:23], v[102:103]
    v_cvt_pk_bf16_f32 v66, v244, v245
    v_cvt_pk_bf16_f32 v67, v246, v247
    s_nop 0
    v_permlane32_swap_b32 v64, v66
    v_permlane32_swap_b32 v65, v67
    buffer_store_dwordx4 v[64:67], v13, s[4:7], s40 offen offset:0
    s_waitcnt lgkmcnt(3)
    v_pk_add_f32 v[24:25], v[24:25], v[88:89]
    v_pk_add_f32 v[26:27], v[26:27], v[90:91]
    v_pk_add_f32 v[104:105], v[104:105], v[120:121]
    v_pk_add_f32 v[106:107], v[106:107], v[122:123]
    v_pk_add_f32 v[248:249], v[24:25], v[104:105]
    v_pk_add_f32 v[250:251], v[26:27], v[106:107]
    v_cvt_pk_bf16_f32 v68, v248, v249
    v_cvt_pk_bf16_f32 v69, v250, v251
    s_waitcnt lgkmcnt(0)
    v_pk_add_f32 v[28:29], v[28:29], v[92:93]
    v_pk_add_f32 v[30:31], v[30:31], v[94:95]
    v_pk_add_f32 v[108:109], v[108:109], v[124:125]
    v_pk_add_f32 v[110:111], v[110:111], v[126:127]
    v_pk_add_f32 v[252:253], v[28:29], v[108:109]
    v_pk_add_f32 v[254:255], v[30:31], v[110:111]
    v_cvt_pk_bf16_f32 v70, v252, v253
    v_cvt_pk_bf16_f32 v71, v254, v255
    s_nop 0
    v_permlane32_swap_b32 v68, v70
    v_permlane32_swap_b32 v69, v71
    buffer_store_dwordx4 v[68:71], v13, s[4:7], s40 offen offset:32
M_END:
    s_endpgm
P2A_E2:
    s_waitcnt vmcnt(0) lgkmcnt(0)
    v_mov_b32 v28, 0
    v_mov_b32 v29, 0
    v_mov_b32 v30, 0
    v_mov_b32 v31, 0
    v_accvgpr_write_b32 a232, 0
    v_accvgpr_write_b32 a233, 0
    v_accvgpr_write_b32 a234, 0
    v_accvgpr_write_b32 a235, 0
    v_accvgpr_write_b32 a236, 0
    v_accvgpr_write_b32 a237, 0
    v_accvgpr_write_b32 a238, 0
    v_accvgpr_write_b32 a239, 0
    v_accvgpr_write_b32 a240, 0
    v_accvgpr_write_b32 a241, 0
    v_accvgpr_write_b32 a242, 0
    v_accvgpr_write_b32 a243, 0
    v_accvgpr_write_b32 a244, 0
    v_accvgpr_write_b32 a245, 0
    v_accvgpr_write_b32 a246, 0
    v_accvgpr_write_b32 a247, 0
    v_accvgpr_write_b32 a248, 0
    v_accvgpr_write_b32 a249, 0
    v_accvgpr_write_b32 a250, 0
    v_accvgpr_write_b32 a251, 0
    v_accvgpr_write_b32 a252, 0
    v_accvgpr_write_b32 a253, 0
    v_accvgpr_write_b32 a254, 0
    v_accvgpr_write_b32 a255, 0
    s_add_u32 m0, s49, 0
    s_add_u32 s19, s43, 0
    buffer_load_dwordx4 v13, s[96:99], s19 offen lds
    s_add_u32 m0, s49, 1024
    s_add_u32 s19, s43, 8192
    buffer_load_dwordx4 v13, s[96:99], s19 offen lds
    s_cmp_lg_u32 s38, 7
    s_cbranch_scc1 P2A_E2_6
    ds_read_b128 a[228:231], v14 offset:4096
    ds_read_b128 a[224:227], v14 offset:8192
    ds_read_b128 a[240:243], v14 offset:6144
    ds_read_b128 a[244:247], v14 offset:7168
    s_waitcnt lgkmcnt(0)
    v_mfma_f32_32x32x16_bf16 v[80:95], a[228:231], v[48:51], v[96:111]
    s_nop 11
    s_branch P2A_B2_7
P2A_E2_6:
    s_add_u32 m0, s49, 2048
    s_add_u32 s19, s43, 16384
    buffer_load_dwordx4 v13, s[96:99], s19 offen lds
    s_add_u32 m0, s49, 3072
    s_add_u32 s19, s43, 24576
    buffer_load_dwordx4 v13, s[96:99], s19 offen lds
    s_cmp_lg_u32 s38, 6
    s_cbranch_scc1 P2A_E2_5
    ds_read_b128 a[224:227], v14 offset:8192
    ds_read_b128 a[228:231], v14 offset:12288
    ds_read_b128 a[248:251], v14 offset:10240
    ds_read_b128 a[252:255], v14 offset:11264
    s_waitcnt lgkmcnt(0)
    v_mfma_f32_32x32x16_bf16 v[64:79], a[224:227], v[48:51], v[96:111]
    s_nop 11
    s_branch P2A_B2_6
P2A_E2_5:
    s_add_u32 m0, s49, 4096
    s_add_u32 s19, s43, 32768
    buffer_load_dwordx4 v13, s[96:99], s19 offen lds
    s_add_u32 m0, s49, 5120
    s_add_u32 s19, s43, 40960
    buffer_load_dwordx4 v13, s[96:99], s19 offen lds
    s_cmp_lg_u32 s38, 5
    s_cbranch_scc1 P2A_E2_4
    ds_read_b128 a[228:231], v14 offset:12288
    ds_read_b128 a[224:227], v14 offset:16384
    ds_read_b128 a[232:235], v14 offset:14336
    ds_read_b128 a[236:239], v14 offset:15360
    s_waitcnt lgkmcnt(0)
    v_mfma_f32_32x32x16_bf16 v[80:95], a[228:231], v[48:51], v[96:111]
    s_nop 11
    s_branch P2A_B2_5
P2A_E2_4:
    s_add_u32 m0, s49, 6144
    s_add_u32 s19, s43, 49152
    buffer_load_dwordx4 v13, s[96:99], s19 offen lds
    s_add_u32 m0, s49, 7168
    s_add_u32 s19, s43, 57344
    buffer_load_dwordx4 v13, s[96:99], s19 offen lds
    s_cmp_lg_u32 s38, 4
    s_cbranch_scc1 P2A_E2_3
    ds_read_b128 a[224:227], v14 offset:16384
    ds_read_b128 a[228:231], v14 offset:20480
    ds_read_b128 a[240:243], v14 offset:18432
    ds_read_b128 a[244:247], v14 offset:19456
    s_waitcnt lgkmcnt(0)
    v_mfma_f32_32x32x16_bf16 v[64:79], a[224:227], v[48:51], v[96:111]
    s_nop 11
    s_branch P2A_B2_4
P2A_E2_3:
    s_add_u32 m0, s49, 8192
    s_add_u32 s19, s43, 65536
    buffer_load_dwordx4 v13, s[96:99], s19 offen lds
    s_add_u32 m0, s49, 9216
    s_add_u32 s19, s43, 73728
    buffer_load_dwordx4 v13, s[96:99], s19 offen lds
    v_add_f32 v128, v208, v112
    v_add_f32 v129, v209, v113
    v_add_f32 v130, v210, v114
    v_add_f32 v131, v211, v115
    v_add_f32 v132, v212, v116
    v_add_f32 v133, v213, v117
    v_add_f32 v134, v214, v118
    v_add_f32 v135, v215, v119
    s_cmp_lg_u32 s38, 3
    s_cbranch_scc1 P2A_E2_2
    ds_read_b128 a[228:231], v14 offset:20480
    ds_read_b128 a[224:227], v14 offset:24576
    ds_read_b128 a[248:251], v14 offset:22528
    ds_read_b128 a[252:255], v14 offset:23552
    s_waitcnt lgkmcnt(0)
    v_mfma_f32_32x32x16_bf16 v[80:95], a[228:231], v[48:51], v[96:111]
    s_nop 11
    s_branch P2A_B2_3
P2A_E2_2:
    s_add_u32 m0, s49, 10240
    s_add_u32 s19, s43, 81920
    buffer_load_dwordx4 v13, s[96:99], s19 offen lds
    s_add_u32 m0, s49, 11264
    s_add_u32 s19, s43, 90112
    buffer_load_dwordx4 v13, s[96:99], s19 offen lds
    v_add_f32 v136, v216, v120
    v_add_f32 v137, v217, v121
    v_add_f32 v138, v218, v122
    v_add_f32 v139, v219, v123
    v_add_f32 v140, v220, v124
    v_add_f32 v141, v221, v125
    v_add_f32 v142, v222, v126
    v_add_f32 v143, v223, v127
    s_cmp_lg_u32 s38, 2
    s_cbranch_scc1 P2A_E2_1
    ds_read_b128 a[224:227], v14 offset:24576
    ds_read_b128 a[228:231], v14 offset:28672
    ds_read_b128 a[232:235], v14 offset:26624
    ds_read_b128 a[236:239], v14 offset:27648
    s_waitcnt lgkmcnt(0)
    v_mfma_f32_32x32x16_bf16 v[64:79], a[224:227], v[48:51], v[96:111]
    s_nop 11
    s_branch P2A_B2_2
P2A_E2_1:
    s_add_u32 m0, s49, 12288
    s_add_u32 s19, s43, 98304
    buffer_load_dwordx4 v13, s[96:99], s19 offen lds
    s_add_u32 m0, s49, 13312
    s_add_u32 s19, s43, 106496
    buffer_load_dwordx4 v13, s[96:99], s19 offen lds
    s_or_b32 s34, s12, s16
    s_cbranch_scc1 WRI5
    s_add_u32 s34, s26, 786
    s_mul_i32 s34, s34, 4352
    v_mov_b32 v11, s34
    s_add_u32 s34, s27, 794
    s_mul_i32 s34, s34, 4352
    v_writelane_b32 v11, s34, 1
    s_add_u32 s34, s26, 808
    s_mul_i32 s34, s34, 4352
    v_writelane_b32 v11, s34, 2
    s_add_u32 s34, s21, 770
    s_mul_i32 s34, s34, 4352
    v_writelane_b32 v11, s34, 3
    v_mov_b32 v12, 16
    v_writelane_b32 v12, 32, 1
    v_writelane_b32 v12, 56, 2
    v_writelane_b32 v12, 64, 3
    s_mov_b32 s3, 50331648
    s_mov_b64 exec, 2
    v_mov_b32 v15, 0
    buffer_atomic_add v15, v11, s[8:11], s3 offen offset:0 sc0 sc1
    s_mov_b64 exec, -1
WRI5:
    s_cmp_lg_u32 s38, 1
    s_cbranch_scc1 P2A_E2_0
    ds_read_b128 a[228:231], v14 offset:28672
    ds_read_b128 a[224:227], v14 offset:1024
    ds_read_b128 a[240:243], v14 offset:30720
    ds_read_b128 a[244:247], v14 offset:31744
    s_waitcnt lgkmcnt(0)
    v_mfma_f32_32x32x16_bf16 v[80:95], a[228:231], v[48:51], v[96:111]
    s_nop 11
    s_branch P2A_B2_1
P2A_E2_0:
    s_add_u32 m0, s49, 14336
    s_add_u32 s19, s43, 114688
    buffer_load_dwordx4 v13, s[96:99], s19 offen lds
    s_add_u32 m0, s49, 15360
    s_add_u32 s19, s43, 122880
    buffer_load_dwordx4 v13, s[96:99], s19 offen lds
    s_nop 4
    s_branch P2A_FIN
P2A_SLOW:
    s_waitcnt lgkmcnt(0)
    v_mov_b32 v8, 0xf149f2ca
    ds_read_b128 v[224:227], v14 offset:32768
    s_waitcnt lgkmcnt(0)
    v_mfma_f32_32x32x16_bf16 v[64:79], v[224:227], v[48:51], v[192:207]
    s_nop 11
    v_max3_f32 v8, v64, v65, v8
    v_max3_f32 v8, v66, v67, v8
    v_max3_f32 v8, v68, v69, v8
    v_max3_f32 v8, v70, v71, v8
    v_max3_f32 v8, v72, v73, v8
    v_max3_f32 v8, v74, v75, v8
    v_max3_f32 v8, v76, v77, v8
    v_max3_f32 v8, v78, v79, v8
    s_cmp_lt_u32 s38, 1
    s_cbranch_scc1 P2A_S1
    ds_read_b128 v[224:227], v14 offset:28672
    s_waitcnt lgkmcnt(0)
    v_mfma_f32_32x32x16_bf16 v[64:79], v[224:227], v[48:51], 0
    s_nop 11
    v_max3_f32 v8, v64, v65, v8
    v_max3_f32 v8, v66, v67, v8
    v_max3_f32 v8, v68, v69, v8
    v_max3_f32 v8, v70, v71, v8
    v_max3_f32 v8, v72, v73, v8
    v_max3_f32 v8, v74, v75, v8
    v_max3_f32 v8, v76, v77, v8
    v_max3_f32 v8, v78, v79, v8
    s_cmp_lt_u32 s38, 2
    s_cbranch_scc1 P2A_S1
    ds_read_b128 v[224:227], v14 offset:24576
    s_waitcnt lgkmcnt(0)
    v_mfma_f32_32x32x16_bf16 v[64:79], v[224:227], v[48:51], 0
    s_nop 11
    v_max3_f32 v8, v64, v65, v8
    v_max3_f32 v8, v66, v67, v8
    v_max3_f32 v8, v68, v69, v8
    v_max3_f32 v8, v70, v71, v8
    v_max3_f32 v8, v72, v73, v8
    v_max3_f32 v8, v74, v75, v8
    v_max3_f32 v8, v76, v77, v8
    v_max3_f32 v8, v78, v79, v8
    s_cmp_lt_u32 s38, 3
    s_cbranch_scc1 P2A_S1
    ds_read_b128 v[224:227], v14 offset:20480
    s_waitcnt lgkmcnt(0)
    v_mfma_f32_32x32x16_bf16 v[64:79], v[224:227], v[48:51], 0
    s_nop 11
    v_max3_f32 v8, v64, v65, v8
    v_max3_f32 v8, v66, v67, v8
    v_max3_f32 v8, v68, v69, v8
    v_max3_f32 v8, v70, v71, v8
    v_max3_f32 v8, v72, v73, v8
    v_max3_f32 v8, v74, v75, v8
    v_max3_f32 v8, v76, v77, v8
    v_max3_f32 v8, v78, v79, v8
    s_cmp_lt_u32 s38, 4
    s_cbranch_scc1 P2A_S1
    ds_read_b128 v[224:227], v14 offset:16384
    s_waitcnt lgkmcnt(0)
    v_mfma_f32_32x32x16_bf16 v[64:79], v[224:227], v[48:51], 0
    s_nop 11
    v_max3_f32 v8, v64, v65, v8
    v_max3_f32 v8, v66, v67, v8
    v_max3_f32 v8, v68, v69, v8
    v_max3_f32 v8, v70, v71, v8
    v_max3_f32 v8, v72, v73, v8
    v_max3_f32 v8, v74, v75, v8
    v_max3_f32 v8, v76, v77, v8
    v_max3_f32 v8, v78, v79, v8
    s_cmp_lt_u32 s38, 5
    s_cbranch_scc1 P2A_S1
    ds_read_b128 v[224:227], v14 offset:12288
    s_waitcnt lgkmcnt(0)
    v_mfma_f32_32x32x16_bf16 v[64:79], v[224:227], v[48:51], 0
    s_nop 11
    v_max3_f32 v8, v64, v65, v8
    v_max3_f32 v8, v66, v67, v8
    v_max3_f32 v8, v68, v69, v8
    v_max3_f32 v8, v70, v71, v8
    v_max3_f32 v8, v72, v73, v8
    v_max3_f32 v8, v74, v75, v8
    v_max3_f32 v8, v76, v77, v8
    v_max3_f32 v8, v78, v79, v8
    s_cmp_lt_u32 s38, 6
    s_cbranch_scc1 P2A_S1
    ds_read_b128 v[224:227], v14 offset:8192
    s_waitcnt lgkmcnt(0)
    v_mfma_f32_32x32x16_bf16 v[64:79], v[224:227], v[48:51], 0
    s_nop 11
    v_max3_f32 v8, v64, v65, v8
    v_max3_f32 v8, v66, v67, v8
    v_max3_f32 v8, v68, v69, v8
    v_max3_f32 v8, v70, v71, v8
    v_max3_f32 v8, v72, v73, v8
    v_max3_f32 v8, v74, v75, v8
    v_max3_f32 v8, v76, v77, v8
    v_max3_f32 v8, v78, v79, v8
    s_cmp_lt_u32 s38, 7
    s_cbranch_scc1 P2A_S1
    ds_read_b128 v[224:227], v14 offset:4096
    s_waitcnt lgkmcnt(0)
    v_mfma_f32_32x32x16_bf16 v[64:79], v[224:227], v[48:51], 0
    s_nop 11
    v_max3_f32 v8, v64, v65, v8
    v_max3_f32 v8, v66, v67, v8
    v_max3_f32 v8, v68, v69, v8
    v_max3_f32 v8, v70, v71, v8
    v_max3_f32 v8, v72, v73, v8
    v_max3_f32 v8, v74, v75, v8
    v_max3_f32 v8, v76, v77, v8
    v_max3_f32 v8, v78, v79, v8
    s_cmp_lt_u32 s38, 8
    s_cbranch_scc1 P2A_S1
    ds_read_b128 v[224:227], v14 offset:0
    s_waitcnt lgkmcnt(0)
    v_mfma_f32_32x32x16_bf16 v[64:79], v[224:227], v[48:51], v[208:223]
    s_nop 11
    v_max3_f32 v8, v64, v65, v8
    v_max3_f32 v8, v66, v67, v8
    v_max3_f32 v8, v68, v69, v8
    v_max3_f32 v8, v70, v71, v8
    v_max3_f32 v8, v72, v73, v8
    v_max3_f32 v8, v74, v75, v8
    v_max3_f32 v8, v76, v77, v8
    v_max3_f32 v8, v78, v79, v8
P2A_S1:
    v_mov_b32 v10, v8
    s_nop 1
    v_permlane32_swap_b32 v8, v10
    v_max_f32 v8, v8, v10
    v_sub_f32 v8, 0, v8
    s_nop 7
    ds_read_b128 v[224:227], v14 offset:32768
    ds_read_b128 v[228:231], v14 offset:34816
    ds_read_b128 v[232:235], v14 offset:35840
    s_waitcnt lgkmcnt(0)
    v_mfma_f32_32x32x16_bf16 v[64:79], v[224:227], v[48:51], v[192:207]
    s_nop 11
    v_pk_add_f32 v[64:65], v[64:65], v[8:9] op_sel_hi:[1,0]
    v_pk_add_f32 v[66:67], v[66:67], v[8:9] op_sel_hi:[1,0]
    v_pk_add_f32 v[68:69], v[68:69], v[8:9] op_sel_hi:[1,0]
    v_pk_add_f32 v[70:71], v[70:71], v[8:9] op_sel_hi:[1,0]
    v_pk_add_f32 v[72:73], v[72:73], v[8:9] op_sel_hi:[1,0]
    v_pk_add_f32 v[74:75], v[74:75], v[8:9] op_sel_hi:[1,0]
    v_pk_add_f32 v[76:77], v[76:77], v[8:9] op_sel_hi:[1,0]
    v_pk_add_f32 v[78:79], v[78:79], v[8:9] op_sel_hi:[1,0]
    v_exp_f32 v64, v64
    v_exp_f32 v65, v65
    v_exp_f32 v66, v66
    v_exp_f32 v67, v67
    v_exp_f32 v68, v68
    v_exp_f32 v69, v69
    v_exp_f32 v70, v70
    v_exp_f32 v71, v71
    v_cvt_pk_bf16_f32 v24, v64, v65
    v_cvt_pk_bf16_f32 v25, v66, v67
    v_cvt_pk_bf16_f32 v26, v68, v69
    v_cvt_pk_bf16_f32 v27, v70, v71
    v_exp_f32 v72, v72
    v_exp_f32 v73, v73
    v_exp_f32 v74, v74
    v_exp_f32 v75, v75
    v_mfma_f32_32x32x16_bf16 v[144:159], v[228:231], v[24:27], 0
    v_exp_f32 v76, v76
    v_exp_f32 v77, v77
    v_exp_f32 v78, v78
    v_exp_f32 v79, v79
    v_mfma_f32_16x16x32_bf16 v[80:83], v[40:43], v[24:27], 0
    v_cvt_pk_bf16_f32 v28, v72, v73
    v_cvt_pk_bf16_f32 v29, v74, v75
    v_cvt_pk_bf16_f32 v30, v76, v77
    v_cvt_pk_bf16_f32 v31, v78, v79
    s_nop 1
    v_mfma_f32_32x32x16_bf16 v[144:159], v[232:235], v[28:31], v[144:159]
    v_mfma_f32_16x16x32_bf16 v[80:83], v[40:43], v[28:31], v[80:83]
    s_cmp_lt_u32 s38, 1
    s_cbranch_scc1 P2A_S2
    s_nop 7
    ds_read_b128 v[224:227], v14 offset:28672
    ds_read_b128 v[228:231], v14 offset:30720
    ds_read_b128 v[232:235], v14 offset:31744
    s_waitcnt lgkmcnt(0)
    v_mfma_f32_32x32x16_bf16 v[64:79], v[224:227], v[48:51], 0
    s_nop 11
    v_pk_add_f32 v[64:65], v[64:65], v[8:9] op_sel_hi:[1,0]
    v_pk_add_f32 v[66:67], v[66:67], v[8:9] op_sel_hi:[1,0]
    v_pk_add_f32 v[68:69], v[68:69], v[8:9] op_sel_hi:[1,0]
    v_pk_add_f32 v[70:71], v[70:71], v[8:9] op_sel_hi:[1,0]
    v_pk_add_f32 v[72:73], v[72:73], v[8:9] op_sel_hi:[1,0]
    v_pk_add_f32 v[74:75], v[74:75], v[8:9] op_sel_hi:[1,0]
    v_pk_add_f32 v[76:77], v[76:77], v[8:9] op_sel_hi:[1,0]
    v_pk_add_f32 v[78:79], v[78:79], v[8:9] op_sel_hi:[1,0]
    v_exp_f32 v64, v64
    v_exp_f32 v65, v65
    v_exp_f32 v66, v66
    v_exp_f32 v67, v67
    v_exp_f32 v68, v68
    v_exp_f32 v69, v69
    v_exp_f32 v70, v70
    v_exp_f32 v71, v71
    v_cvt_pk_bf16_f32 v24, v64, v65
    v_cvt_pk_bf16_f32 v25, v66, v67
    v_cvt_pk_bf16_f32 v26, v68, v69
    v_cvt_pk_bf16_f32 v27, v70, v71
    v_exp_f32 v72, v72
    v_exp_f32 v73, v73
    v_exp_f32 v74, v74
    v_exp_f32 v75, v75
    v_mfma_f32_32x32x16_bf16 v[144:159], v[228:231], v[24:27], v[144:159]
    v_exp_f32 v76, v76
    v_exp_f32 v77, v77
    v_exp_f32 v78, v78
    v_exp_f32 v79, v79
    v_mfma_f32_16x16x32_bf16 v[80:83], v[40:43], v[24:27], v[80:83]
    v_cvt_pk_bf16_f32 v28, v72, v73
    v_cvt_pk_bf16_f32 v29, v74, v75
    v_cvt_pk_bf16_f32 v30, v76, v77
    v_cvt_pk_bf16_f32 v31, v78, v79
    s_nop 1
    v_mfma_f32_32x32x16_bf16 v[144:159], v[232:235], v[28:31], v[144:159]
    v_mfma_f32_16x16x32_bf16 v[80:83], v[40:43], v[28:31], v[80:83]
    s_cmp_lt_u32 s38, 2
    s_cbranch_scc1 P2A_S2
    s_nop 7
    ds_read_b128 v[224:227], v14 offset:24576
    ds_read_b128 v[228:231], v14 offset:26624
    ds_read_b128 v[232:235], v14 offset:27648
    s_waitcnt lgkmcnt(0)
    v_mfma_f32_32x32x16_bf16 v[64:79], v[224:227], v[48:51], 0
    s_nop 11
    v_pk_add_f32 v[64:65], v[64:65], v[8:9] op_sel_hi:[1,0]
    v_pk_add_f32 v[66:67], v[66:67], v[8:9] op_sel_hi:[1,0]
    v_pk_add_f32 v[68:69], v[68:69], v[8:9] op_sel_hi:[1,0]
    v_pk_add_f32 v[70:71], v[70:71], v[8:9] op_sel_hi:[1,0]
    v_pk_add_f32 v[72:73], v[72:73], v[8:9] op_sel_hi:[1,0]
    v_pk_add_f32 v[74:75], v[74:75], v[8:9] op_sel_hi:[1,0]
    v_pk_add_f32 v[76:77], v[76:77], v[8:9] op_sel_hi:[1,0]
    v_pk_add_f32 v[78:79], v[78:79], v[8:9] op_sel_hi:[1,0]
    v_exp_f32 v64, v64
    v_exp_f32 v65, v65
    v_exp_f32 v66, v66
    v_exp_f32 v67, v67
    v_exp_f32 v68, v68
    v_exp_f32 v69, v69
    v_exp_f32 v70, v70
    v_exp_f32 v71, v71
    v_cvt_pk_bf16_f32 v24, v64, v65
    v_cvt_pk_bf16_f32 v25, v66, v67
    v_cvt_pk_bf16_f32 v26, v68, v69
    v_cvt_pk_bf16_f32 v27, v70, v71
    v_exp_f32 v72, v72
    v_exp_f32 v73, v73
    v_exp_f32 v74, v74
    v_exp_f32 v75, v75
    v_mfma_f32_32x32x16_bf16 v[144:159], v[228:231], v[24:27], v[144:159]
    v_exp_f32 v76, v76
    v_exp_f32 v77, v77
    v_exp_f32 v78, v78
    v_exp_f32 v79, v79
    v_mfma_f32_16x16x32_bf16 v[80:83], v[40:43], v[24:27], v[80:83]
    v_cvt_pk_bf16_f32 v28, v72, v73
    v_cvt_pk_bf16_f32 v29, v74, v75
    v_cvt_pk_bf16_f32 v30, v76, v77
    v_cvt_pk_bf16_f32 v31, v78, v79
    s_nop 1
    v_mfma_f32_32x32x16_bf16 v[144:159], v[232:235], v[28:31], v[144:159]
    v_mfma_f32_16x16x32_bf16 v[80:83], v[40:43], v[28:31], v[80:83]
    s_cmp_lt_u32 s38, 3
    s_cbranch_scc1 P2A_S2
    s_nop 7
    ds_read_b128 v[224:227], v14 offset:20480
    ds_read_b128 v[228:231], v14 offset:22528
    ds_read_b128 v[232:235], v14 offset:23552
    s_waitcnt lgkmcnt(0)
    v_mfma_f32_32x32x16_bf16 v[64:79], v[224:227], v[48:51], 0
    s_nop 11
    v_pk_add_f32 v[64:65], v[64:65], v[8:9] op_sel_hi:[1,0]
    v_pk_add_f32 v[66:67], v[66:67], v[8:9] op_sel_hi:[1,0]
    v_pk_add_f32 v[68:69], v[68:69], v[8:9] op_sel_hi:[1,0]
    v_pk_add_f32 v[70:71], v[70:71], v[8:9] op_sel_hi:[1,0]
    v_pk_add_f32 v[72:73], v[72:73], v[8:9] op_sel_hi:[1,0]
    v_pk_add_f32 v[74:75], v[74:75], v[8:9] op_sel_hi:[1,0]
    v_pk_add_f32 v[76:77], v[76:77], v[8:9] op_sel_hi:[1,0]
    v_pk_add_f32 v[78:79], v[78:79], v[8:9] op_sel_hi:[1,0]
    v_exp_f32 v64, v64
    v_exp_f32 v65, v65
    v_exp_f32 v66, v66
    v_exp_f32 v67, v67
    v_exp_f32 v68, v68
    v_exp_f32 v69, v69
    v_exp_f32 v70, v70
    v_exp_f32 v71, v71
    v_cvt_pk_bf16_f32 v24, v64, v65
    v_cvt_pk_bf16_f32 v25, v66, v67
    v_cvt_pk_bf16_f32 v26, v68, v69
    v_cvt_pk_bf16_f32 v27, v70, v71
    v_exp_f32 v72, v72
    v_exp_f32 v73, v73
    v_exp_f32 v74, v74
    v_exp_f32 v75, v75
    v_mfma_f32_32x32x16_bf16 v[144:159], v[228:231], v[24:27], v[144:159]
    v_exp_f32 v76, v76
    v_exp_f32 v77, v77
    v_exp_f32 v78, v78
    v_exp_f32 v79, v79
    v_mfma_f32_16x16x32_bf16 v[80:83], v[40:43], v[24:27], v[80:83]
    v_cvt_pk_bf16_f32 v28, v72, v73
    v_cvt_pk_bf16_f32 v29, v74, v75
    v_cvt_pk_bf16_f32 v30, v76, v77
    v_cvt_pk_bf16_f32 v31, v78, v79
    s_nop 1
    v_mfma_f32_32x32x16_bf16 v[144:159], v[232:235], v[28:31], v[144:159]
    v_mfma_f32_16x16x32_bf16 v[80:83], v[40:43], v[28:31], v[80:83]
    s_cmp_lt_u32 s38, 4
    s_cbranch_scc1 P2A_S2
    s_nop 7
    ds_read_b128 v[224:227], v14 offset:16384
    ds_read_b128 v[228:231], v14 offset:18432
    ds_read_b128 v[232:235], v14 offset:19456
    s_waitcnt lgkmcnt(0)
    v_mfma_f32_32x32x16_bf16 v[64:79], v[224:227], v[48:51], 0
    s_nop 11
    v_pk_add_f32 v[64:65], v[64:65], v[8:9] op_sel_hi:[1,0]
    v_pk_add_f32 v[66:67], v[66:67], v[8:9] op_sel_hi:[1,0]
    v_pk_add_f32 v[68:69], v[68:69], v[8:9] op_sel_hi:[1,0]
    v_pk_add_f32 v[70:71], v[70:71], v[8:9] op_sel_hi:[1,0]
    v_pk_add_f32 v[72:73], v[72:73], v[8:9] op_sel_hi:[1,0]
    v_pk_add_f32 v[74:75], v[74:75], v[8:9] op_sel_hi:[1,0]
    v_pk_add_f32 v[76:77], v[76:77], v[8:9] op_sel_hi:[1,0]
    v_pk_add_f32 v[78:79], v[78:79], v[8:9] op_sel_hi:[1,0]
    v_exp_f32 v64, v64
    v_exp_f32 v65, v65
    v_exp_f32 v66, v66
    v_exp_f32 v67, v67
    v_exp_f32 v68, v68
    v_exp_f32 v69, v69
    v_exp_f32 v70, v70
    v_exp_f32 v71, v71
    v_cvt_pk_bf16_f32 v24, v64, v65
    v_cvt_pk_bf16_f32 v25, v66, v67
    v_cvt_pk_bf16_f32 v26, v68, v69
    v_cvt_pk_bf16_f32 v27, v70, v71
    v_exp_f32 v72, v72
    v_exp_f32 v73, v73
    v_exp_f32 v74, v74
    v_exp_f32 v75, v75
    v_mfma_f32_32x32x16_bf16 v[144:159], v[228:231], v[24:27], v[144:159]
    v_exp_f32 v76, v76
    v_exp_f32 v77, v77
    v_exp_f32 v78, v78
    v_exp_f32 v79, v79
    v_mfma_f32_16x16x32_bf16 v[80:83], v[40:43], v[24:27], v[80:83]
    v_cvt_pk_bf16_f32 v28, v72, v73
    v_cvt_pk_bf16_f32 v29, v74, v75
    v_cvt_pk_bf16_f32 v30, v76, v77
    v_cvt_pk_bf16_f32 v31, v78, v79
    s_nop 1
    v_mfma_f32_32x32x16_bf16 v[144:159], v[232:235], v[28:31], v[144:159]
    v_mfma_f32_16x16x32_bf16 v[80:83], v[40:43], v[28:31], v[80:83]
    s_cmp_lt_u32 s38, 5
    s_cbranch_scc1 P2A_S2
    s_nop 7
    ds_read_b128 v[224:227], v14 offset:12288
    ds_read_b128 v[228:231], v14 offset:14336
    ds_read_b128 v[232:235], v14 offset:15360
    s_waitcnt lgkmcnt(0)
    v_mfma_f32_32x32x16_bf16 v[64:79], v[224:227], v[48:51], 0
    s_nop 11
    v_pk_add_f32 v[64:65], v[64:65], v[8:9] op_sel_hi:[1,0]
    v_pk_add_f32 v[66:67], v[66:67], v[8:9] op_sel_hi:[1,0]
    v_pk_add_f32 v[68:69], v[68:69], v[8:9] op_sel_hi:[1,0]
    v_pk_add_f32 v[70:71], v[70:71], v[8:9] op_sel_hi:[1,0]
    v_pk_add_f32 v[72:73], v[72:73], v[8:9] op_sel_hi:[1,0]
    v_pk_add_f32 v[74:75], v[74:75], v[8:9] op_sel_hi:[1,0]
    v_pk_add_f32 v[76:77], v[76:77], v[8:9] op_sel_hi:[1,0]
    v_pk_add_f32 v[78:79], v[78:79], v[8:9] op_sel_hi:[1,0]
    v_exp_f32 v64, v64
    v_exp_f32 v65, v65
    v_exp_f32 v66, v66
    v_exp_f32 v67, v67
    v_exp_f32 v68, v68
    v_exp_f32 v69, v69
    v_exp_f32 v70, v70
    v_exp_f32 v71, v71
    v_cvt_pk_bf16_f32 v24, v64, v65
    v_cvt_pk_bf16_f32 v25, v66, v67
    v_cvt_pk_bf16_f32 v26, v68, v69
    v_cvt_pk_bf16_f32 v27, v70, v71
    v_exp_f32 v72, v72
    v_exp_f32 v73, v73
    v_exp_f32 v74, v74
    v_exp_f32 v75, v75
    v_mfma_f32_32x32x16_bf16 v[144:159], v[228:231], v[24:27], v[144:159]
    v_exp_f32 v76, v76
    v_exp_f32 v77, v77
    v_exp_f32 v78, v78
    v_exp_f32 v79, v79
    v_mfma_f32_16x16x32_bf16 v[80:83], v[40:43], v[24:27], v[80:83]
    v_cvt_pk_bf16_f32 v28, v72, v73
    v_cvt_pk_bf16_f32 v29, v74, v75
    v_cvt_pk_bf16_f32 v30, v76, v77
    v_cvt_pk_bf16_f32 v31, v78, v79
    s_nop 1
    v_mfma_f32_32x32x16_bf16 v[144:159], v[232:235], v[28:31], v[144:159]
    v_mfma_f32_16x16x32_bf16 v[80:83], v[40:43], v[28:31], v[80:83]
    s_cmp_lt_u32 s38, 6
    s_cbranch_scc1 P2A_S2
    s_nop 7
    ds_read_b128 v[224:227], v14 offset:8192
    ds_read_b128 v[228:231], v14 offset:10240
    ds_read_b128 v[232:235], v14 offset:11264
    s_waitcnt lgkmcnt(0)
    v_mfma_f32_32x32x16_bf16 v[64:79], v[224:227], v[48:51], 0
    s_nop 11
    v_pk_add_f32 v[64:65], v[64:65], v[8:9] op_sel_hi:[1,0]
    v_pk_add_f32 v[66:67], v[66:67], v[8:9] op_sel_hi:[1,0]
    v_pk_add_f32 v[68:69], v[68:69], v[8:9] op_sel_hi:[1,0]
    v_pk_add_f32 v[70:71], v[70:71], v[8:9] op_sel_hi:[1,0]
    v_pk_add_f32 v[72:73], v[72:73], v[8:9] op_sel_hi:[1,0]
    v_pk_add_f32 v[74:75], v[74:75], v[8:9] op_sel_hi:[1,0]
    v_pk_add_f32 v[76:77], v[76:77], v[8:9] op_sel_hi:[1,0]
    v_pk_add_f32 v[78:79], v[78:79], v[8:9] op_sel_hi:[1,0]
    v_exp_f32 v64, v64
    v_exp_f32 v65, v65
    v_exp_f32 v66, v66
    v_exp_f32 v67, v67
    v_exp_f32 v68, v68
    v_exp_f32 v69, v69
    v_exp_f32 v70, v70
    v_exp_f32 v71, v71
    v_cvt_pk_bf16_f32 v24, v64, v65
    v_cvt_pk_bf16_f32 v25, v66, v67
    v_cvt_pk_bf16_f32 v26, v68, v69
    v_cvt_pk_bf16_f32 v27, v70, v71
    v_exp_f32 v72, v72
    v_exp_f32 v73, v73
    v_exp_f32 v74, v74
    v_exp_f32 v75, v75
    v_mfma_f32_32x32x16_bf16 v[144:159], v[228:231], v[24:27], v[144:159]
    v_exp_f32 v76, v76
    v_exp_f32 v77, v77
    v_exp_f32 v78, v78
    v_exp_f32 v79, v79
    v_mfma_f32_16x16x32_bf16 v[80:83], v[40:43], v[24:27], v[80:83]
    v_cvt_pk_bf16_f32 v28, v72, v73
    v_cvt_pk_bf16_f32 v29, v74, v75
    v_cvt_pk_bf16_f32 v30, v76, v77
    v_cvt_pk_bf16_f32 v31, v78, v79
    s_nop 1
    v_mfma_f32_32x32x16_bf16 v[144:159], v[232:235], v[28:31], v[144:159]
    v_mfma_f32_16x16x32_bf16 v[80:83], v[40:43], v[28:31], v[80:83]
    s_cmp_lt_u32 s38, 7
    s_cbranch_scc1 P2A_S2
    s_nop 7
    ds_read_b128 v[224:227], v14 offset:4096
    ds_read_b128 v[228:231], v14 offset:6144
    ds_read_b128 v[232:235], v14 offset:7168
    s_waitcnt lgkmcnt(0)
    v_mfma_f32_32x32x16_bf16 v[64:79], v[224:227], v[48:51], 0
    s_nop 11
    v_pk_add_f32 v[64:65], v[64:65], v[8:9] op_sel_hi:[1,0]
    v_pk_add_f32 v[66:67], v[66:67], v[8:9] op_sel_hi:[1,0]
    v_pk_add_f32 v[68:69], v[68:69], v[8:9] op_sel_hi:[1,0]
    v_pk_add_f32 v[70:71], v[70:71], v[8:9] op_sel_hi:[1,0]
    v_pk_add_f32 v[72:73], v[72:73], v[8:9] op_sel_hi:[1,0]
    v_pk_add_f32 v[74:75], v[74:75], v[8:9] op_sel_hi:[1,0]
    v_pk_add_f32 v[76:77], v[76:77], v[8:9] op_sel_hi:[1,0]
    v_pk_add_f32 v[78:79], v[78:79], v[8:9] op_sel_hi:[1,0]
    v_exp_f32 v64, v64
    v_exp_f32 v65, v65
    v_exp_f32 v66, v66
    v_exp_f32 v67, v67
    v_exp_f32 v68, v68
    v_exp_f32 v69, v69
    v_exp_f32 v70, v70
    v_exp_f32 v71, v71
    v_cvt_pk_bf16_f32 v24, v64, v65
    v_cvt_pk_bf16_f32 v25, v66, v67
    v_cvt_pk_bf16_f32 v26, v68, v69
    v_cvt_pk_bf16_f32 v27, v70, v71
    v_exp_f32 v72, v72
    v_exp_f32 v73, v73
    v_exp_f32 v74, v74
    v_exp_f32 v75, v75
    v_mfma_f32_32x32x16_bf16 v[144:159], v[228:231], v[24:27], v[144:159]
    v_exp_f32 v76, v76
    v_exp_f32 v77, v77
    v_exp_f32 v78, v78
    v_exp_f32 v79, v79
    v_mfma_f32_16x16x32_bf16 v[80:83], v[40:43], v[24:27], v[80:83]
    v_cvt_pk_bf16_f32 v28, v72, v73
    v_cvt_pk_bf16_f32 v29, v74, v75
    v_cvt_pk_bf16_f32 v30, v76, v77
    v_cvt_pk_bf16_f32 v31, v78, v79
    s_nop 1
    v_mfma_f32_32x32x16_bf16 v[144:159], v[232:235], v[28:31], v[144:159]
    v_mfma_f32_16x16x32_bf16 v[80:83], v[40:43], v[28:31], v[80:83]
    s_cmp_lt_u32 s38, 8
    s_cbranch_scc1 P2A_S2
    s_nop 7
    ds_read_b128 v[224:227], v14 offset:0
    ds_read_b128 v[228:231], v14 offset:2048
    ds_read_b128 v[232:235], v14 offset:3072
    s_waitcnt lgkmcnt(0)
    v_mfma_f32_32x32x16_bf16 v[64:79], v[224:227], v[48:51], v[208:223]
    s_nop 11
    v_pk_add_f32 v[64:65], v[64:65], v[8:9] op_sel_hi:[1,0]
    v_pk_add_f32 v[66:67], v[66:67], v[8:9] op_sel_hi:[1,0]
    v_pk_add_f32 v[68:69], v[68:69], v[8:9] op_sel_hi:[1,0]
    v_pk_add_f32 v[70:71], v[70:71], v[8:9] op_sel_hi:[1,0]
    v_pk_add_f32 v[72:73], v[72:73], v[8:9] op_sel_hi:[1,0]
    v_pk_add_f32 v[74:75], v[74:75], v[8:9] op_sel_hi:[1,0]
    v_pk_add_f32 v[76:77], v[76:77], v[8:9] op_sel_hi:[1,0]
    v_pk_add_f32 v[78:79], v[78:79], v[8:9] op_sel_hi:[1,0]
    v_exp_f32 v64, v64
    v_exp_f32 v65, v65
    v_exp_f32 v66, v66
    v_exp_f32 v67, v67
    v_exp_f32 v68, v68
    v_exp_f32 v69, v69
    v_exp_f32 v70, v70
    v_exp_f32 v71, v71
    v_cvt_pk_bf16_f32 v24, v64, v65
    v_cvt_pk_bf16_f32 v25, v66, v67
    v_cvt_pk_bf16_f32 v26, v68, v69
    v_cvt_pk_bf16_f32 v27, v70, v71
    v_exp_f32 v72, v72
    v_exp_f32 v73, v73
    v_exp_f32 v74, v74
    v_exp_f32 v75, v75
    v_mfma_f32_32x32x16_bf16 v[144:159], v[228:231], v[24:27], v[144:159]
    v_exp_f32 v76, v76
    v_exp_f32 v77, v77
    v_exp_f32 v78, v78
    v_exp_f32 v79, v79
    v_mfma_f32_16x16x32_bf16 v[80:83], v[40:43], v[24:27], v[80:83]
    v_cvt_pk_bf16_f32 v28, v72, v73
    v_cvt_pk_bf16_f32 v29, v74, v75
    v_cvt_pk_bf16_f32 v30, v76, v77
    v_cvt_pk_bf16_f32 v31, v78, v79
    s_nop 1
    v_mfma_f32_32x32x16_bf16 v[144:159], v[232:235], v[28:31], v[144:159]
    v_mfma_f32_16x16x32_bf16 v[80:83], v[40:43], v[28:31], v[80:83]
P2A_S2:
    s_nop 7
    v_mov_b32 v9, v80
    v_mfma_f32_32x32x16_bf16 v[64:79], a[224:227], v[52:55], v[128:143]
    s_nop 11
    s_branch P2A_OUT
P2B_E2:
    s_waitcnt vmcnt(0) lgkmcnt(0)
    v_mov_b32 v28, 0
    v_mov_b32 v29, 0
    v_mov_b32 v30, 0
    v_mov_b32 v31, 0
    v_accvgpr_write_b32 a232, 0
    v_accvgpr_write_b32 a233, 0
    v_accvgpr_write_b32 a234, 0
    v_accvgpr_write_b32 a235, 0
    v_accvgpr_write_b32 a236, 0
    v_accvgpr_write_b32 a237, 0
    v_accvgpr_write_b32 a238, 0
    v_accvgpr_write_b32 a239, 0
    v_accvgpr_write_b32 a240, 0
    v_accvgpr_write_b32 a241, 0
    v_accvgpr_write_b32 a242, 0
    v_accvgpr_write_b32 a243, 0
    v_accvgpr_write_b32 a244, 0
    v_accvgpr_write_b32 a245, 0
    v_accvgpr_write_b32 a246, 0
    v_accvgpr_write_b32 a247, 0
    v_accvgpr_write_b32 a248, 0
    v_accvgpr_write_b32 a249, 0
    v_accvgpr_write_b32 a250, 0
    v_accvgpr_write_b32 a251, 0
    v_accvgpr_write_b32 a252, 0
    v_accvgpr_write_b32 a253, 0
    v_accvgpr_write_b32 a254, 0
    v_accvgpr_write_b32 a255, 0
    s_cmp_lg_u32 s16, 0
    s_cbranch_scc1 WRC6
    s_cmp_lg_u32 s12, 0
    s_cbranch_scc1 WRC6B
    s_waitcnt vmcnt(0)
    s_mov_b64 exec, 2
    v_cmp_le_u32 vcc, v12, v15
    s_nop 1
    s_cmp_eq_u64 vcc, exec
    s_cbranch_scc1 POLL11D
    s_mov_b32 s59, 262144
    s_nop 0
POLL11:
    v_mov_b32 v15, 0
    buffer_atomic_add v15, v11, s[8:11], s3 offen offset:0 sc0 sc1
    s_waitcnt vmcnt(0)
    v_cmp_le_u32 vcc, v12, v15
    s_nop 1
    s_cmp_eq_u64 vcc, exec
    s_cbranch_scc1 POLL11D
    s_sub_u32 s59, s59, 1
    s_cbranch_scc0 POLL11
POLL11D:
    s_mov_b64 exec, -1
WRC6B:
    s_barrier
WRC6:
    s_cmp_eq_u32 s16, 0
    s_cselect_b64 vcc, -1, 0
    s_cmp_lg_u32 s38, 7
    s_cbranch_scc1 P2B_E2_6
    ds_read_b128 a[228:231], v14 offset:5120
    ds_read_b128 a[224:227], v14 offset:9216
    ds_read_b128 a[232:235], v14 offset:6144
    ds_read_b128 a[236:239], v14 offset:7168
    s_waitcnt lgkmcnt(0)
    v_mfma_f32_32x32x16_bf16 v[80:95], a[228:231], v[52:55], v[112:127]
    s_nop 11
    s_branch P2B_B2_7
P2B_E2_6:
    s_add_u32 m0, s17, 65536
    s_add_u32 s51, s30, 0
    buffer_load_dwordx4 v1, s[8:11], s51 offen offset:0 sc1 lds
    buffer_load_dwordx4 v1, s[8:11], s51 offen offset:1024 sc1 lds
    s_add_u32 m0, s17, 67584
    s_add_u32 s51, s30, 2048
    buffer_load_dwordx4 v1, s[8:11], s51 offen offset:0 sc1 lds
    buffer_load_dwordx4 v1, s[8:11], s51 offen offset:1024 sc1 lds
    s_cmp_lg_u32 s38, 6
    s_cbranch_scc1 P2B_E2_5
    ds_read_b128 a[224:227], v14 offset:9216
    ds_read_b128 a[228:231], v14 offset:13312
    ds_read_b128 a[240:243], v14 offset:10240
    ds_read_b128 a[244:247], v14 offset:11264
    s_waitcnt lgkmcnt(0)
    v_mfma_f32_32x32x16_bf16 v[64:79], a[224:227], v[52:55], v[112:127]
    s_nop 11
    s_branch P2B_B2_6
P2B_E2_5:
    s_add_u32 m0, s17, 69632
    s_add_u32 s51, s30, 4096
    buffer_load_dwordx4 v1, s[8:11], s51 offen offset:0 sc1 lds
    buffer_load_dwordx4 v1, s[8:11], s51 offen offset:1024 sc1 lds
    s_add_u32 m0, s17, 71680
    s_add_u32 s51, s30, 6144
    buffer_load_dwordx4 v1, s[8:11], s51 offen offset:0 sc1 lds
    buffer_load_dwordx4 v1, s[8:11], s51 offen offset:1024 sc1 lds
    s_cmp_lg_u32 s38, 5
    s_cbranch_scc1 P2B_E2_4
    ds_read_b128 a[228:231], v14 offset:13312
    ds_read_b128 a[224:227], v14 offset:17408
    ds_read_b128 a[248:251], v14 offset:14336
    ds_read_b128 a[252:255], v14 offset:15360
    s_waitcnt lgkmcnt(0)
    v_mfma_f32_32x32x16_bf16 v[80:95], a[228:231], v[52:55], v[112:127]
    s_nop 11
    s_branch P2B_B2_5
P2B_E2_4:
    s_lshl_b32 s19, s12, 10
    s_add_u32 m0, s19, 159744
    s_nop 0
    buffer_load_dwordx4 v1, s[8:11], s58 offen sc1 lds
    s_cmp_lg_u32 s38, 4
    s_cbranch_scc1 P2B_E2_3
    ds_read_b128 a[224:227], v14 offset:17408
    ds_read_b128 a[228:231], v14 offset:21504
    ds_read_b128 a[232:235], v14 offset:18432
    ds_read_b128 a[236:239], v14 offset:19456
    s_waitcnt lgkmcnt(0)
    v_mfma_f32_32x32x16_bf16 v[64:79], a[224:227], v[52:55], v[112:127]
    s_nop 11
    s_branch P2B_B2_4
P2B_E2_3:
    s_mov_b64 exec, 1
    buffer_atomic_add v7, v6, s[8:11], s40 offen offset:0 sc1
    s_mov_b64 exec, -1
    s_or_b32 s34, s12, s16
    s_cbranch_scc1 WRI7
    s_mov_b64 exec, 12
    v_mov_b32 v15, 0
    buffer_atomic_add v15, v11, s[8:11], s3 offen offset:0 sc0 sc1
    s_mov_b64 exec, -1
WRI7:
    s_cmp_lg_u32 s38, 3
    s_cbranch_scc1 P2B_E2_2
    ds_read_b128 a[228:231], v14 offset:21504
    ds_read_b128 a[224:227], v14 offset:25600
    ds_read_b128 a[240:243], v14 offset:22528
    ds_read_b128 a[244:247], v14 offset:23552
    s_waitcnt lgkmcnt(0)
    v_mfma_f32_32x32x16_bf16 v[80:95], a[228:231], v[52:55], v[112:127]
    s_nop 11
    s_branch P2B_B2_3
P2B_E2_2:
    s_cmp_lg_u32 s38, 2
    s_cbranch_scc1 P2B_E2_1
    ds_read_b128 a[224:227], v14 offset:25600
    ds_read_b128 a[228:231], v14 offset:29696
    ds_read_b128 a[248:251], v14 offset:26624
    ds_read_b128 a[252:255], v14 offset:27648
    s_waitcnt lgkmcnt(0)
    v_mfma_f32_32x32x16_bf16 v[64:79], a[224:227], v[52:55], v[112:127]
    s_nop 11
    s_branch P2B_B2_2
P2B_E2_1:
    s_cmp_lg_u32 s38, 1
    s_cbranch_scc1 P2B_E2_0
    ds_read_b128 a[228:231], v14 offset:29696
    ds_read_b128 a[232:235], v14 offset:30720
    ds_read_b128 a[236:239], v14 offset:31744
    s_waitcnt lgkmcnt(0)
    v_mfma_f32_32x32x16_bf16 v[80:95], a[228:231], v[52:55], v[112:127]
    s_nop 11
    s_branch P2B_B2_1
P2B_E2_0:
    s_cmp_lg_u32 s16, 0
    s_cbranch_scc1 WRC8
    s_cmp_lg_u32 s12, 0
    s_cbranch_scc1 WRC8B
    s_waitcnt vmcnt(0)
    s_mov_b64 exec, 12
    v_cmp_le_u32 vcc, v12, v15
    s_nop 1
    s_cmp_eq_u64 vcc, exec
    s_cbranch_scc1 POLL12D
    s_mov_b32 s59, 262144
    s_nop 0
POLL12:
    v_mov_b32 v15, 0
    buffer_atomic_add v15, v11, s[8:11], s3 offen offset:0 sc0 sc1
    s_waitcnt vmcnt(0)
    v_cmp_le_u32 vcc, v12, v15
    s_nop 1
    s_cmp_eq_u64 vcc, exec
    s_cbranch_scc1 POLL12D
    s_sub_u32 s59, s59, 1
    s_cbranch_scc0 POLL12
POLL12D:
    s_mov_b64 exec, -1
WRC8B:
WRC8:
    s_nop 0
    s_branch P2B_FIN
P2B_SLOW:
    s_waitcnt lgkmcnt(0)
    v_mov_b32 v8, 0xf149f2ca
    ds_read_b128 v[224:227], v14 offset:33792
    s_waitcnt lgkmcnt(0)
    v_mfma_f32_32x32x16_bf16 v[64:79], v[224:227], v[52:55], v[192:207]
    s_nop 11
    v_max3_f32 v8, v64, v65, v8
    v_max3_f32 v8, v66, v67, v8
    v_max3_f32 v8, v68, v69, v8
    v_max3_f32 v8, v70, v71, v8
    v_max3_f32 v8, v72, v73, v8
    v_max3_f32 v8, v74, v75, v8
    v_max3_f32 v8, v76, v77, v8
    v_max3_f32 v8, v78, v79, v8
    s_cmp_lt_u32 s38, 1
    s_cbranch_scc1 P2B_S1
    ds_read_b128 v[224:227], v14 offset:29696
    s_waitcnt lgkmcnt(0)
    v_mfma_f32_32x32x16_bf16 v[64:79], v[224:227], v[52:55], 0
    s_nop 11
    v_max3_f32 v8, v64, v65, v8
    v_max3_f32 v8, v66, v67, v8
    v_max3_f32 v8, v68, v69, v8
    v_max3_f32 v8, v70, v71, v8
    v_max3_f32 v8, v72, v73, v8
    v_max3_f32 v8, v74, v75, v8
    v_max3_f32 v8, v76, v77, v8
    v_max3_f32 v8, v78, v79, v8
    s_cmp_lt_u32 s38, 2
    s_cbranch_scc1 P2B_S1
    ds_read_b128 v[224:227], v14 offset:25600
    s_waitcnt lgkmcnt(0)
    v_mfma_f32_32x32x16_bf16 v[64:79], v[224:227], v[52:55], 0
    s_nop 11
    v_max3_f32 v8, v64, v65, v8
    v_max3_f32 v8, v66, v67, v8
    v_max3_f32 v8, v68, v69, v8
    v_max3_f32 v8, v70, v71, v8
    v_max3_f32 v8, v72, v73, v8
    v_max3_f32 v8, v74, v75, v8
    v_max3_f32 v8, v76, v77, v8
    v_max3_f32 v8, v78, v79, v8
    s_cmp_lt_u32 s38, 3
    s_cbranch_scc1 P2B_S1
    ds_read_b128 v[224:227], v14 offset:21504
    s_waitcnt lgkmcnt(0)
    v_mfma_f32_32x32x16_bf16 v[64:79], v[224:227], v[52:55], 0
    s_nop 11
    v_max3_f32 v8, v64, v65, v8
    v_max3_f32 v8, v66, v67, v8
    v_max3_f32 v8, v68, v69, v8
    v_max3_f32 v8, v70, v71, v8
    v_max3_f32 v8, v72, v73, v8
    v_max3_f32 v8, v74, v75, v8
    v_max3_f32 v8, v76, v77, v8
    v_max3_f32 v8, v78, v79, v8
    s_cmp_lt_u32 s38, 4
    s_cbranch_scc1 P2B_S1
    ds_read_b128 v[224:227], v14 offset:17408
    s_waitcnt lgkmcnt(0)
    v_mfma_f32_32x32x16_bf16 v[64:79], v[224:227], v[52:55], 0
    s_nop 11
    v_max3_f32 v8, v64, v65, v8
    v_max3_f32 v8, v66, v67, v8
    v_max3_f32 v8, v68, v69, v8
    v_max3_f32 v8, v70, v71, v8
    v_max3_f32 v8, v72, v73, v8
    v_max3_f32 v8, v74, v75, v8
    v_max3_f32 v8, v76, v77, v8
    v_max3_f32 v8, v78, v79, v8
    s_cmp_lt_u32 s38, 5
    s_cbranch_scc1 P2B_S1
    ds_read_b128 v[224:227], v14 offset:13312
    s_waitcnt lgkmcnt(0)
    v_mfma_f32_32x32x16_bf16 v[64:79], v[224:227], v[52:55], 0
    s_nop 11
    v_max3_f32 v8, v64, v65, v8
    v_max3_f32 v8, v66, v67, v8
    v_max3_f32 v8, v68, v69, v8
    v_max3_f32 v8, v70, v71, v8
    v_max3_f32 v8, v72, v73, v8
    v_max3_f32 v8, v74, v75, v8
    v_max3_f32 v8, v76, v77, v8
    v_max3_f32 v8, v78, v79, v8
    s_cmp_lt_u32 s38, 6
    s_cbranch_scc1 P2B_S1
    ds_read_b128 v[224:227], v14 offset:9216
    s_waitcnt lgkmcnt(0)
    v_mfma_f32_32x32x16_bf16 v[64:79], v[224:227], v[52:55], 0
    s_nop 11
    v_max3_f32 v8, v64, v65, v8
    v_max3_f32 v8, v66, v67, v8
    v_max3_f32 v8, v68, v69, v8
    v_max3_f32 v8, v70, v71, v8
    v_max3_f32 v8, v72, v73, v8
    v_max3_f32 v8, v74, v75, v8
    v_max3_f32 v8, v76, v77, v8
    v_max3_f32 v8, v78, v79, v8
    s_cmp_lt_u32 s38, 7
    s_cbranch_scc1 P2B_S1
    ds_read_b128 v[224:227], v14 offset:5120
    s_waitcnt lgkmcnt(0)
    v_mfma_f32_32x32x16_bf16 v[64:79], v[224:227], v[52:55], 0
    s_nop 11
    v_max3_f32 v8, v64, v65, v8
    v_max3_f32 v8, v66, v67, v8
    v_max3_f32 v8, v68, v69, v8
    v_max3_f32 v8, v70, v71, v8
    v_max3_f32 v8, v72, v73, v8
    v_max3_f32 v8, v74, v75, v8
    v_max3_f32 v8, v76, v77, v8
    v_max3_f32 v8, v78, v79, v8
    s_cmp_lt_u32 s38, 8
    s_cbranch_scc1 P2B_S1
    ds_read_b128 v[224:227], v14 offset:1024
    s_waitcnt lgkmcnt(0)
    v_mfma_f32_32x32x16_bf16 v[64:79], v[224:227], v[52:55], v[208:223]
    s_nop 11
    v_max3_f32 v8, v64, v65, v8
    v_max3_f32 v8, v66, v67, v8
    v_max3_f32 v8, v68, v69, v8
    v_max3_f32 v8, v70, v71, v8
    v_max3_f32 v8, v72, v73, v8
    v_max3_f32 v8, v74, v75, v8
    v_max3_f32 v8, v76, v77, v8
    v_max3_f32 v8, v78, v79, v8
P2B_S1:
    v_mov_b32 v10, v8
    s_nop 1
    v_permlane32_swap_b32 v8, v10
    v_max_f32 v8, v8, v10
    v_sub_f32 v8, 0, v8
    s_nop 7
    ds_read_b128 v[224:227], v14 offset:33792
    ds_read_b128 v[228:231], v14 offset:34816
    ds_read_b128 v[232:235], v14 offset:35840
    s_waitcnt lgkmcnt(0)
    v_mfma_f32_32x32x16_bf16 v[64:79], v[224:227], v[52:55], v[192:207]
    s_nop 11
    v_pk_add_f32 v[64:65], v[64:65], v[8:9] op_sel_hi:[1,0]
    v_pk_add_f32 v[66:67], v[66:67], v[8:9] op_sel_hi:[1,0]
    v_pk_add_f32 v[68:69], v[68:69], v[8:9] op_sel_hi:[1,0]
    v_pk_add_f32 v[70:71], v[70:71], v[8:9] op_sel_hi:[1,0]
    v_pk_add_f32 v[72:73], v[72:73], v[8:9] op_sel_hi:[1,0]
    v_pk_add_f32 v[74:75], v[74:75], v[8:9] op_sel_hi:[1,0]
    v_pk_add_f32 v[76:77], v[76:77], v[8:9] op_sel_hi:[1,0]
    v_pk_add_f32 v[78:79], v[78:79], v[8:9] op_sel_hi:[1,0]
    v_exp_f32 v64, v64
    v_exp_f32 v65, v65
    v_exp_f32 v66, v66
    v_exp_f32 v67, v67
    v_exp_f32 v68, v68
    v_exp_f32 v69, v69
    v_exp_f32 v70, v70
    v_exp_f32 v71, v71
    v_cvt_pk_bf16_f32 v24, v64, v65
    v_cvt_pk_bf16_f32 v25, v66, v67
    v_cvt_pk_bf16_f32 v26, v68, v69
    v_cvt_pk_bf16_f32 v27, v70, v71
    v_exp_f32 v72, v72
    v_exp_f32 v73, v73
    v_exp_f32 v74, v74
    v_exp_f32 v75, v75
    v_mfma_f32_32x32x16_bf16 v[160:175], v[228:231], v[24:27], 0
    v_exp_f32 v76, v76
    v_exp_f32 v77, v77
    v_exp_f32 v78, v78
    v_exp_f32 v79, v79
    v_mfma_f32_16x16x32_bf16 v[88:91], v[40:43], v[24:27], 0
    v_cvt_pk_bf16_f32 v28, v72, v73
    v_cvt_pk_bf16_f32 v29, v74, v75
    v_cvt_pk_bf16_f32 v30, v76, v77
    v_cvt_pk_bf16_f32 v31, v78, v79
    s_nop 1
    v_mfma_f32_32x32x16_bf16 v[160:175], v[232:235], v[28:31], v[160:175]
    v_mfma_f32_16x16x32_bf16 v[88:91], v[40:43], v[28:31], v[88:91]
    s_cmp_lt_u32 s38, 1
    s_cbranch_scc1 P2B_S2
    s_nop 7
    ds_read_b128 v[224:227], v14 offset:29696
    ds_read_b128 v[228:231], v14 offset:30720
    ds_read_b128 v[232:235], v14 offset:31744
    s_waitcnt lgkmcnt(0)
    v_mfma_f32_32x32x16_bf16 v[64:79], v[224:227], v[52:55], 0
    s_nop 11
    v_pk_add_f32 v[64:65], v[64:65], v[8:9] op_sel_hi:[1,0]
    v_pk_add_f32 v[66:67], v[66:67], v[8:9] op_sel_hi:[1,0]
    v_pk_add_f32 v[68:69], v[68:69], v[8:9] op_sel_hi:[1,0]
    v_pk_add_f32 v[70:71], v[70:71], v[8:9] op_sel_hi:[1,0]
    v_pk_add_f32 v[72:73], v[72:73], v[8:9] op_sel_hi:[1,0]
    v_pk_add_f32 v[74:75], v[74:75], v[8:9] op_sel_hi:[1,0]
    v_pk_add_f32 v[76:77], v[76:77], v[8:9] op_sel_hi:[1,0]
    v_pk_add_f32 v[78:79], v[78:79], v[8:9] op_sel_hi:[1,0]
    v_exp_f32 v64, v64
    v_exp_f32 v65, v65
    v_exp_f32 v66, v66
    v_exp_f32 v67, v67
    v_exp_f32 v68, v68
    v_exp_f32 v69, v69
    v_exp_f32 v70, v70
    v_exp_f32 v71, v71
    v_cvt_pk_bf16_f32 v24, v64, v65
    v_cvt_pk_bf16_f32 v25, v66, v67
    v_cvt_pk_bf16_f32 v26, v68, v69
    v_cvt_pk_bf16_f32 v27, v70, v71
    v_exp_f32 v72, v72
    v_exp_f32 v73, v73
    v_exp_f32 v74, v74
    v_exp_f32 v75, v75
    v_mfma_f32_32x32x16_bf16 v[160:175], v[228:231], v[24:27], v[160:175]
    v_exp_f32 v76, v76
    v_exp_f32 v77, v77
    v_exp_f32 v78, v78
    v_exp_f32 v79, v79
    v_mfma_f32_16x16x32_bf16 v[88:91], v[40:43], v[24:27], v[88:91]
    v_cvt_pk_bf16_f32 v28, v72, v73
    v_cvt_pk_bf16_f32 v29, v74, v75
    v_cvt_pk_bf16_f32 v30, v76, v77
    v_cvt_pk_bf16_f32 v31, v78, v79
    s_nop 1
    v_mfma_f32_32x32x16_bf16 v[160:175], v[232:235], v[28:31], v[160:175]
    v_mfma_f32_16x16x32_bf16 v[88:91], v[40:43], v[28:31], v[88:91]
    s_cmp_lt_u32 s38, 2
    s_cbranch_scc1 P2B_S2
    s_nop 7
    ds_read_b128 v[224:227], v14 offset:25600
    ds_read_b128 v[228:231], v14 offset:26624
    ds_read_b128 v[232:235], v14 offset:27648
    s_waitcnt lgkmcnt(0)
    v_mfma_f32_32x32x16_bf16 v[64:79], v[224:227], v[52:55], 0
    s_nop 11
    v_pk_add_f32 v[64:65], v[64:65], v[8:9] op_sel_hi:[1,0]
    v_pk_add_f32 v[66:67], v[66:67], v[8:9] op_sel_hi:[1,0]
    v_pk_add_f32 v[68:69], v[68:69], v[8:9] op_sel_hi:[1,0]
    v_pk_add_f32 v[70:71], v[70:71], v[8:9] op_sel_hi:[1,0]
    v_pk_add_f32 v[72:73], v[72:73], v[8:9] op_sel_hi:[1,0]
    v_pk_add_f32 v[74:75], v[74:75], v[8:9] op_sel_hi:[1,0]
    v_pk_add_f32 v[76:77], v[76:77], v[8:9] op_sel_hi:[1,0]
    v_pk_add_f32 v[78:79], v[78:79], v[8:9] op_sel_hi:[1,0]
    v_exp_f32 v64, v64
    v_exp_f32 v65, v65
    v_exp_f32 v66, v66
    v_exp_f32 v67, v67
    v_exp_f32 v68, v68
    v_exp_f32 v69, v69
    v_exp_f32 v70, v70
    v_exp_f32 v71, v71
    v_cvt_pk_bf16_f32 v24, v64, v65
    v_cvt_pk_bf16_f32 v25, v66, v67
    v_cvt_pk_bf16_f32 v26, v68, v69
    v_cvt_pk_bf16_f32 v27, v70, v71
    v_exp_f32 v72, v72
    v_exp_f32 v73, v73
    v_exp_f32 v74, v74
    v_exp_f32 v75, v75
    v_mfma_f32_32x32x16_bf16 v[160:175], v[228:231], v[24:27], v[160:175]
    v_exp_f32 v76, v76
    v_exp_f32 v77, v77
    v_exp_f32 v78, v78
    v_exp_f32 v79, v79
    v_mfma_f32_16x16x32_bf16 v[88:91], v[40:43], v[24:27], v[88:91]
    v_cvt_pk_bf16_f32 v28, v72, v73
    v_cvt_pk_bf16_f32 v29, v74, v75
    v_cvt_pk_bf16_f32 v30, v76, v77
    v_cvt_pk_bf16_f32 v31, v78, v79
    s_nop 1
    v_mfma_f32_32x32x16_bf16 v[160:175], v[232:235], v[28:31], v[160:175]
    v_mfma_f32_16x16x32_bf16 v[88:91], v[40:43], v[28:31], v[88:91]
    s_cmp_lt_u32 s38, 3
    s_cbranch_scc1 P2B_S2
    s_nop 7
    ds_read_b128 v[224:227], v14 offset:21504
    ds_read_b128 v[228:231], v14 offset:22528
    ds_read_b128 v[232:235], v14 offset:23552
    s_waitcnt lgkmcnt(0)
    v_mfma_f32_32x32x16_bf16 v[64:79], v[224:227], v[52:55], 0
    s_nop 11
    v_pk_add_f32 v[64:65], v[64:65], v[8:9] op_sel_hi:[1,0]
    v_pk_add_f32 v[66:67], v[66:67], v[8:9] op_sel_hi:[1,0]
    v_pk_add_f32 v[68:69], v[68:69], v[8:9] op_sel_hi:[1,0]
    v_pk_add_f32 v[70:71], v[70:71], v[8:9] op_sel_hi:[1,0]
    v_pk_add_f32 v[72:73], v[72:73], v[8:9] op_sel_hi:[1,0]
    v_pk_add_f32 v[74:75], v[74:75], v[8:9] op_sel_hi:[1,0]
    v_pk_add_f32 v[76:77], v[76:77], v[8:9] op_sel_hi:[1,0]
    v_pk_add_f32 v[78:79], v[78:79], v[8:9] op_sel_hi:[1,0]
    v_exp_f32 v64, v64
    v_exp_f32 v65, v65
    v_exp_f32 v66, v66
    v_exp_f32 v67, v67
    v_exp_f32 v68, v68
    v_exp_f32 v69, v69
    v_exp_f32 v70, v70
    v_exp_f32 v71, v71
    v_cvt_pk_bf16_f32 v24, v64, v65
    v_cvt_pk_bf16_f32 v25, v66, v67
    v_cvt_pk_bf16_f32 v26, v68, v69
    v_cvt_pk_bf16_f32 v27, v70, v71
    v_exp_f32 v72, v72
    v_exp_f32 v73, v73
    v_exp_f32 v74, v74
    v_exp_f32 v75, v75
    v_mfma_f32_32x32x16_bf16 v[160:175], v[228:231], v[24:27], v[160:175]
    v_exp_f32 v76, v76
    v_exp_f32 v77, v77
    v_exp_f32 v78, v78
    v_exp_f32 v79, v79
    v_mfma_f32_16x16x32_bf16 v[88:91], v[40:43], v[24:27], v[88:91]
    v_cvt_pk_bf16_f32 v28, v72, v73
    v_cvt_pk_bf16_f32 v29, v74, v75
    v_cvt_pk_bf16_f32 v30, v76, v77
    v_cvt_pk_bf16_f32 v31, v78, v79
    s_nop 1
    v_mfma_f32_32x32x16_bf16 v[160:175], v[232:235], v[28:31], v[160:175]
    v_mfma_f32_16x16x32_bf16 v[88:91], v[40:43], v[28:31], v[88:91]
    s_cmp_lt_u32 s38, 4
    s_cbranch_scc1 P2B_S2
    s_nop 7
    ds_read_b128 v[224:227], v14 offset:17408
    ds_read_b128 v[228:231], v14 offset:18432
    ds_read_b128 v[232:235], v14 offset:19456
    s_waitcnt lgkmcnt(0)
    v_mfma_f32_32x32x16_bf16 v[64:79], v[224:227], v[52:55], 0
    s_nop 11
    v_pk_add_f32 v[64:65], v[64:65], v[8:9] op_sel_hi:[1,0]
    v_pk_add_f32 v[66:67], v[66:67], v[8:9] op_sel_hi:[1,0]
    v_pk_add_f32 v[68:69], v[68:69], v[8:9] op_sel_hi:[1,0]
    v_pk_add_f32 v[70:71], v[70:71], v[8:9] op_sel_hi:[1,0]
    v_pk_add_f32 v[72:73], v[72:73], v[8:9] op_sel_hi:[1,0]
    v_pk_add_f32 v[74:75], v[74:75], v[8:9] op_sel_hi:[1,0]
    v_pk_add_f32 v[76:77], v[76:77], v[8:9] op_sel_hi:[1,0]
    v_pk_add_f32 v[78:79], v[78:79], v[8:9] op_sel_hi:[1,0]
    v_exp_f32 v64, v64
    v_exp_f32 v65, v65
    v_exp_f32 v66, v66
    v_exp_f32 v67, v67
    v_exp_f32 v68, v68
    v_exp_f32 v69, v69
    v_exp_f32 v70, v70
    v_exp_f32 v71, v71
    v_cvt_pk_bf16_f32 v24, v64, v65
    v_cvt_pk_bf16_f32 v25, v66, v67
    v_cvt_pk_bf16_f32 v26, v68, v69
    v_cvt_pk_bf16_f32 v27, v70, v71
    v_exp_f32 v72, v72
    v_exp_f32 v73, v73
    v_exp_f32 v74, v74
    v_exp_f32 v75, v75
    v_mfma_f32_32x32x16_bf16 v[160:175], v[228:231], v[24:27], v[160:175]
    v_exp_f32 v76, v76
    v_exp_f32 v77, v77
    v_exp_f32 v78, v78
    v_exp_f32 v79, v79
    v_mfma_f32_16x16x32_bf16 v[88:91], v[40:43], v[24:27], v[88:91]
    v_cvt_pk_bf16_f32 v28, v72, v73
    v_cvt_pk_bf16_f32 v29, v74, v75
    v_cvt_pk_bf16_f32 v30, v76, v77
    v_cvt_pk_bf16_f32 v31, v78, v79
    s_nop 1
    v_mfma_f32_32x32x16_bf16 v[160:175], v[232:235], v[28:31], v[160:175]
    v_mfma_f32_16x16x32_bf16 v[88:91], v[40:43], v[28:31], v[88:91]
    s_cmp_lt_u32 s38, 5
    s_cbranch_scc1 P2B_S2
    s_nop 7
    ds_read_b128 v[224:227], v14 offset:13312
    ds_read_b128 v[228:231], v14 offset:14336
    ds_read_b128 v[232:235], v14 offset:15360
    s_waitcnt lgkmcnt(0)
    v_mfma_f32_32x32x16_bf16 v[64:79], v[224:227], v[52:55], 0
    s_nop 11
    v_pk_add_f32 v[64:65], v[64:65], v[8:9] op_sel_hi:[1,0]
    v_pk_add_f32 v[66:67], v[66:67], v[8:9] op_sel_hi:[1,0]
    v_pk_add_f32 v[68:69], v[68:69], v[8:9] op_sel_hi:[1,0]
    v_pk_add_f32 v[70:71], v[70:71], v[8:9] op_sel_hi:[1,0]
    v_pk_add_f32 v[72:73], v[72:73], v[8:9] op_sel_hi:[1,0]
    v_pk_add_f32 v[74:75], v[74:75], v[8:9] op_sel_hi:[1,0]
    v_pk_add_f32 v[76:77], v[76:77], v[8:9] op_sel_hi:[1,0]
    v_pk_add_f32 v[78:79], v[78:79], v[8:9] op_sel_hi:[1,0]
    v_exp_f32 v64, v64
    v_exp_f32 v65, v65
    v_exp_f32 v66, v66
    v_exp_f32 v67, v67
    v_exp_f32 v68, v68
    v_exp_f32 v69, v69
    v_exp_f32 v70, v70
    v_exp_f32 v71, v71
    v_cvt_pk_bf16_f32 v24, v64, v65
    v_cvt_pk_bf16_f32 v25, v66, v67
    v_cvt_pk_bf16_f32 v26, v68, v69
    v_cvt_pk_bf16_f32 v27, v70, v71
    v_exp_f32 v72, v72
    v_exp_f32 v73, v73
    v_exp_f32 v74, v74
    v_exp_f32 v75, v75
    v_mfma_f32_32x32x16_bf16 v[160:175], v[228:231], v[24:27], v[160:175]
    v_exp_f32 v76, v76
    v_exp_f32 v77, v77
    v_exp_f32 v78, v78
    v_exp_f32 v79, v79
    v_mfma_f32_16x16x32_bf16 v[88:91], v[40:43], v[24:27], v[88:91]
    v_cvt_pk_bf16_f32 v28, v72, v73
    v_cvt_pk_bf16_f32 v29, v74, v75
    v_cvt_pk_bf16_f32 v30, v76, v77
    v_cvt_pk_bf16_f32 v31, v78, v79
    s_nop 1
    v_mfma_f32_32x32x16_bf16 v[160:175], v[232:235], v[28:31], v[160:175]
    v_mfma_f32_16x16x32_bf16 v[88:91], v[40:43], v[28:31], v[88:91]
    s_cmp_lt_u32 s38, 6
    s_cbranch_scc1 P2B_S2
    s_nop 7
    ds_read_b128 v[224:227], v14 offset:9216
    ds_read_b128 v[228:231], v14 offset:10240
    ds_read_b128 v[232:235], v14 offset:11264
    s_waitcnt lgkmcnt(0)
    v_mfma_f32_32x32x16_bf16 v[64:79], v[224:227], v[52:55], 0
    s_nop 11
    v_pk_add_f32 v[64:65], v[64:65], v[8:9] op_sel_hi:[1,0]
    v_pk_add_f32 v[66:67], v[66:67], v[8:9] op_sel_hi:[1,0]
    v_pk_add_f32 v[68:69], v[68:69], v[8:9] op_sel_hi:[1,0]
    v_pk_add_f32 v[70:71], v[70:71], v[8:9] op_sel_hi:[1,0]
    v_pk_add_f32 v[72:73], v[72:73], v[8:9] op_sel_hi:[1,0]
    v_pk_add_f32 v[74:75], v[74:75], v[8:9] op_sel_hi:[1,0]
    v_pk_add_f32 v[76:77], v[76:77], v[8:9] op_sel_hi:[1,0]
    v_pk_add_f32 v[78:79], v[78:79], v[8:9] op_sel_hi:[1,0]
    v_exp_f32 v64, v64
    v_exp_f32 v65, v65
    v_exp_f32 v66, v66
    v_exp_f32 v67, v67
    v_exp_f32 v68, v68
    v_exp_f32 v69, v69
    v_exp_f32 v70, v70
    v_exp_f32 v71, v71
    v_cvt_pk_bf16_f32 v24, v64, v65
    v_cvt_pk_bf16_f32 v25, v66, v67
    v_cvt_pk_bf16_f32 v26, v68, v69
    v_cvt_pk_bf16_f32 v27, v70, v71
    v_exp_f32 v72, v72
    v_exp_f32 v73, v73
    v_exp_f32 v74, v74
    v_exp_f32 v75, v75
    v_mfma_f32_32x32x16_bf16 v[160:175], v[228:231], v[24:27], v[160:175]
    v_exp_f32 v76, v76
    v_exp_f32 v77, v77
    v_exp_f32 v78, v78
    v_exp_f32 v79, v79
    v_mfma_f32_16x16x32_bf16 v[88:91], v[40:43], v[24:27], v[88:91]
    v_cvt_pk_bf16_f32 v28, v72, v73
    v_cvt_pk_bf16_f32 v29, v74, v75
    v_cvt_pk_bf16_f32 v30, v76, v77
    v_cvt_pk_bf16_f32 v31, v78, v79
    s_nop 1
    v_mfma_f32_32x32x16_bf16 v[160:175], v[232:235], v[28:31], v[160:175]
    v_mfma_f32_16x16x32_bf16 v[88:91], v[40:43], v[28:31], v[88:91]
    s_cmp_lt_u32 s38, 7
    s_cbranch_scc1 P2B_S2
    s_nop 7
    ds_read_b128 v[224:227], v14 offset:5120
    ds_read_b128 v[228:231], v14 offset:6144
    ds_read_b128 v[232:235], v14 offset:7168
    s_waitcnt lgkmcnt(0)
    v_mfma_f32_32x32x16_bf16 v[64:79], v[224:227], v[52:55], 0
    s_nop 11
    v_pk_add_f32 v[64:65], v[64:65], v[8:9] op_sel_hi:[1,0]
    v_pk_add_f32 v[66:67], v[66:67], v[8:9] op_sel_hi:[1,0]
    v_pk_add_f32 v[68:69], v[68:69], v[8:9] op_sel_hi:[1,0]
    v_pk_add_f32 v[70:71], v[70:71], v[8:9] op_sel_hi:[1,0]
    v_pk_add_f32 v[72:73], v[72:73], v[8:9] op_sel_hi:[1,0]
    v_pk_add_f32 v[74:75], v[74:75], v[8:9] op_sel_hi:[1,0]
    v_pk_add_f32 v[76:77], v[76:77], v[8:9] op_sel_hi:[1,0]
    v_pk_add_f32 v[78:79], v[78:79], v[8:9] op_sel_hi:[1,0]
    v_exp_f32 v64, v64
    v_exp_f32 v65, v65
    v_exp_f32 v66, v66
    v_exp_f32 v67, v67
    v_exp_f32 v68, v68
    v_exp_f32 v69, v69
    v_exp_f32 v70, v70
    v_exp_f32 v71, v71
    v_cvt_pk_bf16_f32 v24, v64, v65
    v_cvt_pk_bf16_f32 v25, v66, v67
    v_cvt_pk_bf16_f32 v26, v68, v69
    v_cvt_pk_bf16_f32 v27, v70, v71
    v_exp_f32 v72, v72
    v_exp_f32 v73, v73
    v_exp_f32 v74, v74
    v_exp_f32 v75, v75
    v_mfma_f32_32x32x16_bf16 v[160:175], v[228:231], v[24:27], v[160:175]
    v_exp_f32 v76, v76
    v_exp_f32 v77, v77
    v_exp_f32 v78, v78
    v_exp_f32 v79, v79
    v_mfma_f32_16x16x32_bf16 v[88:91], v[40:43], v[24:27], v[88:91]
    v_cvt_pk_bf16_f32 v28, v72, v73
    v_cvt_pk_bf16_f32 v29, v74, v75
    v_cvt_pk_bf16_f32 v30, v76, v77
    v_cvt_pk_bf16_f32 v31, v78, v79
    s_nop 1
    v_mfma_f32_32x32x16_bf16 v[160:175], v[232:235], v[28:31], v[160:175]
    v_mfma_f32_16x16x32_bf16 v[88:91], v[40:43], v[28:31], v[88:91]
    s_cmp_lt_u32 s38, 8
    s_cbranch_scc1 P2B_S2
    s_nop 7
    ds_read_b128 v[224:227], v14 offset:1024
    ds_read_b128 v[228:231], v14 offset:2048
    ds_read_b128 v[232:235], v14 offset:3072
    s_waitcnt lgkmcnt(0)
    v_mfma_f32_32x32x16_bf16 v[64:79], v[224:227], v[52:55], v[208:223]
    s_nop 11
    v_pk_add_f32 v[64:65], v[64:65], v[8:9] op_sel_hi:[1,0]
    v_pk_add_f32 v[66:67], v[66:67], v[8:9] op_sel_hi:[1,0]
    v_pk_add_f32 v[68:69], v[68:69], v[8:9] op_sel_hi:[1,0]
    v_pk_add_f32 v[70:71], v[70:71], v[8:9] op_sel_hi:[1,0]
    v_pk_add_f32 v[72:73], v[72:73], v[8:9] op_sel_hi:[1,0]
    v_pk_add_f32 v[74:75], v[74:75], v[8:9] op_sel_hi:[1,0]
    v_pk_add_f32 v[76:77], v[76:77], v[8:9] op_sel_hi:[1,0]
    v_pk_add_f32 v[78:79], v[78:79], v[8:9] op_sel_hi:[1,0]
    v_exp_f32 v64, v64
    v_exp_f32 v65, v65
    v_exp_f32 v66, v66
    v_exp_f32 v67, v67
    v_exp_f32 v68, v68
    v_exp_f32 v69, v69
    v_exp_f32 v70, v70
    v_exp_f32 v71, v71
    v_cvt_pk_bf16_f32 v24, v64, v65
    v_cvt_pk_bf16_f32 v25, v66, v67
    v_cvt_pk_bf16_f32 v26, v68, v69
    v_cvt_pk_bf16_f32 v27, v70, v71
    v_exp_f32 v72, v72
    v_exp_f32 v73, v73
    v_exp_f32 v74, v74
    v_exp_f32 v75, v75
    v_mfma_f32_32x32x16_bf16 v[160:175], v[228:231], v[24:27], v[160:175]
    v_exp_f32 v76, v76
    v_exp_f32 v77, v77
    v_exp_f32 v78, v78
    v_exp_f32 v79, v79
    v_mfma_f32_16x16x32_bf16 v[88:91], v[40:43], v[24:27], v[88:91]
    v_cvt_pk_bf16_f32 v28, v72, v73
    v_cvt_pk_bf16_f32 v29, v74, v75
    v_cvt_pk_bf16_f32 v30, v76, v77
    v_cvt_pk_bf16_f32 v31, v78, v79
    s_nop 1
    v_mfma_f32_32x32x16_bf16 v[160:175], v[232:235], v[28:31], v[160:175]
    v_mfma_f32_16x16x32_bf16 v[88:91], v[40:43], v[28:31], v[88:91]
P2B_S2:
    s_nop 7
    v_mov_b32 v9, v88
    s_nop 4
    s_branch P2B_OUT
CODE_END:
.section .rodata,"a"
.p2align 6
.amdhsa_kernel interleave_layers__sliding_block__dense_activation_gelu__prompt_kernel
  .amdhsa_next_free_vgpr 512
  .amdhsa_next_free_sgpr 102
  .amdhsa_accum_offset 256
  .amdhsa_group_segment_fixed_size 0
  .amdhsa_kernarg_size 88
  .amdhsa_user_sgpr_count 2
  .amdhsa_user_sgpr_kernarg_segment_ptr 1
  .amdhsa_system_sgpr_workgroup_id_x 1
.end_amdhsa_kernel
```
